```python
import torch

def _softmax(x, axis=-1):
    return torch.softmax(x, dim=axis)
def _gelu(x):
    return torch.nn.functional.gelu(x, approximate="tanh")
def _silu(x):
    return torch.nn.functional.silu(x)
def _sigmoid(x):
    return torch.sigmoid(x)
def _layernorm(x, axis=-1, eps=1e-5):
    m = x.mean(dim=axis, keepdim=True)
    v = x.var(dim=axis, keepdim=True, unbiased=False)
    return (x - m) / torch.sqrt(v + eps)
def _scatter_add(tgt, idx, src, axis=0):
    return tgt.clone().index_add_(axis, idx, src)
def _segment_sum(src, seg, n):
    out = torch.zeros((n,) + src.shape[1:], dtype=src.dtype)
    return out.index_add_(0, seg, src)
def _pad(x, pw):
    flat = tuple(v for pair in reversed(pw) for v in pair)
    return torch.nn.functional.pad(x, flat)

kernel_name = 'sequential_preLN__ssm_conv_s4__dense_activation_relu__prompt'

def setup_inputs():

    _w = (lambda a: (lambda t: t.to(torch.bfloat16) if t.is_floating_point() else t)(torch.as_tensor(a)))
    def _A_setup():
        B, L, D, N = 1, 2048, 576, 128
        A_re = -(lambda _x: torch.exp(torch.as_tensor(_x)))((lambda *s: torch.randn(*s, dtype=torch.bfloat16) * 6.4)(D, N))
        A_im = torch.pi * (lambda *s: torch.randn(*s, dtype=torch.bfloat16) * 0.05)(D, N)
        B_re = (lambda *s: torch.randn(*s, dtype=torch.bfloat16) * 0.05)(D, N)
        B_im = (lambda *s: torch.randn(*s, dtype=torch.bfloat16) * 0.05)(D, N)
        C_re = (lambda *s: torch.randn(*s, dtype=torch.bfloat16) * 0.05)(D, N)
        C_im = (lambda *s: torch.randn(*s, dtype=torch.bfloat16) * 0.05)(D, N)
        log_dt = (lambda *s: torch.randn(*s, dtype=torch.bfloat16) * 0.05)(D) * 0.5 - 4.0
        Dskip = (lambda *s: torch.randn(*s, dtype=torch.bfloat16) * 0.05)(D)
        return {
            "u": _w((lambda *s: torch.randn(*s, dtype=torch.bfloat16) * 0.05)(B, L, D)),
            "A_re": _w(A_re),
            "A_im": _w(A_im),
            "B_re": _w(B_re),
            "B_im": _w(B_im),
            "C_re": _w(C_re),
            "C_im": _w(C_im),
            "log_dt": _w(log_dt),
            "Dskip": _w(Dskip),
        }
    _A_in = _A_setup()

    def _B_setup():
        B, S, D, Dff = 1, 2048, 576, 4608
        return {
            "x": _w((lambda *s: torch.randn(*s, dtype=torch.bfloat16) * 0.05)(B, S, D)),
            "w1": _w((lambda *s: torch.randn(*s, dtype=torch.bfloat16) * 0.05)(D, Dff)),
            "w2": _w((lambda *s: torch.randn(*s, dtype=torch.bfloat16) * 0.05)(Dff, D)),
        }
    _B_in = _B_setup()

    return {
        "A_u": _A_in["u"],
        "A_A_re": _A_in["A_re"],
        "A_A_im": _A_in["A_im"],
        "A_B_re": _A_in["B_re"],
        "A_B_im": _A_in["B_im"],
        "A_C_re": _A_in["C_re"],
        "A_C_im": _A_in["C_im"],
        "A_log_dt": _A_in["log_dt"],
        "A_Dskip": _A_in["Dskip"],
        "B_x": _B_in["x"],
        "B_w1": _B_in["w1"],
        "B_w2": _B_in["w2"],
    }

def reference(A_u, A_A_re, A_A_im, A_B_re, A_B_im, A_C_re, A_C_im, A_log_dt, A_Dskip, B_x, B_w1, B_w2):
    def _A_ref(u, A_re, A_im, B_re, B_im, C_re, C_im, log_dt, Dskip):
        Bsz, L, D = u.shape
        dt = torch.exp(log_dt)[:, None]
        A = A_re + 1j * A_im
        Bc = B_re + 1j * B_im
        Cc = C_re + 1j * C_im
        logdA = dt * A
        dB = dt * Bc
        l = (lambda x, dt: x.to(dt))(torch.arange(L), A_re.dtype)
        P = torch.exp(logdA[:, :, None] * l[None, None, :])
        K = torch.einsum("dn,dnl,dn->dl", Cc, P, dB).real
        L2 = 2 * L
        Kp = _pad(K, ((0, 0), (0, L)))
        up = (lambda x, *d: x.permute(*d))(u, 0, 2, 1)
        up = _pad(up, ((0, 0), (0, 0), (0, L)))
        Kf = (lambda x, axes=(-2,-1): torch.fft.rfft2(x.float(), dim=axes))(Kp[:, None, :], axes=(-2, -1))
        Uf = (lambda x, axes=(-2,-1): torch.fft.rfft2(x.float(), dim=axes))(up[:, :, None, :], axes=(-2, -1))
        Yf = Uf * Kf[None, :, :, :]
        y = (lambda x, s, axes=(-2,-1): torch.fft.irfft2(x, s=s, dim=axes).to(torch.bfloat16))(Yf, (1, L2), axes=(-2, -1))[:, :, 0, :L]
        y = (lambda x, *d: x.permute(*d))(y, 0, 2, 1) + u * Dskip[None, None, :]
        return y

    def _B_ref(x, w1, w2):
        h = torch.einsum("bsd,df->bsf", x, w1)
        zero = torch.zeros_like(h)
        h = torch.maximum(h, zero)
        return torch.einsum("bsf,fd->bsd", h, w2)

    x = A_u
    h = x + _A_ref(_layernorm(x, axis=-1), A_A_re, A_A_im, A_B_re, A_B_im, A_C_re, A_C_im, A_log_dt, A_Dskip)
    h2 = h + _B_ref(_layernorm(h, axis=-1), B_w1, B_w2)
    return h2
```

```asm
; @launch grid=(256,1,1) block=(256,1,1) lds=156160
.amdgcn_target "amdgcn-amd-amdhsa--gfx950"
.text
.globl sequential_preLN__ssm_conv_s4__dense_activation_relu__prompt_kernel
.p2align 8
.type sequential_preLN__ssm_conv_s4__dense_activation_relu__prompt_kernel,@function
sequential_preLN__ssm_conv_s4__dense_activation_relu__prompt_kernel:
L_code_begin:
    s_cmp_ge_u32 s2, 256
    s_cbranch_scc1 L_exit
    s_load_dwordx16 s[32:47], s[0:1], 0
    s_load_dwordx8 s[48:55], s[0:1], 64
    s_load_dwordx4 s[56:59], s[0:1], 96
    s_load_dwordx2 s[60:61], s[0:1], 112
    s_sub_u32 s30, s2, 0
    s_cmp_ge_u32 s30, 16
    s_cbranch_scc1 L_cpf
    s_getpc_b64 s[28:29]
L_cpf_pc:
    s_lshr_b32 s30, s30, 3
    s_lshl_b32 s30, s30, 15
    v_lshl_add_u32 v96, v0, 7, s30
    v_min_u32 v96, L_code_end-L_cpf_pc-4, v96
    v_add_co_u32 v96, vcc, s28, v96
    v_mov_b32 v97, s29
    s_nop 0
    v_addc_co_u32 v97, vcc, 0, v97, vcc
    global_load_dword v98, v[96:97], off
L_cpf:
    v_lshrrev_b32 v1, 6, v0
    s_nop 0
    v_readfirstlane_b32 s3, v1
    v_and_b32_e64 v2, 63, v0
    v_mov_b32_e64 v92, 0
    v_mov_b32_e64 v93, 0
    v_mov_b32_e64 v94, 0
    v_mov_b32_e64 v95, 0
    s_mov_b32 s72, 200000
    s_and_b32 s75, s2, 7
    s_mul_i32 s75, s75, 18
    s_lshr_b32 s26, s2, 3
    s_add_u32 s75, s75, s26
    s_lshl_b32 s24, s75, 2
    s_add_u32 s24, s24, s3
    s_lshl_b32 s70, s75, 3
    s_add_u32 s71, s70, 4608
    v_mul_u32_u24 v136, 9216, v0
    v_lshlrev_b32 v137, 6, v0
    v_add_u32 v137, 38338560, v137
    s_waitcnt lgkmcnt(0)
    s_mov_b32 s12, s32
    s_and_b32 s13, s33, 0xffff
    s_mov_b32 s14, 2359296
    s_mov_b32 s15, 0x20000
    s_mov_b32 s8, s60
    s_and_b32 s9, s61, 0xffff
    s_mov_b32 s10, 38406144
    s_mov_b32 s11, 0x20000
    s_mov_b32 s4, s58
    s_and_b32 s5, s59, 0xffff
    s_mov_b32 s6, 256
    s_mov_b32 s7, 0x20000
    s_cmp_ge_u32 s2, 144
    s_cbranch_scc1 L_aux
    s_load_dwordx2 s[82:83], s[48:49], s70
    s_lshl_b32 s28, s24, 8
    v_lshl_add_u32 v1, v2, 2, s28
    global_load_dword v84, v1, s[34:35] nt
    global_load_dword v85, v1, s[36:37] nt
    global_load_dword v86, v1, s[38:39] nt
    global_load_dword v87, v1, s[40:41] nt
    global_load_dword v88, v1, s[42:43] nt
    global_load_dword v89, v1, s[44:45] nt
    s_lshl_b32 s28, s24, 1
    v_mov_b32_e64 v1, s28
    global_load_ushort v90, v1, s[46:47]
    s_barrier
    buffer_load_dwordx2 v[164:165], v136, s[12:15], s70 offen offset:0
    buffer_load_dwordx2 v[166:167], v136, s[12:15], s70 offen offset:1152
    buffer_load_dwordx2 v[168:169], v136, s[12:15], s70 offen offset:2304
    buffer_load_dwordx2 v[170:171], v136, s[12:15], s70 offen offset:3456
    s_lshl_b32 s30, s2, 2
    s_add_u32 s30, s30, s3
    s_add_u32 s30, s30, 272
    s_mov_b32 s20, s54
    s_nop 0
    s_and_b32 s21, s55, 0xffff
    s_mov_b32 s22, 5308416
    s_mov_b32 s23, 0x20000
    s_mul_hi_u32 s28, s30, 0xe38e38f
    s_mul_i32 s29, s28, 18
    s_sub_u32 s29, s30, s29
    s_mul_hi_u32 s64, s28, 0x1c71c71d
    s_mul_i32 s64, s64, 662400
    s_lshl_b32 s65, s28, 7
    s_add_u32 s64, s64, s65
    s_mul_i32 s65, s29, 36864
    s_add_u32 s64, s64, s65
    s_mul_i32 s65, s28, 73728
    s_lshl_b32 s67, s29, 10
    s_add_u32 s65, s65, s67
    s_add_u32 s65, s65, 14155776
    s_mov_b32 s63, 1152
    s_mov_b32 s68, 9216
    s_mov_b32 s69, 9216
    s_mov_b32 s81, s65
    s_mul_i32 s66, s3, 29568
    s_add_u32 s66, s66, 8192
    v_lshrrev_b32 v1, 3, v2
    v_mul_u32_u24 v124, s63, v1
    v_lshrrev_b32 v1, 4, v2
    v_lshlrev_b32 v1, 1, v1
    v_xor_b32 v1, v1, v2
    v_and_b32 v1, 7, v1
    v_lshl_add_u32 v124, v1, 4, v124
    v_lshrrev_b32_e64 v1, 2, v2
    v_lshl_add_u32 v120, v1, 7, s66
    v_bfe_u32 v1, v2, 3, 2
    v_lshl_add_u32 v120, v1, 5, v120
    v_and_b32 v1, 3, v2
    v_lshl_add_u32 v120, v1, 3, v120
    v_xor_b32 v121, 32, v120
    v_xor_b32_e64 v122, 64, v120
    v_xor_b32 v123, 96, v120
    v_lshlrev_b32 v125, 4, v2
    v_lshlrev_b32 v1, 4, v0
    v_add_u32 v1, 118272, v1
    ds_write_b128 v1, v[92:95]
    v_and_b32 v196, 15, v2
    v_lshrrev_b32 v197, 4, v2
    v_lshlrev_b32 v198, 3, v197
    v_sub_u32 v198, v196, v198
    s_mov_b32 s29, 0x8001
    s_mov_b32 s30, 0x10001
    v_add_u32 v202, 38, v198
    v_mov_b32 v200, 31
    v_mov_b32_e64 v201, 0
    v_lshlrev_b64 v[200:201], v202, v[200:201]
    v_bfe_u32 v148, v201, 0, 2
    v_bfe_u32 v149, v201, 2, 2
    v_bfe_u32 v150, v201, 4, 2
    v_bfe_u32 v151, v201, 6, 2
    v_mul_u32_u24 v148, s29, v148
    v_mul_u32_u24 v149, s29, v149
    v_mul_u32_u24 v150, s29, v150
    v_mul_u32_u24 v151, s29, v151
    v_and_b32 v148, s30, v148
    v_and_b32 v149, s30, v149
    v_and_b32 v150, s30, v150
    v_and_b32 v151, s30, v151
    v_mul_u32_u24 v148, 16256, v148
    v_mul_u32_u24 v149, 16256, v149
    v_mul_u32_u24 v150, 16256, v150
    v_mul_u32_u24 v151, 16256, v151
    v_add_u32 v202, 43, v198
    v_mov_b32 v200, 7
    v_mov_b32_e64 v201, 0
    v_lshlrev_b64 v[200:201], v202, v[200:201]
    v_bfe_u32 v152, v201, 0, 2
    v_bfe_u32 v153, v201, 2, 2
    v_bfe_u32 v154, v201, 4, 2
    v_bfe_u32 v155, v201, 6, 2
    v_mul_u32_u24 v152, s29, v152
    v_mul_u32_u24 v153, s29, v153
    v_mul_u32_u24 v154, s29, v154
    v_mul_u32_u24 v155, s29, v155
    v_and_b32 v152, s30, v152
    v_and_b32 v153, s30, v153
    v_and_b32 v154, s30, v154
    v_and_b32 v155, s30, v155
    v_mul_u32_u24 v152, 16256, v152
    v_mul_u32_u24 v153, 16256, v153
    v_mul_u32_u24 v154, 16256, v154
    v_mul_u32_u24 v155, 16256, v155
    v_add_u32 v202, 36, v198
    v_mov_b32 v200, 511
    v_mov_b32 v201, 0
    v_lshlrev_b64 v[200:201], v202, v[200:201]
    v_bfe_u32 v156, v201, 0, 2
    v_bfe_u32 v157, v201, 2, 2
    v_bfe_u32 v158, v201, 4, 2
    v_bfe_u32 v159, v201, 6, 2
    v_mul_u32_u24 v156, s29, v156
    v_mul_u32_u24 v157, s29, v157
    v_mul_u32_u24 v158, s29, v158
    v_mul_u32_u24 v159, s29, v159
    v_and_b32 v156, s30, v156
    v_and_b32 v157, s30, v157
    v_and_b32 v158, s30, v158
    v_and_b32 v159, s30, v159
    v_mul_u32_u24 v156, 16256, v156
    v_mul_u32_u24 v157, 16256, v157
    v_mul_u32_u24 v158, 16256, v158
    v_mul_u32_u24 v159, 16256, v159
    v_add_u32 v202, 37, v198
    v_mov_b32 v200, 127
    v_mov_b32 v201, 0
    v_lshlrev_b64 v[200:201], v202, v[200:201]
    v_bfe_u32 v160, v201, 0, 2
    v_bfe_u32 v161, v201, 2, 2
    v_bfe_u32 v162, v201, 4, 2
    v_bfe_u32 v163, v201, 6, 2
    v_mul_u32_u24 v160, s29, v160
    v_mul_u32_u24 v161, s29, v161
    v_mul_u32_u24 v162, s29, v162
    v_mul_u32_u24 v163, s29, v163
    v_and_b32 v160, s30, v160
    v_and_b32 v161, s30, v161
    v_and_b32 v162, s30, v162
    v_and_b32 v163, s30, v163
    v_mul_u32_u24 v160, 16256, v160
    v_mul_u32_u24 v161, 16256, v161
    v_mul_u32_u24 v162, 16256, v162
    v_mul_u32_u24 v163, 16256, v163
    v_add_u32 v202, 44, v198
    v_mov_b32 v200, 3
    v_mov_b32_e64 v201, 0
    v_lshlrev_b64 v[200:201], v202, v[200:201]
    v_bfe_u32 v144, v201, 0, 2
    v_bfe_u32 v145, v201, 2, 2
    v_bfe_u32 v146, v201, 4, 2
    v_bfe_u32 v147, v201, 6, 2
    v_mul_u32_u24 v144, s29, v144
    v_mul_u32_u24 v145, s29, v145
    v_mul_u32_u24 v146, s29, v146
    v_mul_u32_u24 v147, s29, v147
    v_and_b32 v144, s30, v144
    v_and_b32 v145, s30, v145
    v_and_b32 v146, s30, v146
    v_and_b32 v147, s30, v147
    v_mul_u32_u24 v144, 65535, v144
    v_mul_u32_u24 v145, 65535, v145
    v_mul_u32_u24 v146, 65535, v146
    v_mul_u32_u24 v147, 65535, v147
    s_mov_b32 s29, 118272
    v_lshl_add_u32 v203, v196, 1, v197
    v_add_u32 v202, 14, v203
    v_bfe_u32 v200, v202, 1, 3
    v_xor_b32 v200, s3, v200
    v_lshl_add_u32 v200, v200, 4, s29
    v_lshl_add_u32 v232, v202, 7, v200
    v_add_u32 v202, 10, v203
    v_bfe_u32 v200, v202, 1, 3
    v_xor_b32 v200, s3, v200
    v_lshl_add_u32 v200, v200, 4, s29
    v_lshl_add_u32 v233, v202, 7, v200
    v_add_u32 v202, 6, v203
    v_bfe_u32 v200, v202, 1, 3
    v_xor_b32 v200, s3, v200
    v_lshl_add_u32 v200, v200, 4, s29
    v_lshl_add_u32 v234, v202, 7, v200
    v_add_u32 v202, 2, v203
    v_bfe_u32 v200, v202, 1, 3
    v_xor_b32 v200, s3, v200
    v_lshl_add_u32 v200, v200, 4, s29
    v_lshl_add_u32 v235, v202, 7, v200
    v_add3_u32 v202, v196, v197, 29
    v_bfe_u32 v200, v202, 1, 3
    v_xor_b32_e64 v200, s3, v200
    v_lshl_add_u32 v200, v200, 4, s29
    v_lshl_add_u32 v236, v202, 7, v200
    v_add_u32 v202, 29, v203
    v_bfe_u32 v200, v202, 1, 3
    v_xor_b32 v200, s3, v200
    v_lshl_add_u32 v200, v200, 4, s29
    v_lshl_add_u32 v237, v202, 7, v200
    v_lshrrev_b32 v203, 1, v197
    v_lshl_add_u32 v202, v196, 1, v203
    v_add_u32 v202, 32, v202
    v_bfe_u32 v200, v202, 1, 3
    v_xor_b32_e64 v200, s3, v200
    v_xor_b32_e64 v200, 4, v200
    v_lshl_add_u32 v200, v200, 4, s29
    v_lshl_add_u32 v238, v202, 7, v200
    v_and_b32_e64 v202, 1, v197
    v_lshl_add_u32 v238, v202, 3, v238
    v_lshrrev_b32_e64 v200, 2, v196
    v_lshl_add_u32 v200, v202, 2, v200
    v_mul_u32_u24 v200, 73728, v200
    s_bfe_u32 s30, s24, 0x20001
    v_and_b32_e64 v201, 3, v196
    v_xor_b32 v201, s30, v201
    v_lshl_add_u32 v200, v201, 5, v200
    v_lshl_add_u32 v239, v203, 4, v200
    s_lshl_b32 s73, s24, 7
    s_add_u32 s73, s73, 6488064
    s_mul_i32 s29, s3, 29568
    v_lshl_add_u32 v128, v2, 4, s29
    s_add_u32 s30, s29, 5500
    v_lshlrev_b32 v200, 2, v2
    v_sub_u32 v129, s30, v200
    s_add_u32 s30, s29, 4990
    v_lshlrev_b32 v200, 1, v2
    v_sub_u32 v130, s30, v200
    v_and_b32 v200, 7, v2
    v_lshrrev_b32 v201, 1, v200
    v_min_u32 v201, 1, v201
    v_lshlrev_b32 v201, 10, v201
    v_bfe_u32 v202, v2, 3, 2
    v_mul_u32_u24 v203, 1216, v202
    v_add_u32 v201, v201, v203
    v_and_b32 v202, 1, v202
    v_mul_u32_u24 v202, 384, v202
    v_add_u32 v202, 5120, v202
    v_cmp_gt_u32 vcc, 32, v2
    s_nop 1
    v_cndmask_b32 v201, v202, v201, vcc
    v_lshl_add_u32 v200, v200, 4, s29
    v_add_u32 v131, v200, v201
    v_and_b32 v197, 48, v2
    v_add_u32 v203, s29, v197
    v_lshlrev_b32 v200, 3, v196
    v_sub_u32 v200, v203, v200
    v_add_u32 v132, 5240, v200
    v_lshlrev_b32 v200, 2, v196
    v_sub_u32 v200, v203, v200
    v_add_u32 v133, 4924, v200
    v_bfe_u32 v200, v2, 2, 2
    v_mul_u32_u24 v200, 1216, v200
    v_and_b32_e64 v201, 3, v2
    v_lshl_add_u32 v200, v201, 3, v200
    v_sub_u32 v200, v200, v197
    v_add3_u32 v134, v200, s29, 56
    v_lshlrev_b32 v243, 4, v2
    v_bfe_u32 v200, v0, 1, 3
    v_lshlrev_b32 v200, 4, v200
    v_lshl_add_u32 v200, v0, 7, v200
    v_add_u32 v244, 122368, v200
    s_waitcnt lgkmcnt(0)
    s_bitcmp1_b32 s3, 1
    s_cselect_b32 s16, s83, s82
    s_lshl_b32 s17, s16, 16
    s_and_b32 s18, s16, 0xffff0000
    s_bitcmp1_b32 s3, 0
    s_cselect_b32 s16, s18, s17
    v_mov_b32 v135, 0
    v_writelane_b32 v135, s16, 0
    s_mov_b32 s17, 0x05040100
    s_mov_b32 s18, 0x07060302
    v_add_u32 v250, 0, v120
    v_add_u32 v251, 0, v121
    v_add_u32 v252, 0, v122
    v_add_u32 v253, 0, v123
    s_mov_b32 s83, 29568
    s_waitcnt vmcnt(4)
    v_lshlrev_b32 v4, 16, v84
    v_and_b32 v5, 0xffff0000, v84
    v_lshlrev_b32_e64 v6, 16, v85
    v_and_b32 v7, 0xffff0000, v85
    v_lshlrev_b32 v8, 16, v86
    v_and_b32 v9, 0xffff0000, v86
    v_lshlrev_b32 v10, 16, v87
    v_and_b32 v11, 0xffff0000, v87
    v_lshlrev_b32 v12, 16, v88
    v_and_b32 v13, 0xffff0000, v88
    v_lshlrev_b32 v14, 16, v89
    v_and_b32 v15, 0xffff0000, v89
    v_lshlrev_b32_e64 v16, 16, v90
    v_mul_f32 v16, 1069066811, v16
    v_exp_f32_e64 v16, v16
    s_mul_i32 s26, s3, 29568
    v_lshl_add_u32 v17, v2, 3, s26
    v_cvt_pk_bf16_f32 v16, v16, v16
    v_and_b32 v16, 0xffff0000, v16
    v_pk_mul_f32 v[4:5], v[4:5], v[16:17] op_sel_hi:[1,0]
    v_pk_mul_f32 v[6:7], v[6:7], v[16:17] op_sel_hi:[1,0]
    v_pk_mul_f32 v[8:9], v[8:9], v[16:17] op_sel_hi:[1,0]
    v_pk_mul_f32 v[10:11], v[10:11], v[16:17] op_sel_hi:[1,0]
    v_mul_f32 v4, 1069066811, v4
    v_mul_f32_e64 v6, 1042479491, v6
    v_mul_f32 v5, 1069066811, v5
    v_mul_f32_e64 v7, 1042479491, v7
    v_mul_f32 v20, 0x41000000, v4
    v_mul_f32 v22, 0x41000000, v6
    v_mul_f32 v21, 0x41000000, v5
    v_mul_f32 v23, 0x41000000, v7
    v_fract_f32 v22, v22
    v_fract_f32 v23, v23
    v_exp_f32 v20, v20
    v_exp_f32 v21, v21
    v_cos_f32 v52, v22
    v_sin_f32 v53, v22
    v_cos_f32 v54, v23
    v_sin_f32 v55, v23
    v_pk_mul_f32 v[52:53], v[52:53], v[20:21] op_sel_hi:[1,0]
    v_pk_mul_f32 v[54:55], v[54:55], v[20:21] op_sel:[0,1] op_sel_hi:[1,1]
    v_fract_f32 v22, v6
    v_fract_f32 v23, v7
    v_exp_f32 v20, v4
    v_exp_f32 v21, v5
    v_cos_f32 v48, v22
    v_sin_f32 v49, v22
    v_cos_f32 v50, v23
    v_sin_f32 v51, v23
    v_pk_mul_f32 v[48:49], v[48:49], v[20:21] op_sel_hi:[1,0]
    v_pk_mul_f32 v[50:51], v[50:51], v[20:21] op_sel:[0,1] op_sel_hi:[1,1]
    v_mul_f32 v20, 0x43800000, v4
    v_mul_f32 v22, 0x43800000, v6
    v_mul_f32 v21, 0x43800000, v5
    v_mul_f32 v23, 0x43800000, v7
    v_fract_f32 v22, v22
    v_fract_f32 v23, v23
    v_exp_f32 v20, v20
    v_exp_f32 v21, v21
    v_cos_f32 v56, v22
    v_sin_f32 v57, v22
    v_cos_f32 v58, v23
    v_sin_f32 v59, v23
    v_pk_mul_f32 v[56:57], v[56:57], v[20:21] op_sel_hi:[1,0]
    v_pk_mul_f32 v[58:59], v[58:59], v[20:21] op_sel:[0,1] op_sel_hi:[1,1]
    v_mul_f32 v112, v12, v8
    v_mul_f32 v113, v12, v10
    v_mul_f32 v114, v13, v9
    v_mul_f32 v115, v13, v11
    v_fma_f32 v112, -v14, v10, v112
    v_fma_f32 v113, v14, v8, v113
    v_fma_f32 v114, -v15, v11, v114
    v_fma_f32 v115, v15, v9, v115
    v_mov_b32 v24, 0x3f80
    v_mov_b32 v25, 0x3f80
    ds_write_b64 v17, v[24:25] offset:0
    v_cvt_pk_bf16_f32 v84, v48, v49
    v_cvt_pk_bf16_f32 v85, v50, v51
    ds_write_b64 v17, v[84:85] offset:528
    v_cvt_pk_bf16_f32 v86, v56, v57
    v_cvt_pk_bf16_f32 v87, v58, v59
    ds_write_b64 v17, v[86:87] offset:2112
    ds_write_b64 v17, v[86:87] offset:2640
    v_pk_mul_f32 v[116:117], v[112:113], v[52:53] op_sel_hi:[1,0]
    v_pk_mul_f32 v[118:119], v[114:115], v[54:55] op_sel_hi:[1,0]
    v_cvt_pk_bf16_f32 v88, v112, -v113
    v_cvt_pk_bf16_f32 v89, v114, -v115
    v_pk_fma_f32 v[116:117], v[112:113], v[52:53], v[116:117] op_sel:[1,1,0] op_sel_hi:[0,1,1] neg_lo:[1,0,0]
    v_pk_fma_f32 v[118:119], v[114:115], v[54:55], v[118:119] op_sel:[1,1,0] op_sel_hi:[0,1,1] neg_lo:[1,0,0]
    ds_write_b64 v17, v[88:89] offset:12672
    v_pk_mul_f32 v[60:61], v[48:49], v[48:49] op_sel_hi:[1,0]
    v_pk_mul_f32 v[62:63], v[50:51], v[50:51] op_sel_hi:[1,0]
    v_pk_fma_f32 v[60:61], v[48:49], v[48:49], v[60:61] op_sel:[1,1,0] op_sel_hi:[0,1,1] neg_lo:[1,0,0]
    v_pk_fma_f32 v[62:63], v[50:51], v[50:51], v[62:63] op_sel:[1,1,0] op_sel_hi:[0,1,1] neg_lo:[1,0,0]
    v_cvt_pk_bf16_f32 v90, v60, v61
    v_cvt_pk_bf16_f32 v91, v62, v63
    ds_write_b64 v17, v[90:91] offset:1056
    v_pk_mul_f32 v[112:113], v[116:117], v[52:53] op_sel_hi:[1,0]
    v_pk_mul_f32 v[114:115], v[118:119], v[54:55] op_sel_hi:[1,0]
    v_cvt_pk_bf16_f32 v84, v116, -v117
    v_cvt_pk_bf16_f32 v85, v118, -v119
    v_pk_fma_f32 v[112:113], v[116:117], v[52:53], v[112:113] op_sel:[1,1,0] op_sel_hi:[0,1,1] neg_lo:[1,0,0]
    v_pk_fma_f32 v[114:115], v[118:119], v[54:55], v[114:115] op_sel:[1,1,0] op_sel_hi:[0,1,1] neg_lo:[1,0,0]
    ds_write_b64 v17, v[84:85] offset:13200
    v_pk_mul_f32 v[104:105], v[56:57], v[52:53] op_sel_hi:[1,0]
    v_pk_mul_f32 v[106:107], v[58:59], v[54:55] op_sel_hi:[1,0]
    v_pk_fma_f32 v[104:105], v[56:57], v[52:53], v[104:105] op_sel:[1,1,0] op_sel_hi:[0,1,1] neg_lo:[1,0,0]
    v_pk_fma_f32 v[106:107], v[58:59], v[54:55], v[106:107] op_sel:[1,1,0] op_sel_hi:[0,1,1] neg_lo:[1,0,0]
    v_cvt_pk_bf16_f32 v86, v104, v105
    v_cvt_pk_bf16_f32 v87, v106, v107
    ds_write_b64 v17, v[86:87] offset:7920
    v_pk_mul_f32 v[116:117], v[112:113], v[52:53] op_sel_hi:[1,0]
    v_pk_mul_f32 v[118:119], v[114:115], v[54:55] op_sel_hi:[1,0]
    v_cvt_pk_bf16_f32 v88, v112, -v113
    v_cvt_pk_bf16_f32 v89, v114, -v115
    v_pk_fma_f32 v[116:117], v[112:113], v[52:53], v[116:117] op_sel:[1,1,0] op_sel_hi:[0,1,1] neg_lo:[1,0,0]
    v_pk_fma_f32 v[118:119], v[114:115], v[54:55], v[118:119] op_sel:[1,1,0] op_sel_hi:[0,1,1] neg_lo:[1,0,0]
    ds_write_b64 v17, v[88:89] offset:13728
    v_pk_mul_f32 v[64:65], v[60:61], v[48:49] op_sel_hi:[1,0]
    v_pk_mul_f32 v[66:67], v[62:63], v[50:51] op_sel_hi:[1,0]
    v_pk_fma_f32 v[64:65], v[60:61], v[48:49], v[64:65] op_sel:[1,1,0] op_sel_hi:[0,1,1] neg_lo:[1,0,0]
    v_pk_fma_f32 v[66:67], v[62:63], v[50:51], v[66:67] op_sel:[1,1,0] op_sel_hi:[0,1,1] neg_lo:[1,0,0]
    v_cvt_pk_bf16_f32 v90, v64, v65
    v_cvt_pk_bf16_f32 v91, v66, v67
    ds_write_b64 v17, v[90:91] offset:1584
    v_pk_mul_f32 v[112:113], v[116:117], v[52:53] op_sel_hi:[1,0]
    v_pk_mul_f32 v[114:115], v[118:119], v[54:55] op_sel_hi:[1,0]
    v_cvt_pk_bf16_f32 v84, v116, -v117
    v_cvt_pk_bf16_f32 v85, v118, -v119
    v_pk_fma_f32 v[112:113], v[116:117], v[52:53], v[112:113] op_sel:[1,1,0] op_sel_hi:[0,1,1] neg_lo:[1,0,0]
    v_pk_fma_f32 v[114:115], v[118:119], v[54:55], v[114:115] op_sel:[1,1,0] op_sel_hi:[0,1,1] neg_lo:[1,0,0]
    ds_write_b64 v17, v[84:85] offset:14256
    v_pk_mul_f32 v[68:69], v[60:61], v[60:61] op_sel_hi:[1,0]
    v_pk_mul_f32 v[70:71], v[62:63], v[62:63] op_sel_hi:[1,0]
    v_pk_fma_f32 v[68:69], v[60:61], v[60:61], v[68:69] op_sel:[1,1,0] op_sel_hi:[0,1,1] neg_lo:[1,0,0]
    v_pk_fma_f32 v[70:71], v[62:63], v[62:63], v[70:71] op_sel:[1,1,0] op_sel_hi:[0,1,1] neg_lo:[1,0,0]
    v_cvt_pk_bf16_f32 v86, v68, v69
    v_cvt_pk_bf16_f32 v87, v70, v71
    ds_write_b64 v17, v[86:87] offset:4224
    v_pk_mul_f32 v[116:117], v[112:113], v[52:53] op_sel_hi:[1,0]
    v_pk_mul_f32 v[118:119], v[114:115], v[54:55] op_sel_hi:[1,0]
    v_cvt_pk_bf16_f32 v88, v112, -v113
    v_cvt_pk_bf16_f32 v89, v114, -v115
    v_pk_fma_f32 v[116:117], v[112:113], v[52:53], v[116:117] op_sel:[1,1,0] op_sel_hi:[0,1,1] neg_lo:[1,0,0]
    v_pk_fma_f32 v[118:119], v[114:115], v[54:55], v[118:119] op_sel:[1,1,0] op_sel_hi:[0,1,1] neg_lo:[1,0,0]
    ds_write_b64 v17, v[88:89] offset:14784
    v_pk_mul_f32 v[108:109], v[104:105], v[56:57] op_sel_hi:[1,0]
    v_pk_mul_f32 v[110:111], v[106:107], v[58:59] op_sel_hi:[1,0]
    v_pk_fma_f32 v[108:109], v[104:105], v[56:57], v[108:109] op_sel:[1,1,0] op_sel_hi:[0,1,1] neg_lo:[1,0,0]
    v_pk_fma_f32 v[110:111], v[106:107], v[58:59], v[110:111] op_sel:[1,1,0] op_sel_hi:[0,1,1] neg_lo:[1,0,0]
    v_cvt_pk_bf16_f32 v90, v108, v109
    v_cvt_pk_bf16_f32 v91, v110, v111
    ds_write_b64 v17, v[90:91] offset:8448
    v_pk_mul_f32 v[112:113], v[116:117], v[52:53] op_sel_hi:[1,0]
    v_pk_mul_f32 v[114:115], v[118:119], v[54:55] op_sel_hi:[1,0]
    v_cvt_pk_bf16_f32 v84, v116, -v117
    v_cvt_pk_bf16_f32 v85, v118, -v119
    v_pk_fma_f32 v[112:113], v[116:117], v[52:53], v[112:113] op_sel:[1,1,0] op_sel_hi:[0,1,1] neg_lo:[1,0,0]
    v_pk_fma_f32 v[114:115], v[118:119], v[54:55], v[114:115] op_sel:[1,1,0] op_sel_hi:[0,1,1] neg_lo:[1,0,0]
    ds_write_b64 v17, v[84:85] offset:15312
    v_pk_mul_f32 v[76:77], v[56:57], v[60:61] op_sel_hi:[1,0]
    v_pk_mul_f32 v[78:79], v[58:59], v[62:63] op_sel_hi:[1,0]
    v_pk_fma_f32 v[76:77], v[56:57], v[60:61], v[76:77] op_sel:[1,1,0] op_sel_hi:[0,1,1] neg_lo:[1,0,0]
    v_pk_fma_f32 v[78:79], v[58:59], v[62:63], v[78:79] op_sel:[1,1,0] op_sel_hi:[0,1,1] neg_lo:[1,0,0]
    v_cvt_pk_bf16_f32 v86, v76, v77
    v_cvt_pk_bf16_f32 v87, v78, v79
    ds_write_b64 v17, v[86:87] offset:3168
    buffer_load_dwordx2 v[172:173], v136, s[12:15], s71 offen offset:0
    v_pk_mul_f32 v[116:117], v[112:113], v[52:53] op_sel_hi:[1,0]
    v_pk_mul_f32 v[118:119], v[114:115], v[54:55] op_sel_hi:[1,0]
    v_cvt_pk_bf16_f32 v88, v112, -v113
    v_cvt_pk_bf16_f32 v89, v114, -v115
    v_pk_fma_f32 v[116:117], v[112:113], v[52:53], v[116:117] op_sel:[1,1,0] op_sel_hi:[0,1,1] neg_lo:[1,0,0]
    v_pk_fma_f32 v[118:119], v[114:115], v[54:55], v[118:119] op_sel:[1,1,0] op_sel_hi:[0,1,1] neg_lo:[1,0,0]
    ds_write_b64 v17, v[88:89] offset:15840
    v_pk_mul_f32 v[100:101], v[68:69], v[48:49] op_sel_hi:[1,0]
    v_pk_mul_f32 v[102:103], v[70:71], v[50:51] op_sel_hi:[1,0]
    v_pk_fma_f32 v[100:101], v[68:69], v[48:49], v[100:101] op_sel:[1,1,0] op_sel_hi:[0,1,1] neg_lo:[1,0,0]
    v_pk_fma_f32 v[102:103], v[70:71], v[50:51], v[102:103] op_sel:[1,1,0] op_sel_hi:[0,1,1] neg_lo:[1,0,0]
    v_cvt_pk_bf16_f32 v90, v100, v101
    v_cvt_pk_bf16_f32 v91, v102, v103
    ds_write_b64 v17, v[90:91] offset:4752
    v_pk_mul_f32 v[112:113], v[116:117], v[52:53] op_sel_hi:[1,0]
    v_pk_mul_f32 v[114:115], v[118:119], v[54:55] op_sel_hi:[1,0]
    v_cvt_pk_bf16_f32 v84, v116, -v117
    v_cvt_pk_bf16_f32 v85, v118, -v119
    v_pk_fma_f32 v[112:113], v[116:117], v[52:53], v[112:113] op_sel:[1,1,0] op_sel_hi:[0,1,1] neg_lo:[1,0,0]
    v_pk_fma_f32 v[114:115], v[118:119], v[54:55], v[114:115] op_sel:[1,1,0] op_sel_hi:[0,1,1] neg_lo:[1,0,0]
    ds_write_b64 v17, v[84:85] offset:16368
    v_pk_mul_f32 v[104:105], v[108:109], v[56:57] op_sel_hi:[1,0]
    v_pk_mul_f32 v[106:107], v[110:111], v[58:59] op_sel_hi:[1,0]
    v_pk_fma_f32 v[104:105], v[108:109], v[56:57], v[104:105] op_sel:[1,1,0] op_sel_hi:[0,1,1] neg_lo:[1,0,0]
    v_pk_fma_f32 v[106:107], v[110:111], v[58:59], v[106:107] op_sel:[1,1,0] op_sel_hi:[0,1,1] neg_lo:[1,0,0]
    v_cvt_pk_bf16_f32 v86, v104, v105
    v_cvt_pk_bf16_f32 v87, v106, v107
    ds_write_b64 v17, v[86:87] offset:10560
    v_pk_mul_f32 v[116:117], v[112:113], v[52:53] op_sel_hi:[1,0]
    v_pk_mul_f32 v[118:119], v[114:115], v[54:55] op_sel_hi:[1,0]
    v_cvt_pk_bf16_f32 v88, v112, -v113
    v_cvt_pk_bf16_f32 v89, v114, -v115
    v_pk_fma_f32 v[116:117], v[112:113], v[52:53], v[116:117] op_sel:[1,1,0] op_sel_hi:[0,1,1] neg_lo:[1,0,0]
    v_pk_fma_f32 v[118:119], v[114:115], v[54:55], v[118:119] op_sel:[1,1,0] op_sel_hi:[0,1,1] neg_lo:[1,0,0]
    ds_write_b64 v17, v[88:89] offset:16896
    v_pk_mul_f32 v[72:73], v[68:69], v[60:61] op_sel_hi:[1,0]
    v_pk_mul_f32 v[74:75], v[70:71], v[62:63] op_sel_hi:[1,0]
    v_pk_fma_f32 v[72:73], v[68:69], v[60:61], v[72:73] op_sel:[1,1,0] op_sel_hi:[0,1,1] neg_lo:[1,0,0]
    v_pk_fma_f32 v[74:75], v[70:71], v[62:63], v[74:75] op_sel:[1,1,0] op_sel_hi:[0,1,1] neg_lo:[1,0,0]
    v_cvt_pk_bf16_f32 v90, v72, v73
    v_cvt_pk_bf16_f32 v91, v74, v75
    ds_write_b64 v17, v[90:91] offset:5280
    v_pk_mul_f32 v[112:113], v[116:117], v[52:53] op_sel_hi:[1,0]
    v_pk_mul_f32 v[114:115], v[118:119], v[54:55] op_sel_hi:[1,0]
    v_cvt_pk_bf16_f32 v84, v116, -v117
    v_cvt_pk_bf16_f32 v85, v118, -v119
    v_pk_fma_f32 v[112:113], v[116:117], v[52:53], v[112:113] op_sel:[1,1,0] op_sel_hi:[0,1,1] neg_lo:[1,0,0]
    v_pk_fma_f32 v[114:115], v[118:119], v[54:55], v[114:115] op_sel:[1,1,0] op_sel_hi:[0,1,1] neg_lo:[1,0,0]
    ds_write_b64 v17, v[84:85] offset:17424
    v_pk_mul_f32 v[76:77], v[68:69], v[64:65] op_sel_hi:[1,0]
    v_pk_mul_f32 v[78:79], v[70:71], v[66:67] op_sel_hi:[1,0]
    v_pk_fma_f32 v[76:77], v[68:69], v[64:65], v[76:77] op_sel:[1,1,0] op_sel_hi:[0,1,1] neg_lo:[1,0,0]
    v_pk_fma_f32 v[78:79], v[70:71], v[66:67], v[78:79] op_sel:[1,1,0] op_sel_hi:[0,1,1] neg_lo:[1,0,0]
    v_cvt_pk_bf16_f32 v86, v76, v77
    v_cvt_pk_bf16_f32 v87, v78, v79
    ds_write_b64 v17, v[86:87] offset:5808
    v_pk_mul_f32 v[116:117], v[112:113], v[52:53] op_sel_hi:[1,0]
    v_pk_mul_f32 v[118:119], v[114:115], v[54:55] op_sel_hi:[1,0]
    v_cvt_pk_bf16_f32 v88, v112, -v113
    v_cvt_pk_bf16_f32 v89, v114, -v115
    v_pk_fma_f32 v[116:117], v[112:113], v[52:53], v[116:117] op_sel:[1,1,0] op_sel_hi:[0,1,1] neg_lo:[1,0,0]
    v_pk_fma_f32 v[118:119], v[114:115], v[54:55], v[118:119] op_sel:[1,1,0] op_sel_hi:[0,1,1] neg_lo:[1,0,0]
    ds_write_b64 v17, v[88:89] offset:17952
    v_pk_mul_f32 v[108:109], v[104:105], v[56:57] op_sel_hi:[1,0]
    v_pk_mul_f32 v[110:111], v[106:107], v[58:59] op_sel_hi:[1,0]
    v_pk_fma_f32 v[108:109], v[104:105], v[56:57], v[108:109] op_sel:[1,1,0] op_sel_hi:[0,1,1] neg_lo:[1,0,0]
    v_pk_fma_f32 v[110:111], v[106:107], v[58:59], v[110:111] op_sel:[1,1,0] op_sel_hi:[0,1,1] neg_lo:[1,0,0]
    v_cvt_pk_bf16_f32 v90, v108, v109
    v_cvt_pk_bf16_f32 v91, v110, v111
    ds_write_b64 v17, v[90:91] offset:9504
    v_pk_mul_f32 v[112:113], v[116:117], v[52:53] op_sel_hi:[1,0]
    v_pk_mul_f32 v[114:115], v[118:119], v[54:55] op_sel_hi:[1,0]
    v_cvt_pk_bf16_f32 v84, v116, -v117
    v_cvt_pk_bf16_f32 v85, v118, -v119
    v_pk_fma_f32 v[112:113], v[116:117], v[52:53], v[112:113] op_sel:[1,1,0] op_sel_hi:[0,1,1] neg_lo:[1,0,0]
    v_pk_fma_f32 v[114:115], v[118:119], v[54:55], v[114:115] op_sel:[1,1,0] op_sel_hi:[0,1,1] neg_lo:[1,0,0]
    ds_write_b64 v17, v[84:85] offset:18480
    v_pk_mul_f32 v[100:101], v[56:57], v[68:69] op_sel_hi:[1,0]
    v_pk_mul_f32 v[102:103], v[58:59], v[70:71] op_sel_hi:[1,0]
    v_pk_fma_f32 v[100:101], v[56:57], v[68:69], v[100:101] op_sel:[1,1,0] op_sel_hi:[0,1,1] neg_lo:[1,0,0]
    v_pk_fma_f32 v[102:103], v[58:59], v[70:71], v[102:103] op_sel:[1,1,0] op_sel_hi:[0,1,1] neg_lo:[1,0,0]
    v_cvt_pk_bf16_f32 v86, v100, v101
    v_cvt_pk_bf16_f32 v87, v102, v103
    ds_write_b64 v17, v[86:87] offset:3696
    ds_write_b64 v17, v[86:87] offset:6336
    ds_write_b64 v17, v[86:87] offset:6864
    v_pk_mul_f32 v[116:117], v[112:113], v[52:53] op_sel_hi:[1,0]
    v_pk_mul_f32 v[118:119], v[114:115], v[54:55] op_sel_hi:[1,0]
    v_cvt_pk_bf16_f32 v88, v112, -v113
    v_cvt_pk_bf16_f32 v89, v114, -v115
    v_pk_fma_f32 v[116:117], v[112:113], v[52:53], v[116:117] op_sel:[1,1,0] op_sel_hi:[0,1,1] neg_lo:[1,0,0]
    v_pk_fma_f32 v[118:119], v[114:115], v[54:55], v[118:119] op_sel:[1,1,0] op_sel_hi:[0,1,1] neg_lo:[1,0,0]
    ds_write_b64 v17, v[88:89] offset:19008
    v_pk_mul_f32 v[76:77], v[56:57], v[72:73] op_sel_hi:[1,0]
    v_pk_mul_f32 v[78:79], v[58:59], v[74:75] op_sel_hi:[1,0]
    v_pk_fma_f32 v[76:77], v[56:57], v[72:73], v[76:77] op_sel:[1,1,0] op_sel_hi:[0,1,1] neg_lo:[1,0,0]
    v_pk_fma_f32 v[78:79], v[58:59], v[74:75], v[78:79] op_sel:[1,1,0] op_sel_hi:[0,1,1] neg_lo:[1,0,0]
    v_cvt_pk_bf16_f32 v90, v76, v77
    v_cvt_pk_bf16_f32 v91, v78, v79
    ds_write_b64 v17, v[90:91] offset:7392
    v_pk_mul_f32 v[112:113], v[116:117], v[52:53] op_sel_hi:[1,0]
    v_pk_mul_f32 v[114:115], v[118:119], v[54:55] op_sel_hi:[1,0]
    v_cvt_pk_bf16_f32 v84, v116, -v117
    v_cvt_pk_bf16_f32 v85, v118, -v119
    v_pk_fma_f32 v[112:113], v[116:117], v[52:53], v[112:113] op_sel:[1,1,0] op_sel_hi:[0,1,1] neg_lo:[1,0,0]
    v_pk_fma_f32 v[114:115], v[118:119], v[54:55], v[114:115] op_sel:[1,1,0] op_sel_hi:[0,1,1] neg_lo:[1,0,0]
    ds_write_b64 v17, v[84:85] offset:19536
    v_pk_mul_f32 v[104:105], v[108:109], v[56:57] op_sel_hi:[1,0]
    v_pk_mul_f32 v[106:107], v[110:111], v[58:59] op_sel_hi:[1,0]
    v_pk_fma_f32 v[104:105], v[108:109], v[56:57], v[104:105] op_sel:[1,1,0] op_sel_hi:[0,1,1] neg_lo:[1,0,0]
    v_pk_fma_f32 v[106:107], v[110:111], v[58:59], v[106:107] op_sel:[1,1,0] op_sel_hi:[0,1,1] neg_lo:[1,0,0]
    v_cvt_pk_bf16_f32 v86, v104, v105
    v_cvt_pk_bf16_f32 v87, v106, v107
    ds_write_b64 v17, v[86:87] offset:11616
    buffer_load_dwordx2 v[174:175], v136, s[12:15], s71 offen offset:1152
    v_pk_mul_f32 v[116:117], v[112:113], v[52:53] op_sel_hi:[1,0]
    v_pk_mul_f32 v[118:119], v[114:115], v[54:55] op_sel_hi:[1,0]
    v_cvt_pk_bf16_f32 v88, v112, -v113
    v_cvt_pk_bf16_f32 v89, v114, -v115
    v_pk_fma_f32 v[116:117], v[112:113], v[52:53], v[116:117] op_sel:[1,1,0] op_sel_hi:[0,1,1] neg_lo:[1,0,0]
    v_pk_fma_f32 v[118:119], v[114:115], v[54:55], v[118:119] op_sel:[1,1,0] op_sel_hi:[0,1,1] neg_lo:[1,0,0]
    ds_write_b64 v17, v[88:89] offset:20064
    v_pk_mul_f32 v[64:65], v[100:101], v[56:57] op_sel_hi:[1,0]
    v_pk_mul_f32 v[66:67], v[102:103], v[58:59] op_sel_hi:[1,0]
    v_pk_fma_f32 v[64:65], v[100:101], v[56:57], v[64:65] op_sel:[1,1,0] op_sel_hi:[0,1,1] neg_lo:[1,0,0]
    v_pk_fma_f32 v[66:67], v[102:103], v[58:59], v[66:67] op_sel:[1,1,0] op_sel_hi:[0,1,1] neg_lo:[1,0,0]
    v_cvt_pk_bf16_f32 v90, v64, v65
    v_cvt_pk_bf16_f32 v91, v66, v67
    ds_write_b64 v17, v[90:91] offset:8976
    v_pk_mul_f32 v[112:113], v[116:117], v[52:53] op_sel_hi:[1,0]
    v_pk_mul_f32 v[114:115], v[118:119], v[54:55] op_sel_hi:[1,0]
    v_cvt_pk_bf16_f32 v84, v116, -v117
    v_cvt_pk_bf16_f32 v85, v118, -v119
    v_pk_fma_f32 v[112:113], v[116:117], v[52:53], v[112:113] op_sel:[1,1,0] op_sel_hi:[0,1,1] neg_lo:[1,0,0]
    v_pk_fma_f32 v[114:115], v[118:119], v[54:55], v[114:115] op_sel:[1,1,0] op_sel_hi:[0,1,1] neg_lo:[1,0,0]
    ds_write_b64 v17, v[84:85] offset:20592
    v_pk_mul_f32 v[108:109], v[104:105], v[56:57] op_sel_hi:[1,0]
    v_pk_mul_f32 v[110:111], v[106:107], v[58:59] op_sel_hi:[1,0]
    v_pk_fma_f32 v[108:109], v[104:105], v[56:57], v[108:109] op_sel:[1,1,0] op_sel_hi:[0,1,1] neg_lo:[1,0,0]
    v_pk_fma_f32 v[110:111], v[106:107], v[58:59], v[110:111] op_sel:[1,1,0] op_sel_hi:[0,1,1] neg_lo:[1,0,0]
    v_cvt_pk_bf16_f32 v86, v108, v109
    v_cvt_pk_bf16_f32 v87, v110, v111
    ds_write_b64 v17, v[86:87] offset:10032
    v_pk_mul_f32 v[116:117], v[112:113], v[52:53] op_sel_hi:[1,0]
    v_pk_mul_f32 v[118:119], v[114:115], v[54:55] op_sel_hi:[1,0]
    v_cvt_pk_bf16_f32 v88, v112, -v113
    v_cvt_pk_bf16_f32 v89, v114, -v115
    v_pk_fma_f32 v[116:117], v[112:113], v[52:53], v[116:117] op_sel:[1,1,0] op_sel_hi:[0,1,1] neg_lo:[1,0,0]
    v_pk_fma_f32 v[118:119], v[114:115], v[54:55], v[118:119] op_sel:[1,1,0] op_sel_hi:[0,1,1] neg_lo:[1,0,0]
    ds_write_b64 v17, v[88:89] offset:21120
    v_pk_mul_f32 v[76:77], v[64:65], v[56:57] op_sel_hi:[1,0]
    v_pk_mul_f32 v[78:79], v[66:67], v[58:59] op_sel_hi:[1,0]
    v_pk_fma_f32 v[76:77], v[64:65], v[56:57], v[76:77] op_sel:[1,1,0] op_sel_hi:[0,1,1] neg_lo:[1,0,0]
    v_pk_fma_f32 v[78:79], v[66:67], v[58:59], v[78:79] op_sel:[1,1,0] op_sel_hi:[0,1,1] neg_lo:[1,0,0]
    v_cvt_pk_bf16_f32 v90, v76, v77
    v_cvt_pk_bf16_f32 v91, v78, v79
    ds_write_b64 v17, v[90:91] offset:11088
    v_pk_mul_f32 v[112:113], v[116:117], v[52:53] op_sel_hi:[1,0]
    v_pk_mul_f32 v[114:115], v[118:119], v[54:55] op_sel_hi:[1,0]
    v_cvt_pk_bf16_f32 v84, v116, -v117
    v_cvt_pk_bf16_f32 v85, v118, -v119
    v_pk_fma_f32 v[112:113], v[116:117], v[52:53], v[112:113] op_sel:[1,1,0] op_sel_hi:[0,1,1] neg_lo:[1,0,0]
    v_pk_fma_f32 v[114:115], v[118:119], v[54:55], v[114:115] op_sel:[1,1,0] op_sel_hi:[0,1,1] neg_lo:[1,0,0]
    ds_write_b64 v17, v[84:85] offset:21648
    v_pk_mul_f32 v[104:105], v[108:109], v[56:57] op_sel_hi:[1,0]
    v_pk_mul_f32 v[106:107], v[110:111], v[58:59] op_sel_hi:[1,0]
    v_pk_fma_f32 v[104:105], v[108:109], v[56:57], v[104:105] op_sel:[1,1,0] op_sel_hi:[0,1,1] neg_lo:[1,0,0]
    v_pk_fma_f32 v[106:107], v[110:111], v[58:59], v[106:107] op_sel:[1,1,0] op_sel_hi:[0,1,1] neg_lo:[1,0,0]
    v_cvt_pk_bf16_f32 v86, v104, v105
    v_cvt_pk_bf16_f32 v87, v106, v107
    ds_write_b64 v17, v[86:87] offset:12144
    v_pk_mul_f32 v[116:117], v[112:113], v[52:53] op_sel_hi:[1,0]
    v_pk_mul_f32 v[118:119], v[114:115], v[54:55] op_sel_hi:[1,0]
    v_cvt_pk_bf16_f32 v88, v112, -v113
    v_cvt_pk_bf16_f32 v89, v114, -v115
    v_pk_fma_f32 v[116:117], v[112:113], v[52:53], v[116:117] op_sel:[1,1,0] op_sel_hi:[0,1,1] neg_lo:[1,0,0]
    v_pk_fma_f32 v[118:119], v[114:115], v[54:55], v[118:119] op_sel:[1,1,0] op_sel_hi:[0,1,1] neg_lo:[1,0,0]
    ds_write_b64 v17, v[88:89] offset:22176
    v_pk_mul_f32 v[112:113], v[116:117], v[52:53] op_sel_hi:[1,0]
    v_pk_mul_f32 v[114:115], v[118:119], v[54:55] op_sel_hi:[1,0]
    v_cvt_pk_bf16_f32 v90, v116, -v117
    v_cvt_pk_bf16_f32 v91, v118, -v119
    v_pk_fma_f32 v[112:113], v[116:117], v[52:53], v[112:113] op_sel:[1,1,0] op_sel_hi:[0,1,1] neg_lo:[1,0,0]
    v_pk_fma_f32 v[114:115], v[118:119], v[54:55], v[114:115] op_sel:[1,1,0] op_sel_hi:[0,1,1] neg_lo:[1,0,0]
    ds_write_b64 v17, v[90:91] offset:22704
    v_pk_mul_f32 v[116:117], v[112:113], v[52:53] op_sel_hi:[1,0]
    v_pk_mul_f32 v[118:119], v[114:115], v[54:55] op_sel_hi:[1,0]
    v_cvt_pk_bf16_f32 v84, v112, -v113
    v_cvt_pk_bf16_f32 v85, v114, -v115
    v_pk_fma_f32 v[116:117], v[112:113], v[52:53], v[116:117] op_sel:[1,1,0] op_sel_hi:[0,1,1] neg_lo:[1,0,0]
    v_pk_fma_f32 v[118:119], v[114:115], v[54:55], v[118:119] op_sel:[1,1,0] op_sel_hi:[0,1,1] neg_lo:[1,0,0]
    ds_write_b64 v17, v[84:85] offset:23232
    v_pk_mul_f32 v[112:113], v[116:117], v[52:53] op_sel_hi:[1,0]
    v_pk_mul_f32 v[114:115], v[118:119], v[54:55] op_sel_hi:[1,0]
    v_cvt_pk_bf16_f32 v86, v116, -v117
    v_cvt_pk_bf16_f32 v87, v118, -v119
    v_pk_fma_f32 v[112:113], v[116:117], v[52:53], v[112:113] op_sel:[1,1,0] op_sel_hi:[0,1,1] neg_lo:[1,0,0]
    v_pk_fma_f32 v[114:115], v[118:119], v[54:55], v[114:115] op_sel:[1,1,0] op_sel_hi:[0,1,1] neg_lo:[1,0,0]
    ds_write_b64 v17, v[86:87] offset:23760
    buffer_load_dwordx2 v[176:177], v136, s[12:15], s71 offen offset:2304
    v_pk_mul_f32 v[116:117], v[112:113], v[52:53] op_sel_hi:[1,0]
    v_pk_mul_f32 v[118:119], v[114:115], v[54:55] op_sel_hi:[1,0]
    v_cvt_pk_bf16_f32 v88, v112, -v113
    v_cvt_pk_bf16_f32 v89, v114, -v115
    v_pk_fma_f32 v[116:117], v[112:113], v[52:53], v[116:117] op_sel:[1,1,0] op_sel_hi:[0,1,1] neg_lo:[1,0,0]
    v_pk_fma_f32 v[118:119], v[114:115], v[54:55], v[118:119] op_sel:[1,1,0] op_sel_hi:[0,1,1] neg_lo:[1,0,0]
    ds_write_b64 v17, v[88:89] offset:24288
    v_pk_mul_f32 v[112:113], v[116:117], v[52:53] op_sel_hi:[1,0]
    v_pk_mul_f32 v[114:115], v[118:119], v[54:55] op_sel_hi:[1,0]
    v_cvt_pk_bf16_f32 v90, v116, -v117
    v_cvt_pk_bf16_f32 v91, v118, -v119
    v_pk_fma_f32 v[112:113], v[116:117], v[52:53], v[112:113] op_sel:[1,1,0] op_sel_hi:[0,1,1] neg_lo:[1,0,0]
    v_pk_fma_f32 v[114:115], v[118:119], v[54:55], v[114:115] op_sel:[1,1,0] op_sel_hi:[0,1,1] neg_lo:[1,0,0]
    ds_write_b64 v17, v[90:91] offset:24816
    v_pk_mul_f32 v[116:117], v[112:113], v[52:53] op_sel_hi:[1,0]
    v_pk_mul_f32 v[118:119], v[114:115], v[54:55] op_sel_hi:[1,0]
    v_cvt_pk_bf16_f32 v84, v112, -v113
    v_cvt_pk_bf16_f32 v85, v114, -v115
    v_pk_fma_f32 v[116:117], v[112:113], v[52:53], v[116:117] op_sel:[1,1,0] op_sel_hi:[0,1,1] neg_lo:[1,0,0]
    v_pk_fma_f32 v[118:119], v[114:115], v[54:55], v[118:119] op_sel:[1,1,0] op_sel_hi:[0,1,1] neg_lo:[1,0,0]
    ds_write_b64 v17, v[84:85] offset:25344
    v_pk_mul_f32 v[112:113], v[116:117], v[52:53] op_sel_hi:[1,0]
    v_pk_mul_f32 v[114:115], v[118:119], v[54:55] op_sel_hi:[1,0]
    v_cvt_pk_bf16_f32 v86, v116, -v117
    v_cvt_pk_bf16_f32 v87, v118, -v119
    v_pk_fma_f32 v[112:113], v[116:117], v[52:53], v[112:113] op_sel:[1,1,0] op_sel_hi:[0,1,1] neg_lo:[1,0,0]
    v_pk_fma_f32 v[114:115], v[118:119], v[54:55], v[114:115] op_sel:[1,1,0] op_sel_hi:[0,1,1] neg_lo:[1,0,0]
    ds_write_b64 v17, v[86:87] offset:25872
    s_load_dword s80, s[58:59], 0
    v_pk_mul_f32 v[116:117], v[112:113], v[52:53] op_sel_hi:[1,0]
    v_pk_mul_f32 v[118:119], v[114:115], v[54:55] op_sel_hi:[1,0]
    v_cvt_pk_bf16_f32 v88, v112, -v113
    v_cvt_pk_bf16_f32 v89, v114, -v115
    v_pk_fma_f32 v[116:117], v[112:113], v[52:53], v[116:117] op_sel:[1,1,0] op_sel_hi:[0,1,1] neg_lo:[1,0,0]
    v_pk_fma_f32 v[118:119], v[114:115], v[54:55], v[118:119] op_sel:[1,1,0] op_sel_hi:[0,1,1] neg_lo:[1,0,0]
    ds_write_b64 v17, v[88:89] offset:26400
    v_pk_mul_f32 v[112:113], v[116:117], v[52:53] op_sel_hi:[1,0]
    v_pk_mul_f32 v[114:115], v[118:119], v[54:55] op_sel_hi:[1,0]
    v_cvt_pk_bf16_f32 v90, v116, -v117
    v_cvt_pk_bf16_f32 v91, v118, -v119
    v_pk_fma_f32 v[112:113], v[116:117], v[52:53], v[112:113] op_sel:[1,1,0] op_sel_hi:[0,1,1] neg_lo:[1,0,0]
    v_pk_fma_f32 v[114:115], v[118:119], v[54:55], v[114:115] op_sel:[1,1,0] op_sel_hi:[0,1,1] neg_lo:[1,0,0]
    ds_write_b64 v17, v[90:91] offset:26928
    v_pk_mul_f32 v[116:117], v[112:113], v[52:53] op_sel_hi:[1,0]
    v_pk_mul_f32 v[118:119], v[114:115], v[54:55] op_sel_hi:[1,0]
    v_cvt_pk_bf16_f32 v84, v112, -v113
    v_cvt_pk_bf16_f32 v85, v114, -v115
    v_pk_fma_f32 v[116:117], v[112:113], v[52:53], v[116:117] op_sel:[1,1,0] op_sel_hi:[0,1,1] neg_lo:[1,0,0]
    v_pk_fma_f32 v[118:119], v[114:115], v[54:55], v[118:119] op_sel:[1,1,0] op_sel_hi:[0,1,1] neg_lo:[1,0,0]
    ds_write_b64 v17, v[84:85] offset:27456
    v_pk_mul_f32 v[112:113], v[116:117], v[52:53] op_sel_hi:[1,0]
    v_pk_mul_f32 v[114:115], v[118:119], v[54:55] op_sel_hi:[1,0]
    v_cvt_pk_bf16_f32 v86, v116, -v117
    v_cvt_pk_bf16_f32 v87, v118, -v119
    v_pk_fma_f32 v[112:113], v[116:117], v[52:53], v[112:113] op_sel:[1,1,0] op_sel_hi:[0,1,1] neg_lo:[1,0,0]
    v_pk_fma_f32 v[114:115], v[118:119], v[54:55], v[114:115] op_sel:[1,1,0] op_sel_hi:[0,1,1] neg_lo:[1,0,0]
    ds_write_b64 v17, v[86:87] offset:27984
    buffer_load_dwordx2 v[178:179], v136, s[12:15], s71 offen offset:3456
    v_pk_mul_f32 v[116:117], v[112:113], v[52:53] op_sel_hi:[1,0]
    v_pk_mul_f32 v[118:119], v[114:115], v[54:55] op_sel_hi:[1,0]
    v_cvt_pk_bf16_f32 v88, v112, -v113
    v_cvt_pk_bf16_f32 v89, v114, -v115
    v_pk_fma_f32 v[116:117], v[112:113], v[52:53], v[116:117] op_sel:[1,1,0] op_sel_hi:[0,1,1] neg_lo:[1,0,0]
    v_pk_fma_f32 v[118:119], v[114:115], v[54:55], v[118:119] op_sel:[1,1,0] op_sel_hi:[0,1,1] neg_lo:[1,0,0]
    ds_write_b64 v17, v[88:89] offset:28512
    v_cvt_pk_bf16_f32 v90, v116, -v117
    v_cvt_pk_bf16_f32 v91, v118, -v119
    ds_write_b64 v17, v[90:91] offset:29040
    v_and_b32_e64 v1, 31, v2
    v_mul_u32_u24 v1, 528, v1
    v_lshrrev_b32_e64 v3, 5, v2
    v_lshl_add_u32 v1, v3, 4, v1
    v_add_u32 v1, s26, v1
    s_waitcnt lgkmcnt(0)
    s_cmp_lt_u32 s80, 1
    s_cbranch_scc1 L_zfc
L_zfokc:
    ds_read_b128 a[0:3], v1 offset:0
    ds_read_b128 a[64:67], v1 offset:12672
    ds_read_b128 a[4:7], v1 offset:32
    ds_read_b128 a[68:71], v1 offset:12704
    ds_read_b128 a[8:11], v1 offset:64
    ds_read_b128 a[72:75], v1 offset:12736
    ds_read_b128 a[12:15], v1 offset:96
    ds_read_b128 a[76:79], v1 offset:12768
    ds_read_b128 a[16:19], v1 offset:128
    ds_read_b128 a[80:83], v1 offset:12800
    ds_read_b128 a[20:23], v1 offset:160
    ds_read_b128 a[84:87], v1 offset:12832
    s_waitcnt lgkmcnt(10)
    v_mfma_f32_32x32x16_bf16 v[4:19], a[0:3], a[64:67], 0
    ds_read_b128 a[24:27], v1 offset:192
    ds_read_b128 a[88:91], v1 offset:12864
    s_waitcnt lgkmcnt(10)
    v_mfma_f32_32x32x16_bf16 v[4:19], a[4:7], a[68:71], v[4:19]
    ds_read_b128 a[28:31], v1 offset:224
    ds_read_b128 a[92:95], v1 offset:12896
    s_waitcnt lgkmcnt(10)
    v_mfma_f32_32x32x16_bf16 v[4:19], a[8:11], a[72:75], v[4:19]
    ds_read_b128 a[32:35], v1 offset:256
    ds_read_b128 a[96:99], v1 offset:12928
    s_waitcnt lgkmcnt(10)
    v_mfma_f32_32x32x16_bf16 v[4:19], a[12:15], a[76:79], v[4:19]
    ds_read_b128 a[36:39], v1 offset:288
    ds_read_b128 a[100:103], v1 offset:12960
    s_waitcnt lgkmcnt(10)
    v_mfma_f32_32x32x16_bf16 v[4:19], a[16:19], a[80:83], v[4:19]
    ds_read_b128 a[40:43], v1 offset:320
    ds_read_b128 a[104:107], v1 offset:12992
    s_waitcnt lgkmcnt(10)
    v_mfma_f32_32x32x16_bf16 v[4:19], a[20:23], a[84:87], v[4:19]
    ds_read_b128 a[44:47], v1 offset:352
    ds_read_b128 a[108:111], v1 offset:13024
    s_waitcnt lgkmcnt(10)
    v_mfma_f32_32x32x16_bf16 v[4:19], a[24:27], a[88:91], v[4:19]
    ds_read_b128 a[48:51], v1 offset:384
    ds_read_b128 a[112:115], v1 offset:13056
    s_waitcnt lgkmcnt(10)
    v_mfma_f32_32x32x16_bf16 v[4:19], a[28:31], a[92:95], v[4:19]
    ds_read_b128 a[52:55], v1 offset:416
    ds_read_b128 a[116:119], v1 offset:13088
    s_waitcnt lgkmcnt(10)
    v_mfma_f32_32x32x16_bf16 v[4:19], a[32:35], a[96:99], v[4:19]
    ds_read_b128 a[56:59], v1 offset:448
    ds_read_b128 a[120:123], v1 offset:13120
    s_waitcnt lgkmcnt(10)
    v_mfma_f32_32x32x16_bf16 v[4:19], a[36:39], a[100:103], v[4:19]
    ds_read_b128 a[60:63], v1 offset:480
    ds_read_b128 a[124:127], v1 offset:13152
    s_waitcnt lgkmcnt(10)
    v_mfma_f32_32x32x16_bf16 v[4:19], a[40:43], a[104:107], v[4:19]
    s_waitcnt lgkmcnt(8)
    v_mfma_f32_32x32x16_bf16 v[4:19], a[44:47], a[108:111], v[4:19]
    s_waitcnt lgkmcnt(6)
    v_mfma_f32_32x32x16_bf16 v[4:19], a[48:51], a[112:115], v[4:19]
    s_waitcnt lgkmcnt(4)
    v_mfma_f32_32x32x16_bf16 v[4:19], a[52:55], a[116:119], v[4:19]
    s_waitcnt lgkmcnt(2)
    v_mfma_f32_32x32x16_bf16 v[4:19], a[56:59], a[120:123], v[4:19]
    s_waitcnt lgkmcnt(0)
    v_mfma_f32_32x32x16_bf16 v[4:19], a[60:63], a[124:127], v[4:19]
    s_nop 11
    v_add_f32 v4, v4, v135
    v_cvt_pk_bf16_f32 v24, v4, v5
    v_cvt_pk_bf16_f32 v25, v6, v7
    v_cvt_pk_bf16_f32 v26, v8, v9
    v_cvt_pk_bf16_f32 v27, v10, v11
    v_cvt_pk_bf16_f32 v20, v12, v13
    v_cvt_pk_bf16_f32 v21, v14, v15
    ds_write_b128 v128, v[24:27] offset:32
    v_mov_b32_dpp v28, v27 wave_shr:1 row_mask:0xf bank_mask:0xf bound_ctrl:1
    v_mov_b32_dpp v22, v26 wave_shr:1 row_mask:0xf bank_mask:0xf bound_ctrl:1
    v_mov_b32 v29, v24
    v_mov_b32 v30, v25
    v_mov_b32_e64 v31, v26
    v_readlane_b32 s27, v26, 63
    v_readlane_b32 s28, v27, 63
    v_readlane_b32 s31, v20, 63
    ds_write_b128 v128, v[28:31] offset:2464
    v_alignbit_b32 v32, v24, v28, 16
    v_alignbit_b32 v33, v25, v29, 16
    v_alignbit_b32 v34, v26, v30, 16
    v_alignbit_b32 v35, v27, v31, 16
    ds_write_b128 v128, v[32:35] offset:1248
    v_alignbit_b32 v36, v28, v22, 16
    v_mov_b32 v37, v32
    v_mov_b32 v38, v33
    v_mov_b32 v39, v34
    ds_write_b128 v128, v[36:39] offset:3680
    s_lshr_b32 s27, s27, 16
    s_pack_ll_b32_b16 s27, s27, s28
    s_pack_hh_b32_b16 s29, s28, s28
    s_lshr_b32 s30, s28, 16
    s_pack_ll_b32_b16 s31, s31, s31
    v_writelane_b32 v92, s29, 2
    v_writelane_b32 v93, s30, 2
    v_writelane_b32 v92, s29, 10
    v_writelane_b32 v93, s29, 10
    v_writelane_b32 v92, s28, 18
    v_writelane_b32 v93, s29, 18
    v_writelane_b32 v94, s30, 18
    v_writelane_b32 v92, s27, 26
    v_writelane_b32 v93, s29, 26
    v_writelane_b32 v94, s29, 26
    ds_write_b32 v129, v20
    ds_write_b16 v130, v21 offset:128
    ds_write_b16_d16_hi v130, v21
    ds_write_b128 v131, v[92:95]
    v_and_b32 v144, s31, v144
    v_and_b32 v145, s31, v145
    v_and_b32 v146, s31, v146
    v_and_b32 v147, s31, v147
    buffer_load_dwordx4 v[180:183], v137, s[8:11], 0 offen offset:0 sc1
    buffer_load_dwordx4 v[184:187], v137, s[8:11], 0 offen offset:16 sc1
    buffer_load_dwordx4 v[188:191], v137, s[8:11], 0 offen offset:32 sc1
    buffer_load_dwordx4 v[192:195], v137, s[8:11], 0 offen offset:48 sc1
    ds_read2_b64 a[200:203], v132 offset0:32 offset1:33
    ds_read2_b64 a[208:211], v132 offset0:16 offset1:17
    ds_read2_b64 a[216:219], v132 offset0:0 offset1:1
    ds_read2_b64 a[196:199], v132 offset0:40 offset1:41
    ds_read2_b64 a[204:207], v132 offset0:24 offset1:25
    ds_read2_b64 a[212:215], v132 offset0:8 offset1:9
    ds_read2_b32 a[220:221], v133 offset0:48 offset1:49
    ds_read2_b32 a[222:223], v133 offset0:50 offset1:51
    ds_read2_b32 a[224:225], v133 offset0:32 offset1:33
    ds_read2_b32 a[226:227], v133 offset0:34 offset1:35
    ds_read2_b32 a[228:229], v133 offset0:16 offset1:17
    ds_read2_b32 a[230:231], v133 offset0:18 offset1:19
    ds_read2_b32 a[232:233], v133 offset0:0 offset1:1
    ds_read2_b32 a[234:235], v133 offset0:2 offset1:3
    ds_read_b64_tr_b16 a[128:129], v134 offset:8
    ds_read_b64_tr_b16 a[130:131], v134 offset:0
    ds_read_b64_tr_b16 a[132:133], v134 offset:72
    ds_read_b64_tr_b16 a[134:135], v134 offset:64
    ds_read_b64_tr_b16 a[136:137], v134 offset:136
    ds_read_b64_tr_b16 a[138:139], v134 offset:128
    ds_read_b64_tr_b16 a[140:141], v134 offset:200
    ds_read_b64_tr_b16 a[142:143], v134 offset:192
    ds_read_b64_tr_b16 a[144:145], v134 offset:264
    ds_read_b64_tr_b16 a[146:147], v134 offset:256
    ds_read_b64_tr_b16 a[148:149], v134 offset:328
    ds_read_b64_tr_b16 a[150:151], v134 offset:320
    ds_read_b64_tr_b16 a[152:153], v134 offset:392
    ds_read_b64_tr_b16 a[154:155], v134 offset:384
    ds_read_b64_tr_b16 a[156:157], v134 offset:456
    ds_read_b64_tr_b16 a[158:159], v134 offset:448
    ds_read_b64_tr_b16 a[160:161], v134 offset:520
    ds_read_b64_tr_b16 a[162:163], v134 offset:512
    ds_read_b64_tr_b16 a[164:165], v134 offset:584
    ds_read_b64_tr_b16 a[166:167], v134 offset:576
    ds_read_b64_tr_b16 a[168:169], v134 offset:648
    ds_read_b64_tr_b16 a[170:171], v134 offset:640
    ds_read_b64_tr_b16 a[172:173], v134 offset:712
    ds_read_b64_tr_b16 a[174:175], v134 offset:704
    ds_read_b64_tr_b16 a[176:177], v134 offset:776
    ds_read_b64_tr_b16 a[178:179], v134 offset:768
    ds_read_b64_tr_b16 a[180:181], v134 offset:840
    ds_read_b64_tr_b16 a[182:183], v134 offset:832
    ds_read_b64_tr_b16 a[184:185], v134 offset:904
    ds_read_b64_tr_b16 a[186:187], v134 offset:896
    ds_read_b64_tr_b16 a[188:189], v134 offset:968
    ds_read_b64_tr_b16 a[190:191], v134 offset:960
    ds_read_b64_tr_b16 a[192:193], v134 offset:1032
    ds_read_b64_tr_b16 a[194:195], v134 offset:1024
    s_waitcnt vmcnt(4)
    v_perm_b32 v212, v166, v164, s17
    v_perm_b32 v213, v170, v168, s17
    v_perm_b32 v214, v174, v172, s17
    v_perm_b32 v215, v178, v176, s17
    v_xor_b32 v3, 64, v244
    ds_write_b128 v3, v[212:215]
    v_perm_b32 v216, v166, v164, s18
    v_perm_b32 v217, v170, v168, s18
    v_perm_b32 v218, v174, v172, s18
    v_perm_b32 v219, v178, v176, s18
    v_xor_b32 v3, 80, v244
    ds_write_b128 v3, v[216:219]
    v_perm_b32 v220, v167, v165, s17
    v_perm_b32 v221, v171, v169, s17
    v_perm_b32 v222, v175, v173, s17
    v_perm_b32 v223, v179, v177, s17
    v_xor_b32 v3, 96, v244
    ds_write_b128 v3, v[220:223]
    v_perm_b32 v224, v167, v165, s18
    v_perm_b32 v225, v171, v169, s18
    v_perm_b32 v226, v175, v173, s18
    v_perm_b32 v227, v179, v177, s18
    v_xor_b32 v3, 112, v244
    ds_write_b128 v3, v[224:227]
    v_lshlrev_b32 v40, 16, v164
    v_and_b32 v41, 0xffff0000, v164
    v_lshlrev_b32 v42, 16, v165
    v_and_b32 v43, 0xffff0000, v165
    v_lshlrev_b32 v44, 16, v166
    v_and_b32 v45, 0xffff0000, v166
    v_lshlrev_b32 v46, 16, v167
    v_and_b32 v47, 0xffff0000, v167
    v_lshlrev_b32 v48, 16, v168
    v_and_b32 v49, 0xffff0000, v168
    v_lshlrev_b32 v50, 16, v169
    v_and_b32 v51, 0xffff0000, v169
    v_lshlrev_b32_e64 v52, 16, v170
    v_and_b32 v53, 0xffff0000, v170
    v_lshlrev_b32 v54, 16, v171
    v_and_b32 v55, 0xffff0000, v171
    v_lshlrev_b32 v56, 16, v172
    v_and_b32 v57, 0xffff0000, v172
    v_lshlrev_b32 v58, 16, v173
    v_and_b32 v59, 0xffff0000, v173
    v_lshlrev_b32 v60, 16, v174
    v_and_b32 v61, 0xffff0000, v174
    v_lshlrev_b32_e64 v62, 16, v175
    v_and_b32 v63, 0xffff0000, v175
    v_lshlrev_b32 v64, 16, v176
    v_and_b32 v65, 0xffff0000, v176
    v_lshlrev_b32 v66, 16, v177
    v_and_b32 v67, 0xffff0000, v177
    v_lshlrev_b32 v68, 16, v178
    v_and_b32 v69, 0xffff0000, v178
    v_lshlrev_b32_e64 v70, 16, v179
    v_and_b32 v71, 0xffff0000, v179
    s_waitcnt vmcnt(0)
    v_min_u32_e64 v1, v180, v182
    v_min3_u32 v1, v1, v184, v186
    v_min3_u32 v1, v1, v188, v190
    v_min3_u32 v1, v1, v192, v194
    v_cmp_eq_u32 vcc, 0, v1
    s_cbranch_vccnz L_st_slow
L_st_back:
    v_pk_fma_f32 v[72:73], v[40:41], v[180:181], v[180:181] op_sel:[0,0,1] op_sel_hi:[1,0,1]
    v_pk_fma_f32 v[76:77], v[44:45], v[182:183], v[182:183] op_sel:[0,0,1] op_sel_hi:[1,0,1]
    v_pk_fma_f32 v[80:81], v[48:49], v[184:185], v[184:185] op_sel:[0,0,1] op_sel_hi:[1,0,1]
    v_pk_fma_f32 v[84:85], v[52:53], v[186:187], v[186:187] op_sel:[0,0,1] op_sel_hi:[1,0,1]
    v_pk_fma_f32 v[88:89], v[56:57], v[188:189], v[188:189] op_sel:[0,0,1] op_sel_hi:[1,0,1]
    v_pk_fma_f32 v[92:93], v[60:61], v[190:191], v[190:191] op_sel:[0,0,1] op_sel_hi:[1,0,1]
    v_pk_fma_f32 v[96:97], v[64:65], v[192:193], v[192:193] op_sel:[0,0,1] op_sel_hi:[1,0,1]
    v_pk_fma_f32 v[100:101], v[68:69], v[194:195], v[194:195] op_sel:[0,0,1] op_sel_hi:[1,0,1]
    v_cvt_pk_bf16_f32 v196, v72, v76
    v_cvt_pk_bf16_f32 v197, v80, v84
    v_cvt_pk_bf16_f32 v198, v88, v92
    v_cvt_pk_bf16_f32 v199, v96, v100
    v_xor_b32_e64 v1, 0, v244
    ds_write_b128 v1, v[196:199]
    v_cvt_pk_bf16_f32 v200, v73, v77
    v_cvt_pk_bf16_f32 v201, v81, v85
    v_cvt_pk_bf16_f32 v202, v89, v93
    v_cvt_pk_bf16_f32 v203, v97, v101
    v_xor_b32_e64 v1, 16, v244
    ds_write_b128 v1, v[200:203]
    v_pk_fma_f32 v[74:75], v[42:43], v[180:181], v[180:181] op_sel:[0,0,1] op_sel_hi:[1,0,1]
    v_pk_fma_f32 v[78:79], v[46:47], v[182:183], v[182:183] op_sel:[0,0,1] op_sel_hi:[1,0,1]
    v_pk_fma_f32 v[82:83], v[50:51], v[184:185], v[184:185] op_sel:[0,0,1] op_sel_hi:[1,0,1]
    v_pk_fma_f32 v[86:87], v[54:55], v[186:187], v[186:187] op_sel:[0,0,1] op_sel_hi:[1,0,1]
    v_pk_fma_f32 v[90:91], v[58:59], v[188:189], v[188:189] op_sel:[0,0,1] op_sel_hi:[1,0,1]
    v_pk_fma_f32 v[94:95], v[62:63], v[190:191], v[190:191] op_sel:[0,0,1] op_sel_hi:[1,0,1]
    v_pk_fma_f32 v[98:99], v[66:67], v[192:193], v[192:193] op_sel:[0,0,1] op_sel_hi:[1,0,1]
    v_pk_fma_f32 v[102:103], v[70:71], v[194:195], v[194:195] op_sel:[0,0,1] op_sel_hi:[1,0,1]
    v_cvt_pk_bf16_f32 v204, v74, v78
    v_cvt_pk_bf16_f32 v205, v82, v86
    v_cvt_pk_bf16_f32 v206, v90, v94
    v_cvt_pk_bf16_f32 v207, v98, v102
    v_xor_b32_e64 v1, 32, v244
    ds_write_b128 v1, v[204:207]
    v_cvt_pk_bf16_f32 v208, v75, v79
    v_cvt_pk_bf16_f32 v209, v83, v87
    v_cvt_pk_bf16_f32 v210, v91, v95
    v_cvt_pk_bf16_f32 v211, v99, v103
    v_xor_b32_e64 v1, 48, v244
    ds_write_b128 v1, v[208:211]
    s_add_u32 m0, s66, 0
    s_nop 0
    buffer_load_dwordx4 v124, s[20:23], s64 offen nt lds
    s_add_u32 m0, s66, 1024
    s_add_u32 s64, s64, s68
    buffer_load_dwordx4 v124, s[20:23], s64 offen nt lds
    s_add_u32 m0, s66, 2048
    s_add_u32 s64, s64, s68
    buffer_load_dwordx4 v124, s[20:23], s64 offen nt lds
    s_add_u32 m0, s66, 3072
    s_add_u32 s64, s64, s68
    buffer_load_dwordx4 v124, s[20:23], s64 offen nt lds
    s_add_u32 s64, s64, s69
    s_waitcnt lgkmcnt(0)
    s_barrier
    ds_read_b128 v[164:167], v236 offset:0
    ds_read_b128 v[168:171], v236 offset:2048
    ds_read_b128 v[172:175], v236 offset:4096
    ds_read_b128 v[176:179], v236 offset:6144
    ds_read_b128 v[180:183], v236 offset:8192
    ds_read_b128 v[184:187], v236 offset:10240
    s_waitcnt lgkmcnt(5)
    v_mfma_f32_16x16x32_bf16 v[196:199], v[164:167], v[148:151], 0
    ds_read_b128 v[188:191], v236 offset:12288
    v_mfma_f32_16x16x32_bf16 v[200:203], v[164:167], v[152:155], 0
    s_waitcnt lgkmcnt(5)
    v_mfma_f32_16x16x32_bf16 v[204:207], v[168:171], v[148:151], 0
    ds_read_b128 v[192:195], v236 offset:14336
    s_nop 4
    v_cvt_pk_bf16_f32 v220, v196, v200
    v_mfma_f32_16x16x32_bf16 v[208:211], v[168:171], v[152:155], 0
    v_cvt_pk_bf16_f32 v221, v197, v201
    v_cvt_pk_bf16_f32 v222, v198, v202
    v_cvt_pk_bf16_f32 v223, v199, v203
    s_waitcnt lgkmcnt(5)
    v_mfma_f32_16x16x32_bf16 v[212:215], v[172:175], v[148:151], 0
    ds_read_b128 v[164:167], v236 offset:16384
    s_nop 1
    v_cvt_pk_bf16_f32 v224, v204, v208
    v_mfma_f32_16x16x32_bf16 v[216:219], v[172:175], v[152:155], 0
    v_cvt_pk_bf16_f32 v225, v205, v209
    v_cvt_pk_bf16_f32 v226, v206, v210
    v_mfma_f32_16x16x32_bf16 v[12:15], v[220:223], a[200:203], 0
    v_cvt_pk_bf16_f32 v227, v207, v211
    v_mfma_f32_16x16x32_bf16 v[16:19], v[220:223], a[208:211], 0
    v_mfma_f32_16x16x32_bf16 v[20:23], v[220:223], a[216:219], 0
    s_waitcnt lgkmcnt(5)
    v_mfma_f32_16x16x32_bf16 v[196:199], v[176:179], v[148:151], 0
    ds_read_b128 v[168:171], v236 offset:18432
    v_cvt_pk_bf16_f32 v228, v212, v216
    v_mfma_f32_16x16x32_bf16 v[200:203], v[176:179], v[152:155], 0
    v_cvt_pk_bf16_f32 v229, v213, v217
    v_cvt_pk_bf16_f32 v230, v214, v218
    v_mfma_f32_16x16x32_bf16 v[12:15], v[224:227], a[196:199], v[12:15]
    v_cvt_pk_bf16_f32 v231, v215, v219
    v_mfma_f32_16x16x32_bf16 v[16:19], v[224:227], a[204:207], v[16:19]
    v_mfma_f32_16x16x32_bf16 v[20:23], v[224:227], a[212:215], v[20:23]
    s_waitcnt lgkmcnt(5)
    v_mfma_f32_16x16x32_bf16 v[204:207], v[180:183], v[148:151], 0
    ds_read_b128 v[172:175], v236 offset:20480
    v_cvt_pk_bf16_f32 v220, v196, v200
    v_mfma_f32_16x16x32_bf16 v[208:211], v[180:183], v[152:155], 0
    v_cvt_pk_bf16_f32 v221, v197, v201
    v_cvt_pk_bf16_f32 v222, v198, v202
    v_mfma_f32_16x16x32_bf16 v[16:19], v[228:231], a[200:203], v[16:19]
    v_cvt_pk_bf16_f32 v223, v199, v203
    v_mfma_f32_16x16x32_bf16 v[20:23], v[228:231], a[208:211], v[20:23]
    v_mfma_f32_16x16x32_bf16 v[24:27], v[228:231], a[216:219], 0
    s_waitcnt lgkmcnt(5)
    v_mfma_f32_16x16x32_bf16 v[212:215], v[184:187], v[148:151], 0
    ds_read_b128 v[176:179], v236 offset:22528
    v_cvt_pk_bf16_f32 v224, v204, v208
    v_mfma_f32_16x16x32_bf16 v[216:219], v[184:187], v[152:155], 0
    v_cvt_pk_bf16_f32 v225, v205, v209
    v_cvt_pk_bf16_f32 v226, v206, v210
    v_mfma_f32_16x16x32_bf16 v[16:19], v[220:223], a[196:199], v[16:19]
    v_cvt_pk_bf16_f32 v227, v207, v211
    v_mfma_f32_16x16x32_bf16 v[20:23], v[220:223], a[204:207], v[20:23]
    v_mfma_f32_16x16x32_bf16 v[24:27], v[220:223], a[212:215], v[24:27]
    s_waitcnt lgkmcnt(5)
    v_mfma_f32_16x16x32_bf16 v[196:199], v[188:191], v[148:151], 0
    ds_read_b128 v[180:183], v237 offset:0
    v_cvt_pk_bf16_f32 v228, v212, v216
    v_mfma_f32_16x16x32_bf16 v[200:203], v[188:191], v[152:155], 0
    v_cvt_pk_bf16_f32 v229, v213, v217
    v_cvt_pk_bf16_f32 v230, v214, v218
    v_mfma_f32_16x16x32_bf16 v[20:23], v[224:227], a[200:203], v[20:23]
    v_cvt_pk_bf16_f32 v231, v215, v219
    v_mfma_f32_16x16x32_bf16 v[24:27], v[224:227], a[208:211], v[24:27]
    v_mfma_f32_16x16x32_bf16 v[28:31], v[224:227], a[216:219], 0
    s_waitcnt lgkmcnt(5)
    v_mfma_f32_16x16x32_bf16 v[204:207], v[192:195], v[148:151], 0
    ds_read_b128 v[184:187], v232 offset:2048
    v_cvt_pk_bf16_f32 v220, v196, v200
    v_mfma_f32_16x16x32_bf16 v[208:211], v[192:195], v[152:155], 0
    v_cvt_pk_bf16_f32 v221, v197, v201
    v_cvt_pk_bf16_f32 v222, v198, v202
    v_mfma_f32_16x16x32_bf16 v[20:23], v[228:231], a[196:199], v[20:23]
    v_cvt_pk_bf16_f32 v223, v199, v203
    v_mfma_f32_16x16x32_bf16 v[24:27], v[228:231], a[204:207], v[24:27]
    v_mfma_f32_16x16x32_bf16 v[28:31], v[228:231], a[212:215], v[28:31]
    s_waitcnt lgkmcnt(5)
    v_mfma_f32_16x16x32_bf16 v[212:215], v[164:167], v[148:151], 0
    ds_read_b128 v[188:191], v237 offset:4096
    v_cvt_pk_bf16_f32 v224, v204, v208
    v_mfma_f32_16x16x32_bf16 v[216:219], v[164:167], v[152:155], 0
    v_cvt_pk_bf16_f32 v225, v205, v209
    v_cvt_pk_bf16_f32 v226, v206, v210
    v_mfma_f32_16x16x32_bf16 v[24:27], v[220:223], a[200:203], v[24:27]
    v_cvt_pk_bf16_f32 v227, v207, v211
    v_mfma_f32_16x16x32_bf16 v[28:31], v[220:223], a[208:211], v[28:31]
    v_mfma_f32_16x16x32_bf16 v[32:35], v[220:223], a[216:219], 0
    s_waitcnt lgkmcnt(5)
    v_mfma_f32_16x16x32_bf16 v[196:199], v[168:171], v[148:151], 0
    ds_read_b128 v[192:195], v232 offset:6144
    v_cvt_pk_bf16_f32 v228, v212, v216
    v_mfma_f32_16x16x32_bf16 v[200:203], v[168:171], v[152:155], 0
    v_cvt_pk_bf16_f32 v229, v213, v217
    v_cvt_pk_bf16_f32 v230, v214, v218
    v_mfma_f32_16x16x32_bf16 v[24:27], v[224:227], a[196:199], v[24:27]
    v_cvt_pk_bf16_f32 v231, v215, v219
    v_mfma_f32_16x16x32_bf16 v[28:31], v[224:227], a[204:207], v[28:31]
    v_mfma_f32_16x16x32_bf16 v[32:35], v[224:227], a[212:215], v[32:35]
    s_waitcnt lgkmcnt(5)
    v_mfma_f32_16x16x32_bf16 v[204:207], v[172:175], v[148:151], 0
    ds_read_b128 v[164:167], v237 offset:8192
    v_cvt_pk_bf16_f32 v220, v196, v200
    v_mfma_f32_16x16x32_bf16 v[208:211], v[172:175], v[152:155], 0
    v_cvt_pk_bf16_f32 v221, v197, v201
    v_cvt_pk_bf16_f32 v222, v198, v202
    v_mfma_f32_16x16x32_bf16 v[28:31], v[228:231], a[200:203], v[28:31]
    v_cvt_pk_bf16_f32 v223, v199, v203
    v_mfma_f32_16x16x32_bf16 v[32:35], v[228:231], a[208:211], v[32:35]
    s_waitcnt lgkmcnt(5)
    v_mfma_f32_16x16x32_bf16 v[212:215], v[176:179], v[148:151], 0
    ds_read_b128 v[168:171], v232 offset:10240
    v_cvt_pk_bf16_f32 v224, v204, v208
    v_mfma_f32_16x16x32_bf16 v[216:219], v[176:179], v[152:155], 0
    v_cvt_pk_bf16_f32 v225, v205, v209
    v_cvt_pk_bf16_f32 v226, v206, v210
    v_mfma_f32_16x16x32_bf16 v[28:31], v[220:223], a[196:199], v[28:31]
    v_cvt_pk_bf16_f32 v227, v207, v211
    v_mfma_f32_16x16x32_bf16 v[32:35], v[220:223], a[204:207], v[32:35]
    s_waitcnt lgkmcnt(4)
    v_mfma_f32_16x16x32_bf16 v[196:199], v[180:183], v[156:159], 0
    ds_read_b128 v[172:175], v237 offset:12288
    ds_read_b128 v[176:179], v232 offset:14336
    v_mfma_f32_16x16x32_bf16 v[200:203], v[184:187], v[160:163], 0
    v_cvt_pk_bf16_f32 v228, v212, v216
    v_cvt_pk_bf16_f32 v229, v213, v217
    v_mfma_f32_16x16x32_bf16 v[32:35], v[224:227], a[200:203], v[32:35]
    v_cvt_pk_bf16_f32 v230, v214, v218
    v_cvt_pk_bf16_f32 v231, v215, v219
    s_waitcnt lgkmcnt(4)
    v_mfma_f32_16x16x32_bf16 v[204:207], v[188:191], v[156:159], 0
    ds_read_b128 v[180:183], v232 offset:2048
    ds_read_b128 v[184:187], v233 offset:2048
    v_mfma_f32_16x16x32_bf16 v[208:211], v[192:195], v[160:163], 0
    v_cvt_pk_bf16_f32 v220, v196, v200
    v_cvt_pk_bf16_f32 v221, v197, v201
    v_mfma_f32_16x16x32_bf16 v[32:35], v[228:231], a[196:199], v[32:35]
    v_cvt_pk_bf16_f32 v222, v198, v202
    v_cvt_pk_bf16_f32 v223, v199, v203
    s_waitcnt lgkmcnt(4)
    v_mfma_f32_16x16x32_bf16 v[212:215], v[164:167], v[156:159], 0
    ds_read_b128 v[188:191], v234 offset:2048
    ds_read_b128 v[192:195], v235 offset:2048
    v_mfma_f32_16x16x32_bf16 v[216:219], v[168:171], v[160:163], 0
    v_cvt_pk_bf16_f32 v224, v204, v208
    v_cvt_pk_bf16_f32 v225, v205, v209
    v_mfma_f32_16x16x32_bf16 v[20:23], v[220:223], a[220:223], v[20:23]
    v_cvt_pk_bf16_f32 v226, v206, v210
    v_cvt_pk_bf16_f32 v227, v207, v211
    v_mfma_f32_16x16x32_bf16 v[24:27], v[220:223], a[224:227], v[24:27]
    v_mfma_f32_16x16x32_bf16 v[28:31], v[220:223], a[228:231], v[28:31]
    v_mfma_f32_16x16x32_bf16 v[32:35], v[220:223], a[232:235], v[32:35]
    s_waitcnt lgkmcnt(4)
    v_mfma_f32_16x16x32_bf16 v[196:199], v[172:175], v[156:159], 0
    ds_read_b128 v[164:167], v232 offset:0
    ds_read_b128 v[168:171], v233 offset:0
    v_mfma_f32_16x16x32_bf16 v[200:203], v[176:179], v[160:163], 0
    v_cvt_pk_bf16_f32 v228, v212, v216
    v_cvt_pk_bf16_f32 v229, v213, v217
    v_mfma_f32_16x16x32_bf16 v[24:27], v[224:227], a[220:223], v[24:27]
    v_cvt_pk_bf16_f32 v230, v214, v218
    v_cvt_pk_bf16_f32 v231, v215, v219
    v_mfma_f32_16x16x32_bf16 v[28:31], v[224:227], a[224:227], v[28:31]
    v_mfma_f32_16x16x32_bf16 v[32:35], v[224:227], a[228:231], v[32:35]
    v_mfma_f32_16x16x32_bf16 v[28:31], v[228:231], a[220:223], v[28:31]
    v_cvt_pk_bf16_f32 v220, v196, v200
    v_cvt_pk_bf16_f32 v221, v197, v201
    v_mfma_f32_16x16x32_bf16 v[32:35], v[228:231], a[224:227], v[32:35]
    v_cvt_pk_bf16_f32 v222, v198, v202
    v_cvt_pk_bf16_f32 v223, v199, v203
    s_nop 1
    v_mfma_f32_16x16x32_bf16 v[32:35], v[220:223], a[220:223], v[32:35]
    s_waitcnt lgkmcnt(5)
    v_mfma_f32_16x16x32_bf16 v[4:7], a[128:131], v[180:183], 0
    ds_read_b128 v[172:175], v234 offset:0
    v_mfma_f32_16x16x32_bf16 v[8:11], a[160:163], v[180:183], 0
    v_mfma_f32_16x16x32_bf16 v[12:15], a[192:195], v[180:183], v[12:15]
    v_mfma_f32_16x16x32_bf16 v[20:23], v[144:147], v[180:183], v[20:23]
    s_waitcnt lgkmcnt(5)
    v_mfma_f32_16x16x32_bf16 v[8:11], a[164:167], v[184:187], v[8:11]
    ds_read_b128 v[176:179], v235 offset:0
    v_mfma_f32_16x16x32_bf16 v[4:7], a[132:135], v[184:187], v[4:7]
    s_waitcnt lgkmcnt(5)
    v_mfma_f32_16x16x32_bf16 v[4:7], a[136:139], v[188:191], v[4:7]
    ds_read_b128 v[180:183], v232 offset:6144
    v_mfma_f32_16x16x32_bf16 v[8:11], a[168:171], v[188:191], v[8:11]
    s_waitcnt lgkmcnt(5)
    v_mfma_f32_16x16x32_bf16 v[8:11], a[172:175], v[192:195], v[8:11]
    ds_read_b128 v[184:187], v233 offset:6144
    v_mfma_f32_16x16x32_bf16 v[4:7], a[140:143], v[192:195], v[4:7]
    s_waitcnt lgkmcnt(5)
    v_mfma_f32_16x16x32_bf16 v[4:7], a[144:147], v[164:167], v[4:7]
    ds_read_b128 v[188:191], v234 offset:6144
    v_mfma_f32_16x16x32_bf16 v[8:11], a[176:179], v[164:167], v[8:11]
    s_waitcnt lgkmcnt(5)
    v_mfma_f32_16x16x32_bf16 v[8:11], a[180:183], v[168:171], v[8:11]
    ds_read_b128 v[192:195], v235 offset:6144
    v_mfma_f32_16x16x32_bf16 v[4:7], a[148:151], v[168:171], v[4:7]
    s_waitcnt lgkmcnt(5)
    v_mfma_f32_16x16x32_bf16 v[4:7], a[152:155], v[172:175], v[4:7]
    ds_read_b128 v[164:167], v232 offset:4096
    v_mfma_f32_16x16x32_bf16 v[8:11], a[184:187], v[172:175], v[8:11]
    s_waitcnt lgkmcnt(5)
    v_mfma_f32_16x16x32_bf16 v[8:11], a[188:191], v[176:179], v[8:11]
    ds_read_b64 v[248:249], v238 offset:0
    ds_read_b128 v[168:171], v233 offset:4096
    v_mfma_f32_16x16x32_bf16 v[4:7], a[156:159], v[176:179], v[4:7]
    s_waitcnt lgkmcnt(6)
    v_mfma_f32_16x16x32_bf16 v[8:11], a[128:131], v[180:183], v[8:11]
    ds_read_b128 v[172:175], v234 offset:4096
    v_mfma_f32_16x16x32_bf16 v[12:15], a[160:163], v[180:183], v[12:15]
    v_mfma_f32_16x16x32_bf16 v[16:19], a[192:195], v[180:183], v[16:19]
    v_mfma_f32_16x16x32_bf16 v[24:27], v[144:147], v[180:183], v[24:27]
    s_waitcnt lgkmcnt(6)
    v_mfma_f32_16x16x32_bf16 v[12:15], a[164:167], v[184:187], v[12:15]
    s_waitcnt lgkmcnt(2)
    v_lshlrev_b32 v196, 16, v248
    v_mfma_f32_16x16x32_bf16 v[8:11], a[132:135], v[184:187], v[8:11]
    v_and_b32 v197, 0xffff0000, v248
    ds_read_b128 v[176:179], v235 offset:4096
    v_mfma_f32_16x16x32_bf16 v[8:11], a[136:139], v[188:191], v[8:11]
    v_lshlrev_b32 v198, 16, v249
    v_and_b32 v199, 0xffff0000, v249
    v_mfma_f32_16x16x32_bf16 v[12:15], a[168:171], v[188:191], v[12:15]
    ds_read_b128 v[180:183], v232 offset:10240
    v_mfma_f32_16x16x32_bf16 v[12:15], a[172:175], v[192:195], v[12:15]
    v_add_f32 v196, v196, v4
    v_add_f32 v197, v197, v5
    v_mfma_f32_16x16x32_bf16 v[8:11], a[140:143], v[192:195], v[8:11]
    ds_read_b128 v[184:187], v233 offset:10240
    v_mfma_f32_16x16x32_bf16 v[8:11], a[144:147], v[164:167], v[8:11]
    v_add_f32_e64 v198, v198, v6
    v_add_f32 v199, v199, v7
    v_mfma_f32_16x16x32_bf16 v[12:15], a[176:179], v[164:167], v[12:15]
    ds_read_b128 v[188:191], v234 offset:10240
    s_waitcnt lgkmcnt(5)
    v_mfma_f32_16x16x32_bf16 v[12:15], a[180:183], v[168:171], v[12:15]
    v_cvt_pk_bf16_f32 v244, v196, v197
    v_cvt_pk_bf16_f32 v245, v198, v199
    v_mfma_f32_16x16x32_bf16 v[8:11], a[148:151], v[168:171], v[8:11]
    ds_read_b128 v[192:195], v235 offset:10240
    s_waitcnt lgkmcnt(5)
    v_mfma_f32_16x16x32_bf16 v[8:11], a[152:155], v[172:175], v[8:11]
    ds_read_b128 v[164:167], v232 offset:8192
    v_mfma_f32_16x16x32_bf16 v[12:15], a[184:187], v[172:175], v[12:15]
    s_waitcnt lgkmcnt(5)
    v_mfma_f32_16x16x32_bf16 v[12:15], a[188:191], v[176:179], v[12:15]
    ds_read_b64 v[248:249], v238 offset:4096
    ds_read_b128 v[168:171], v233 offset:8192
    v_mfma_f32_16x16x32_bf16 v[8:11], a[156:159], v[176:179], v[8:11]
    s_waitcnt lgkmcnt(6)
    v_mfma_f32_16x16x32_bf16 v[12:15], a[128:131], v[180:183], v[12:15]
    ds_read_b128 v[172:175], v234 offset:8192
    v_mfma_f32_16x16x32_bf16 v[16:19], a[160:163], v[180:183], v[16:19]
    v_mfma_f32_16x16x32_bf16 v[20:23], a[192:195], v[180:183], v[20:23]
    v_mfma_f32_16x16x32_bf16 v[28:31], v[144:147], v[180:183], v[28:31]
    s_waitcnt lgkmcnt(6)
    v_mfma_f32_16x16x32_bf16 v[16:19], a[164:167], v[184:187], v[16:19]
    s_waitcnt lgkmcnt(2)
    v_lshlrev_b32 v196, 16, v248
    v_mfma_f32_16x16x32_bf16 v[12:15], a[132:135], v[184:187], v[12:15]
    v_and_b32 v197, 0xffff0000, v248
    ds_read_b128 v[176:179], v235 offset:8192
    v_mfma_f32_16x16x32_bf16 v[12:15], a[136:139], v[188:191], v[12:15]
    v_lshlrev_b32_e64 v198, 16, v249
    v_and_b32 v199, 0xffff0000, v249
    v_mfma_f32_16x16x32_bf16 v[16:19], a[168:171], v[188:191], v[16:19]
    ds_read_b128 v[180:183], v232 offset:14336
    v_mfma_f32_16x16x32_bf16 v[16:19], a[172:175], v[192:195], v[16:19]
    v_add_f32 v196, v196, v8
    v_add_f32 v197, v197, v9
    v_mfma_f32_16x16x32_bf16 v[12:15], a[140:143], v[192:195], v[12:15]
    ds_read_b128 v[184:187], v233 offset:14336
    v_mfma_f32_16x16x32_bf16 v[12:15], a[144:147], v[164:167], v[12:15]
    v_add_f32 v198, v198, v10
    v_add_f32 v199, v199, v11
    v_mfma_f32_16x16x32_bf16 v[16:19], a[176:179], v[164:167], v[16:19]
    ds_read_b128 v[188:191], v234 offset:14336
    s_waitcnt lgkmcnt(5)
    v_mfma_f32_16x16x32_bf16 v[16:19], a[180:183], v[168:171], v[16:19]
    v_cvt_pk_bf16_f32 v246, v196, v197
    v_cvt_pk_bf16_f32 v247, v198, v199
    v_mfma_f32_16x16x32_bf16 v[12:15], a[148:151], v[168:171], v[12:15]
    ds_read_b128 v[192:195], v235 offset:14336
    s_waitcnt lgkmcnt(5)
    v_mfma_f32_16x16x32_bf16 v[12:15], a[152:155], v[172:175], v[12:15]
    s_add_u32 s26, s73, 0
    v_permlane16_swap_b32 v244, v246
    v_mfma_f32_16x16x32_bf16 v[16:19], a[184:187], v[172:175], v[16:19]
    ds_read_b128 v[164:167], v232 offset:12288
    s_waitcnt lgkmcnt(5)
    v_mfma_f32_16x16x32_bf16 v[16:19], a[188:191], v[176:179], v[16:19]
    v_permlane16_swap_b32 v245, v247
    buffer_store_dwordx4 v[244:247], v239, s[8:11], s26 offen sc1
    v_mfma_f32_16x16x32_bf16 v[12:15], a[156:159], v[176:179], v[12:15]
    ds_read_b64 v[248:249], v238 offset:8192
    ds_read_b128 v[168:171], v233 offset:12288
    s_waitcnt lgkmcnt(6)
    v_mfma_f32_16x16x32_bf16 v[16:19], a[128:131], v[180:183], v[16:19]
    ds_read_b128 v[172:175], v234 offset:12288
    v_mfma_f32_16x16x32_bf16 v[20:23], a[160:163], v[180:183], v[20:23]
    v_mfma_f32_16x16x32_bf16 v[24:27], a[192:195], v[180:183], v[24:27]
    v_mfma_f32_16x16x32_bf16 v[32:35], v[144:147], v[180:183], v[32:35]
    s_waitcnt lgkmcnt(6)
    v_mfma_f32_16x16x32_bf16 v[20:23], a[164:167], v[184:187], v[20:23]
    s_waitcnt lgkmcnt(2)
    v_lshlrev_b32 v196, 16, v248
    v_mfma_f32_16x16x32_bf16 v[16:19], a[132:135], v[184:187], v[16:19]
    v_and_b32 v197, 0xffff0000, v248
    ds_read_b128 v[176:179], v235 offset:12288
    v_mfma_f32_16x16x32_bf16 v[16:19], a[136:139], v[188:191], v[16:19]
    v_lshlrev_b32_e64 v198, 16, v249
    v_and_b32 v199, 0xffff0000, v249
    v_mfma_f32_16x16x32_bf16 v[20:23], a[168:171], v[188:191], v[20:23]
    ds_read_b128 v[180:183], v232 offset:18432
    v_mfma_f32_16x16x32_bf16 v[20:23], a[172:175], v[192:195], v[20:23]
    v_add_f32 v196, v196, v12
    v_add_f32 v197, v197, v13
    v_mfma_f32_16x16x32_bf16 v[16:19], a[140:143], v[192:195], v[16:19]
    ds_read_b128 v[184:187], v233 offset:18432
    v_mfma_f32_16x16x32_bf16 v[16:19], a[144:147], v[164:167], v[16:19]
    v_add_f32 v198, v198, v14
    v_add_f32 v199, v199, v15
    v_mfma_f32_16x16x32_bf16 v[20:23], a[176:179], v[164:167], v[20:23]
    ds_read_b128 v[188:191], v234 offset:18432
    s_waitcnt lgkmcnt(5)
    v_mfma_f32_16x16x32_bf16 v[20:23], a[180:183], v[168:171], v[20:23]
    v_cvt_pk_bf16_f32 v244, v196, v197
    v_cvt_pk_bf16_f32 v245, v198, v199
    v_mfma_f32_16x16x32_bf16 v[16:19], a[148:151], v[168:171], v[16:19]
    ds_read_b128 v[192:195], v235 offset:18432
    s_waitcnt lgkmcnt(5)
    v_mfma_f32_16x16x32_bf16 v[16:19], a[152:155], v[172:175], v[16:19]
    ds_read_b128 v[164:167], v232 offset:16384
    v_mfma_f32_16x16x32_bf16 v[20:23], a[184:187], v[172:175], v[20:23]
    s_waitcnt lgkmcnt(5)
    v_mfma_f32_16x16x32_bf16 v[20:23], a[188:191], v[176:179], v[20:23]
    ds_read_b64 v[248:249], v238 offset:12288
    ds_read_b128 v[168:171], v233 offset:16384
    v_mfma_f32_16x16x32_bf16 v[16:19], a[156:159], v[176:179], v[16:19]
    s_waitcnt lgkmcnt(6)
    v_mfma_f32_16x16x32_bf16 v[20:23], a[128:131], v[180:183], v[20:23]
    ds_read_b128 v[172:175], v234 offset:16384
    v_mfma_f32_16x16x32_bf16 v[24:27], a[160:163], v[180:183], v[24:27]
    v_mfma_f32_16x16x32_bf16 v[28:31], a[192:195], v[180:183], v[28:31]
    s_waitcnt lgkmcnt(6)
    v_mfma_f32_16x16x32_bf16 v[24:27], a[164:167], v[184:187], v[24:27]
    s_waitcnt lgkmcnt(2)
    v_lshlrev_b32_e64 v196, 16, v248
    v_mfma_f32_16x16x32_bf16 v[20:23], a[132:135], v[184:187], v[20:23]
    v_and_b32 v197, 0xffff0000, v248
    ds_read_b128 v[176:179], v235 offset:16384
    v_mfma_f32_16x16x32_bf16 v[20:23], a[136:139], v[188:191], v[20:23]
    v_lshlrev_b32_e64 v198, 16, v249
    v_and_b32 v199, 0xffff0000, v249
    v_mfma_f32_16x16x32_bf16 v[24:27], a[168:171], v[188:191], v[24:27]
    ds_read_b128 v[180:183], v232 offset:22528
    v_mfma_f32_16x16x32_bf16 v[24:27], a[172:175], v[192:195], v[24:27]
    v_add_f32_e64 v196, v196, v16
    v_add_f32_e64 v197, v197, v17
    v_mfma_f32_16x16x32_bf16 v[20:23], a[140:143], v[192:195], v[20:23]
    ds_read_b128 v[184:187], v233 offset:22528
    v_mfma_f32_16x16x32_bf16 v[20:23], a[144:147], v[164:167], v[20:23]
    v_add_f32_e64 v198, v198, v18
    v_add_f32 v199, v199, v19
    v_mfma_f32_16x16x32_bf16 v[24:27], a[176:179], v[164:167], v[24:27]
    ds_read_b128 v[188:191], v234 offset:22528
    s_waitcnt lgkmcnt(5)
    v_mfma_f32_16x16x32_bf16 v[24:27], a[180:183], v[168:171], v[24:27]
    v_cvt_pk_bf16_f32 v246, v196, v197
    v_cvt_pk_bf16_f32 v247, v198, v199
    v_mfma_f32_16x16x32_bf16 v[20:23], a[148:151], v[168:171], v[20:23]
    ds_read_b128 v[192:195], v235 offset:22528
    s_waitcnt lgkmcnt(5)
    v_mfma_f32_16x16x32_bf16 v[20:23], a[152:155], v[172:175], v[20:23]
    s_add_u32 s26, s73, 589824
    v_permlane16_swap_b32 v244, v246
    v_mfma_f32_16x16x32_bf16 v[24:27], a[184:187], v[172:175], v[24:27]
    ds_read_b128 v[164:167], v232 offset:20480
    s_waitcnt lgkmcnt(5)
    v_mfma_f32_16x16x32_bf16 v[24:27], a[188:191], v[176:179], v[24:27]
    v_permlane16_swap_b32 v245, v247
    buffer_store_dwordx4 v[244:247], v239, s[8:11], s26 offen sc1
    v_mfma_f32_16x16x32_bf16 v[20:23], a[156:159], v[176:179], v[20:23]
    ds_read_b64 v[248:249], v238 offset:16384
    ds_read_b128 v[168:171], v233 offset:20480
    s_waitcnt lgkmcnt(6)
    v_mfma_f32_16x16x32_bf16 v[24:27], a[128:131], v[180:183], v[24:27]
    ds_read_b128 v[172:175], v234 offset:20480
    v_mfma_f32_16x16x32_bf16 v[28:31], a[160:163], v[180:183], v[28:31]
    v_mfma_f32_16x16x32_bf16 v[32:35], a[192:195], v[180:183], v[32:35]
    s_waitcnt lgkmcnt(6)
    v_mfma_f32_16x16x32_bf16 v[28:31], a[164:167], v[184:187], v[28:31]
    s_waitcnt lgkmcnt(2)
    v_lshlrev_b32 v196, 16, v248
    v_mfma_f32_16x16x32_bf16 v[24:27], a[132:135], v[184:187], v[24:27]
    v_and_b32 v197, 0xffff0000, v248
    ds_read_b128 v[176:179], v235 offset:20480
    v_mfma_f32_16x16x32_bf16 v[24:27], a[136:139], v[188:191], v[24:27]
    v_lshlrev_b32_e64 v198, 16, v249
    v_and_b32 v199, 0xffff0000, v249
    v_mfma_f32_16x16x32_bf16 v[28:31], a[168:171], v[188:191], v[28:31]
    ds_read_b128 v[180:183], v232 offset:26624
    v_mfma_f32_16x16x32_bf16 v[28:31], a[172:175], v[192:195], v[28:31]
    v_add_f32 v196, v196, v20
    v_add_f32 v197, v197, v21
    v_mfma_f32_16x16x32_bf16 v[24:27], a[140:143], v[192:195], v[24:27]
    ds_read_b128 v[184:187], v233 offset:26624
    v_mfma_f32_16x16x32_bf16 v[24:27], a[144:147], v[164:167], v[24:27]
    v_add_f32_e64 v198, v198, v22
    v_add_f32 v199, v199, v23
    v_mfma_f32_16x16x32_bf16 v[28:31], a[176:179], v[164:167], v[28:31]
    ds_read_b128 v[188:191], v234 offset:26624
    s_waitcnt lgkmcnt(5)
    v_mfma_f32_16x16x32_bf16 v[28:31], a[180:183], v[168:171], v[28:31]
    v_cvt_pk_bf16_f32 v244, v196, v197
    v_cvt_pk_bf16_f32 v245, v198, v199
    v_mfma_f32_16x16x32_bf16 v[24:27], a[148:151], v[168:171], v[24:27]
    ds_read_b128 v[192:195], v235 offset:26624
    s_waitcnt lgkmcnt(5)
    v_mfma_f32_16x16x32_bf16 v[24:27], a[152:155], v[172:175], v[24:27]
    ds_read_b128 v[164:167], v232 offset:24576
    v_mfma_f32_16x16x32_bf16 v[28:31], a[184:187], v[172:175], v[28:31]
    s_waitcnt lgkmcnt(5)
    v_mfma_f32_16x16x32_bf16 v[28:31], a[188:191], v[176:179], v[28:31]
    ds_read_b64 v[248:249], v238 offset:20480
    ds_read_b128 v[168:171], v233 offset:24576
    v_mfma_f32_16x16x32_bf16 v[24:27], a[156:159], v[176:179], v[24:27]
    s_waitcnt lgkmcnt(6)
    v_mfma_f32_16x16x32_bf16 v[28:31], a[128:131], v[180:183], v[28:31]
    ds_read_b128 v[172:175], v234 offset:24576
    v_mfma_f32_16x16x32_bf16 v[32:35], a[160:163], v[180:183], v[32:35]
    s_waitcnt lgkmcnt(6)
    v_mfma_f32_16x16x32_bf16 v[32:35], a[164:167], v[184:187], v[32:35]
    s_waitcnt lgkmcnt(2)
    v_lshlrev_b32 v196, 16, v248
    v_mfma_f32_16x16x32_bf16 v[28:31], a[132:135], v[184:187], v[28:31]
    v_and_b32 v197, 0xffff0000, v248
    ds_read_b128 v[176:179], v235 offset:24576
    v_mfma_f32_16x16x32_bf16 v[28:31], a[136:139], v[188:191], v[28:31]
    v_lshlrev_b32_e64 v198, 16, v249
    v_and_b32 v199, 0xffff0000, v249
    v_mfma_f32_16x16x32_bf16 v[32:35], a[168:171], v[188:191], v[32:35]
    ds_read_b128 v[180:183], v232 offset:30720
    v_mfma_f32_16x16x32_bf16 v[32:35], a[172:175], v[192:195], v[32:35]
    v_add_f32_e64 v196, v196, v24
    v_add_f32_e64 v197, v197, v25
    v_mfma_f32_16x16x32_bf16 v[28:31], a[140:143], v[192:195], v[28:31]
    ds_read_b128 v[184:187], v233 offset:30720
    v_mfma_f32_16x16x32_bf16 v[28:31], a[144:147], v[164:167], v[28:31]
    v_add_f32 v198, v198, v26
    v_add_f32_e64 v199, v199, v27
    v_mfma_f32_16x16x32_bf16 v[32:35], a[176:179], v[164:167], v[32:35]
    ds_read_b128 v[188:191], v234 offset:30720
    s_waitcnt lgkmcnt(5)
    v_mfma_f32_16x16x32_bf16 v[32:35], a[180:183], v[168:171], v[32:35]
    v_cvt_pk_bf16_f32 v246, v196, v197
    v_cvt_pk_bf16_f32 v247, v198, v199
    v_mfma_f32_16x16x32_bf16 v[28:31], a[148:151], v[168:171], v[28:31]
    ds_read_b128 v[192:195], v235 offset:30720
    s_waitcnt lgkmcnt(5)
    v_mfma_f32_16x16x32_bf16 v[28:31], a[152:155], v[172:175], v[28:31]
    s_add_u32 s26, s73, 1179648
    v_permlane16_swap_b32 v244, v246
    v_mfma_f32_16x16x32_bf16 v[32:35], a[184:187], v[172:175], v[32:35]
    ds_read_b128 v[164:167], v232 offset:28672
    s_waitcnt lgkmcnt(5)
    v_mfma_f32_16x16x32_bf16 v[32:35], a[188:191], v[176:179], v[32:35]
    v_permlane16_swap_b32 v245, v247
    buffer_store_dwordx4 v[244:247], v239, s[8:11], s26 offen sc1
    v_mfma_f32_16x16x32_bf16 v[28:31], a[156:159], v[176:179], v[28:31]
    ds_read_b64 v[248:249], v238 offset:24576
    ds_read_b128 v[168:171], v233 offset:28672
    s_waitcnt lgkmcnt(6)
    v_mfma_f32_16x16x32_bf16 v[32:35], a[128:131], v[180:183], v[32:35]
    ds_read_b128 v[172:175], v234 offset:28672
    s_waitcnt lgkmcnt(6)
    v_mfma_f32_16x16x32_bf16 v[32:35], a[132:135], v[184:187], v[32:35]
    s_waitcnt lgkmcnt(2)
    v_lshlrev_b32 v196, 16, v248
    v_and_b32 v197, 0xffff0000, v248
    ds_read_b128 v[176:179], v235 offset:28672
    v_mfma_f32_16x16x32_bf16 v[32:35], a[136:139], v[188:191], v[32:35]
    v_lshlrev_b32 v198, 16, v249
    v_and_b32 v199, 0xffff0000, v249
    v_mfma_f32_16x16x32_bf16 v[32:35], a[140:143], v[192:195], v[32:35]
    v_add_f32 v196, v196, v28
    v_add_f32_e64 v197, v197, v29
    v_mfma_f32_16x16x32_bf16 v[32:35], a[144:147], v[164:167], v[32:35]
    v_add_f32 v198, v198, v30
    v_add_f32_e64 v199, v199, v31
    s_waitcnt lgkmcnt(2)
    v_mfma_f32_16x16x32_bf16 v[32:35], a[148:151], v[168:171], v[32:35]
    v_cvt_pk_bf16_f32 v244, v196, v197
    v_cvt_pk_bf16_f32 v245, v198, v199
    s_waitcnt lgkmcnt(1)
    v_mfma_f32_16x16x32_bf16 v[32:35], a[152:155], v[172:175], v[32:35]
    s_waitcnt lgkmcnt(0)
    v_mfma_f32_16x16x32_bf16 v[32:35], a[156:159], v[176:179], v[32:35]
    ds_read_b64 v[248:249], v238 offset:28672
    s_waitcnt lgkmcnt(0)
    v_lshlrev_b32 v196, 16, v248
    v_and_b32 v197, 0xffff0000, v248
    v_lshlrev_b32 v198, 16, v249
    v_and_b32 v199, 0xffff0000, v249
    s_nop 1
    v_add_f32 v196, v196, v32
    v_add_f32 v197, v197, v33
    v_add_f32_e64 v198, v198, v34
    v_add_f32 v199, v199, v35
    v_cvt_pk_bf16_f32 v246, v196, v197
    v_cvt_pk_bf16_f32 v247, v198, v199
    s_add_u32 s26, s73, 1769472
    v_permlane16_swap_b32 v244, v246
    v_permlane16_swap_b32 v245, v247
    buffer_store_dwordx4 v[244:247], v239, s[8:11], s26 offen sc1
L_front_end:
    s_load_dword s80, s[58:59], 128
    s_lshl_b32 s4, s2, 1
    s_bfe_u32 s72, s2, 0x10003
    s_or_b32 s4, s4, s72
    s_and_b32 s4, s4, 7
    s_lshr_b32 s5, s2, 4
    s_and_b32 s72, s2, 4
    s_lshl_b32 s72, s72, 2
    s_or_b32 s5, s5, s72
    v_lshlrev_b32_e64 v4, 4, v2
    v_add_u32 v5, 4096, v4
    v_add_u32 v6, 8192, v4
    v_add_u32 v7, 12288, v4
    v_add_u32 v8, 16384, v4
    s_mul_i32 s72, s5, 73728
    s_lshl_b32 s73, s3, 10
    s_add_u32 s72, s72, s73
    s_mul_i32 s17, s4, 663552
    s_mul_i32 s74, s3, 18432
    s_add_u32 s17, s17, s74
    s_add_u32 s18, s17, 14155776
    s_add_u32 s17, s17, 8847360
    s_add_u32 s72, s72, s73
    s_add_u32 s19, s72, 6488064
    s_mov_b32 s12, s56
    s_and_b32 s13, s57, 0xffff
    s_mov_b32 s14, 2359296
    s_mov_b32 s15, 0x20000
    v_lshrrev_b32 v28, 2, v2
    v_bfe_u32 v29, v2, 3, 2
    v_xor_b32 v29, s3, v29
    v_and_b32 v30, 3, v2
    v_lshlrev_b32_e64 v30, 3, v30
    v_lshl_add_u32 v30, v28, 7, v30
    v_lshl_add_u32 v10, v29, 5, v30
    v_xor_b32 v11, 32, v10
    v_xor_b32 v12, 64, v10
    v_xor_b32 v13, 96, v10
    v_add_u32 v18, 73728, v4
    v_add_u32 v19, 110592, v4
    s_lshr_b32 s72, s3, 1
    s_lshl_b32 s72, s72, 12
    s_and_b32 s74, s3, 1
    s_lshl_b32 s74, s74, 3
    s_add_u32 s72, s72, s74
    s_xor_b32 s74, s73, 0
    s_add_u32 s74, s74, s72
    v_add_u32 v14, s74, v18
    s_xor_b32 s74, s73, 1024
    s_add_u32 s74, s74, s72
    v_add_u32 v15, s74, v18
    s_xor_b32 s74, s73, 2048
    s_add_u32 s74, s74, s72
    v_add_u32 v16, s74, v18
    s_xor_b32 s74, s73, 3072
    s_add_u32 s74, s74, s72
    v_add_u32 v17, s74, v18
    s_mul_i32 s72, s5, 589824
    s_add_u32 s72, s72, 19464192
    s_lshl_b32 s27, s4, 10
    s_add_u32 s27, s27, s72
    s_lshl_b32 s74, s3, 8
    s_add_u32 s27, s27, s74
    s_lshl_b32 s74, s3, 11
    s_add_u32 s72, s72, s74
    s_lshl_b32 s25, s4, 13
    s_add_u32 s74, s72, s25
    v_add_u32 v212, s74, v4
    s_lshl_b32 s21, s4, 16
    s_add_u32 s74, s72, s21
    v_add_u32_e64 v213, s74, v4
    s_lshl_b32 s72, s5, 10
    s_add_u32 s72, s72, 38371328
    s_lshr_b32 s74, s4, 1
    s_lshl_b32 s74, s74, 2
    s_add_u32 s26, s72, s74
    s_lshl_b32 s74, s3, 2
    s_add_u32 s72, s72, s74
    s_lshl_b32 s22, s4, 7
    s_add_u32 s74, s72, s22
    v_min_u32 v9, 1, v2
    v_lshl_add_u32 v214, v9, 31, s74
    s_lshl_b32 s23, s4, 4
    s_add_u32 s74, s72, s23
    v_lshl_add_u32 v9, v9, 31, s74
    v_lshlrev_b32 v215, 2, v2
    v_lshrrev_b32 v216, 5, v2
    v_mul_u32_u24 v216, 1024, v216
    v_add_u32 v216, v216, v215
    s_mul_i32 s29, s5, 73728
    s_lshl_b32 s72, s4, 2
    s_add_u32 s72, s72, s3
    s_mul_i32 s72, s72, 2304
    s_add_u32 s28, s29, s72
    s_lshl_b32 s72, s4, 7
    s_add_u32 s29, s29, s72
    s_mul_i32 s72, s3, 18432
    s_add_u32 s29, s29, s72
    v_lshrrev_b32 v31, 3, v2
    v_mul_u32_u24 v27, 1024, v31
    v_add_u32 v27, v27, v4
    v_xor_b32 v218, v31, v2
    v_and_b32 v218, 7, v218
    v_lshlrev_b32 v218, 4, v218
    v_lshl_add_u32 v218, v31, 7, v218
    s_lshl_b32 s72, s3, 11
    s_add_u32 s72, s72, 147968
    v_add_u32 v218, s72, v218
    v_lshrrev_b32 v217, 5, v2
    s_lshl_b32 s72, s3, 1
    v_or_b32 v217, s72, v217
    v_xor_b32 v217, v217, v2
    v_and_b32 v217, 7, v217
    v_lshlrev_b32 v217, 4, v217
    v_and_b32_e64 v31, 15, v2
    v_lshl_add_u32 v217, v31, 7, v217
    v_bfe_u32 v31, v2, 4, 1
    v_lshl_add_u32 v217, v31, 3, v217
    v_add_u32 v217, 147968, v217
    v_lshrrev_b32 v31, 3, v2
    v_min_u32 v31, 1, v31
    v_mul_u32_u24 v26, 144, v2
    v_lshl_add_u32 v26, v31, 31, v26
    v_mov_b32_e64 v24, 1
    s_cmp_eq_u32 s4, 0
    s_cselect_b32 s30, 1.0, 0
    v_mov_b32 v64, 1065369472
    v_mov_b32 v65, 1065369472
    v_mov_b32 v66, 1065369472
    v_mov_b32 v67, 1065369472
    s_mov_b32 s74, 0xaaaaaaaa
    s_mov_b32 s75, 0xaaaaaaaa
    s_mov_b32 s76, 0xcccccccc
    s_mov_b32 s77, 0xcccccccc
    s_mov_b32 s78, 0x00f0000f
    s_mov_b32 s79, 0xf0000f00
    s_mov_b32 s31, 400000
    s_and_b32 s72, s2, 7
    s_lshl_b32 s72, s72, 7
    s_add_u32 s72, s72, 38354944
    v_lshl_add_u32 v220, v2, 10, s72
    s_add_u32 s72, s72, 49152
    v_min_u32_e64 v222, 1, v0
    v_lshl_add_u32 v222, v222, 31, s72
    v_and_b32 v223, 7, v2
    v_lshlrev_b32 v223, 7, v223
    v_add_u32 v223, 38404096, v223
    s_bfe_u32 s72, s2, 0x40003
    s_lshl_b32 s72, s72, 10
    s_add_u32 s72, s72, 38354944
    v_lshl_add_u32 v221, v2, 7, s72
    v_mov_b32 v72, -1
    v_mov_b32_e64 v73, -1
    v_mov_b32 v74, -1
    v_mov_b32_e64 v75, -1
    s_waitcnt vmcnt(0)
    ds_read_b64_tr_b16 a[240:241], v250 offset:0
    ds_read_b64_tr_b16 a[242:243], v250 offset:2048
    ds_read_b64_tr_b16 a[244:245], v251 offset:0
    ds_read_b64_tr_b16 a[246:247], v251 offset:2048
    ds_read_b64_tr_b16 a[248:249], v252 offset:0
    ds_read_b64_tr_b16 a[250:251], v252 offset:2048
    ds_read_b64_tr_b16 a[252:253], v253 offset:0
    ds_read_b64_tr_b16 a[254:255], v253 offset:2048
    s_barrier
    s_cmp_lg_u32 s3, 0
    s_cbranch_scc1 L_s2_other
    s_waitcnt lgkmcnt(0)
    s_cmp_lt_u32 s80, 25
    s_cbranch_scc1 L_zff
L_zfokf:
    s_mov_b64 exec, 0xffff
    buffer_atomic_add v24, v220, s[8:11], 0 offen sc1
    s_mov_b64 exec, 0xff
L_s2_poll:
    v_mov_b32_e64 v25, 0
    buffer_atomic_add v25, v221, s[8:11], 0 offen sc0 sc1
    s_sub_u32 s31, s31, 1
    s_waitcnt vmcnt(0)
    v_cmp_ne_u32_e64 vcc, 32, v25
    s_cbranch_vccz L_s2_ok
    s_cmp_lg_u32 s31, 0
    s_cbranch_scc1 L_s2_poll
L_s2_ok:
    s_mov_b64 exec, -1
    s_branch L_s2_done
L_s2_other:
    s_waitcnt lgkmcnt(0)
    buffer_store_dwordx4 a[240:243], v4, s[8:11], s81 offen sc1
    s_add_u32 s81, s81, 18432
    buffer_store_dwordx4 a[244:247], v4, s[8:11], s81 offen sc1
    s_add_u32 s81, s81, 18432
    buffer_store_dwordx4 a[248:251], v4, s[8:11], s81 offen sc1
    s_add_u32 s81, s81, 18432
    buffer_store_dwordx4 a[252:255], v4, s[8:11], s81 offen sc1
    s_add_u32 s81, s81, 18432
    s_add_u32 s24, s21, 393216
    s_and_b32 s24, s24, 0x7ffff
    buffer_store_dwordx4 v[72:75], v212, s[8:11], s24 offen offset:0 sc1
    buffer_store_dwordx4 v[72:75], v212, s[8:11], s24 offen offset:1024 sc1
    s_add_u32 s24, s21, 458752
    s_and_b32 s24, s24, 0x7ffff
    buffer_store_dwordx4 v[72:75], v212, s[8:11], s24 offen offset:0 sc1
    buffer_store_dwordx4 v[72:75], v212, s[8:11], s24 offen offset:1024 sc1
    s_cmp_eq_u32 s3, 3
    s_cbranch_scc1 L_s2_done
    s_cmp_eq_u32 s3, 2
    s_cbranch_scc1 L_s2_w2
    v_subrev_u32_e64 v250, s83, v250
    v_subrev_u32_e64 v251, s83, v251
    v_subrev_u32_e64 v252, s83, v252
    v_subrev_u32_e64 v253, s83, v253
    s_sub_u32 s81, s81, 74752
    ds_read_b64_tr_b16 a[240:241], v250 offset:0
    ds_read_b64_tr_b16 a[242:243], v250 offset:2048
    ds_read_b64_tr_b16 a[244:245], v251 offset:0
    ds_read_b64_tr_b16 a[246:247], v251 offset:2048
    ds_read_b64_tr_b16 a[248:249], v252 offset:0
    ds_read_b64_tr_b16 a[250:251], v252 offset:2048
    ds_read_b64_tr_b16 a[252:253], v253 offset:0
    ds_read_b64_tr_b16 a[254:255], v253 offset:2048
    s_waitcnt lgkmcnt(0)
    buffer_store_dwordx4 a[240:243], v4, s[8:11], s81 offen sc1
    s_add_u32 s81, s81, 18432
    buffer_store_dwordx4 a[244:247], v4, s[8:11], s81 offen sc1
    s_add_u32 s81, s81, 18432
    buffer_store_dwordx4 a[248:251], v4, s[8:11], s81 offen sc1
    s_add_u32 s81, s81, 18432
    buffer_store_dwordx4 a[252:255], v4, s[8:11], s81 offen sc1
    s_add_u32 s81, s81, 18432
    s_branch L_s2_done
L_s2_w2:
    v_subrev_u32 v104, 0x1000, v212
    s_add_u32 s24, s21, 393216
    s_and_b32 s24, s24, 0x7ffff
    buffer_store_dwordx4 v[72:75], v104, s[8:11], s24 offen offset:0 sc1
    buffer_store_dwordx4 v[72:75], v104, s[8:11], s24 offen offset:1024 sc1
    s_add_u32 s24, s21, 458752
    s_and_b32 s24, s24, 0x7ffff
    buffer_store_dwordx4 v[72:75], v104, s[8:11], s24 offen offset:0 sc1
    buffer_store_dwordx4 v[72:75], v104, s[8:11], s24 offen offset:1024 sc1
L_s2_done:
    s_barrier
    s_lshl_b32 s73, s3, 11
    s_mov_b32 s16, s17
    s_add_u32 m0, s73, 0
    s_add_u32 s72, s19, 0
    s_nop 0
    buffer_load_dwordx4 v4, s[8:11], s72 offen sc1 lds
    buffer_load_dwordx4 v4, s[8:11], s72 offen offset:1024 sc1 lds
    s_add_u32 m0, s73, 8192
    s_add_u32 s72, s19, 8192
    buffer_load_dwordx4 v4, s[8:11], s72 offen sc1 lds
    buffer_load_dwordx4 v4, s[8:11], s72 offen offset:1024 sc1 lds
    buffer_load_dwordx4 v[140:143], v4, s[8:11], s16 offen offset:0 sc1
    buffer_load_dwordx4 v[144:147], v4, s[8:11], s16 offen offset:1024 sc1
    s_add_u32 m0, s73, 16384
    s_add_u32 s72, s19, 16384
    buffer_load_dwordx4 v4, s[8:11], s72 offen sc1 lds
    buffer_load_dwordx4 v4, s[8:11], s72 offen offset:1024 sc1 lds
    buffer_load_dwordx4 v[148:151], v4, s[8:11], s16 offen offset:2048 sc1
    buffer_load_dwordx4 v[152:155], v4, s[8:11], s16 offen offset:3072 sc1
    s_add_u32 m0, s73, 24576
    s_add_u32 s72, s19, 24576
    buffer_load_dwordx4 v4, s[8:11], s72 offen sc1 lds
    buffer_load_dwordx4 v4, s[8:11], s72 offen offset:1024 sc1 lds
    buffer_load_dwordx4 v[156:159], v5, s[8:11], s16 offen offset:0 sc1
    buffer_load_dwordx4 v[160:163], v5, s[8:11], s16 offen offset:1024 sc1
    s_add_u32 m0, s73, 32768
    s_add_u32 s72, s19, 32768
    buffer_load_dwordx4 v4, s[8:11], s72 offen sc1 lds
    buffer_load_dwordx4 v4, s[8:11], s72 offen offset:1024 sc1 lds
    buffer_load_dwordx4 v[164:167], v5, s[8:11], s16 offen offset:2048 sc1
    buffer_load_dwordx4 v[168:171], v5, s[8:11], s16 offen offset:3072 sc1
    s_waitcnt vmcnt(16)
    s_barrier
    ds_read_b64_tr_b16 a[0:1], v10 offset:0
    ds_read_b64_tr_b16 a[2:3], v10 offset:2048
    ds_read_b64_tr_b16 a[16:17], v10 offset:4096
    ds_read_b64_tr_b16 a[18:19], v10 offset:6144
    ds_read_b64_tr_b16 a[4:5], v11 offset:0
    ds_read_b64_tr_b16 a[6:7], v11 offset:2048
    ds_read_b64_tr_b16 a[20:21], v11 offset:4096
    ds_read_b64_tr_b16 a[22:23], v11 offset:6144
    ds_read_b64_tr_b16 a[8:9], v12 offset:0
    ds_read_b64_tr_b16 a[10:11], v12 offset:2048
    ds_read_b64_tr_b16 a[24:25], v12 offset:4096
    ds_read_b64_tr_b16 a[26:27], v12 offset:6144
    ds_read_b64_tr_b16 a[12:13], v13 offset:0
    ds_read_b64_tr_b16 a[14:15], v13 offset:2048
    ds_read_b64_tr_b16 a[28:29], v13 offset:4096
    ds_read_b64_tr_b16 a[30:31], v13 offset:6144
    s_mov_b32 s16, s17
    s_add_u32 s17, s17, 73728
    s_waitcnt vmcnt(12)
    s_barrier
    s_waitcnt lgkmcnt(12)
    v_mfma_f32_16x16x32_bf16 v[32:35], v[140:143], a[0:3], 0
    ds_read_b64_tr_b16 a[44:45], v13 offset:8192
    ds_read_b64_tr_b16 a[46:47], v13 offset:10240
    v_mfma_f32_16x16x32_bf16 v[32:35], v[144:147], a[16:19], v[32:35]
    ds_read_b64_tr_b16 a[60:61], v13 offset:12288
    ds_read_b64_tr_b16 a[62:63], v13 offset:14336
    s_waitcnt lgkmcnt(12)
    v_mfma_f32_16x16x32_bf16 v[36:39], v[144:147], a[20:23], 0
    ds_read_b64_tr_b16 a[40:41], v12 offset:8192
    ds_read_b64_tr_b16 a[42:43], v12 offset:10240
    v_mfma_f32_16x16x32_bf16 v[36:39], v[140:143], a[4:7], v[36:39]
    ds_read_b64_tr_b16 a[56:57], v12 offset:12288
    ds_read_b64_tr_b16 a[58:59], v12 offset:14336
    s_waitcnt lgkmcnt(12)
    v_mfma_f32_16x16x32_bf16 v[40:43], v[140:143], a[8:11], 0
    ds_read_b64_tr_b16 a[36:37], v11 offset:8192
    ds_read_b64_tr_b16 a[38:39], v11 offset:10240
    v_mfma_f32_16x16x32_bf16 v[40:43], v[144:147], a[24:27], v[40:43]
    ds_read_b64_tr_b16 a[52:53], v11 offset:12288
    ds_read_b64_tr_b16 a[54:55], v11 offset:14336
    s_waitcnt lgkmcnt(12)
    s_nop 0
    v_mfma_f32_16x16x32_bf16 v[44:47], v[144:147], a[28:31], 0
    ds_read_b64_tr_b16 a[32:33], v10 offset:8192
    ds_read_b64_tr_b16 a[34:35], v10 offset:10240
    v_mfma_f32_16x16x32_bf16 v[44:47], v[140:143], a[12:15], v[44:47]
    ds_read_b64_tr_b16 a[48:49], v10 offset:12288
    ds_read_b64_tr_b16 a[50:51], v10 offset:14336
    v_mfma_f32_16x16x32_bf16 v[96:99], a[0:3], a[0:3], 0
    s_add_u32 m0, s73, 40960
    s_add_u32 s72, s19, 40960
    v_mfma_f32_16x16x32_bf16 v[96:99], a[16:19], a[16:19], v[96:99]
    buffer_load_dwordx4 v4, s[8:11], s72 offen sc1 lds
    buffer_load_dwordx4 v4, s[8:11], s72 offen offset:1024 sc1 lds
    v_mfma_f32_16x16x32_bf16 v[100:103], v[64:67], a[0:3], 0
    buffer_load_dwordx4 v[172:175], v6, s[8:11], s16 offen offset:0 sc1
    buffer_load_dwordx4 v[176:179], v6, s[8:11], s16 offen offset:1024 sc1
    v_mfma_f32_16x16x32_bf16 v[100:103], v[64:67], a[16:19], v[100:103]
    s_waitcnt vmcnt(12)
    s_barrier
    s_waitcnt lgkmcnt(12)
    v_mfma_f32_16x16x32_bf16 v[44:47], v[148:151], a[44:47], v[44:47]
    ds_read_b64_tr_b16 a[64:65], v10 offset:16384
    ds_read_b64_tr_b16 a[66:67], v10 offset:18432
    v_mfma_f32_16x16x32_bf16 v[44:47], v[152:155], a[60:63], v[44:47]
    ds_read_b64_tr_b16 a[80:81], v10 offset:20480
    ds_read_b64_tr_b16 a[82:83], v10 offset:22528
    s_waitcnt lgkmcnt(12)
    v_mfma_f32_16x16x32_bf16 v[40:43], v[152:155], a[56:59], v[40:43]
    ds_read_b64_tr_b16 a[68:69], v11 offset:16384
    ds_read_b64_tr_b16 a[70:71], v11 offset:18432
    v_mfma_f32_16x16x32_bf16 v[40:43], v[148:151], a[40:43], v[40:43]
    ds_read_b64_tr_b16 a[84:85], v11 offset:20480
    ds_read_b64_tr_b16 a[86:87], v11 offset:22528
    s_waitcnt lgkmcnt(12)
    v_mfma_f32_16x16x32_bf16 v[36:39], v[148:151], a[36:39], v[36:39]
    ds_read_b64_tr_b16 a[72:73], v12 offset:16384
    ds_read_b64_tr_b16 a[74:75], v12 offset:18432
    v_mfma_f32_16x16x32_bf16 v[36:39], v[152:155], a[52:55], v[36:39]
    ds_read_b64_tr_b16 a[88:89], v12 offset:20480
    ds_read_b64_tr_b16 a[90:91], v12 offset:22528
    s_waitcnt lgkmcnt(12)
    v_mfma_f32_16x16x32_bf16 v[32:35], v[152:155], a[48:51], v[32:35]
    ds_read_b64_tr_b16 a[76:77], v13 offset:16384
    ds_read_b64_tr_b16 a[78:79], v13 offset:18432
    v_mfma_f32_16x16x32_bf16 v[32:35], v[148:151], a[32:35], v[32:35]
    ds_read_b64_tr_b16 a[92:93], v13 offset:20480
    ds_read_b64_tr_b16 a[94:95], v13 offset:22528
    v_mfma_f32_16x16x32_bf16 v[96:99], a[32:35], a[32:35], v[96:99]
    s_add_u32 m0, s73, 49152
    s_add_u32 s72, s19, 49152
    v_mfma_f32_16x16x32_bf16 v[96:99], a[48:51], a[48:51], v[96:99]
    buffer_load_dwordx4 v4, s[8:11], s72 offen sc1 lds
    buffer_load_dwordx4 v4, s[8:11], s72 offen offset:1024 sc1 lds
    v_mfma_f32_16x16x32_bf16 v[100:103], v[64:67], a[32:35], v[100:103]
    buffer_load_dwordx4 v[180:183], v6, s[8:11], s16 offen offset:2048 sc1
    buffer_load_dwordx4 v[184:187], v6, s[8:11], s16 offen offset:3072 sc1
    v_mfma_f32_16x16x32_bf16 v[100:103], v[64:67], a[48:51], v[100:103]
    s_waitcnt vmcnt(12)
    s_barrier
    s_waitcnt lgkmcnt(12)
    v_mfma_f32_16x16x32_bf16 v[32:35], v[156:159], a[64:67], v[32:35]
    ds_read_b64_tr_b16 a[108:109], v13 offset:24576
    ds_read_b64_tr_b16 a[110:111], v13 offset:26624
    v_mfma_f32_16x16x32_bf16 v[32:35], v[160:163], a[80:83], v[32:35]
    ds_read_b64_tr_b16 a[124:125], v13 offset:28672
    ds_read_b64_tr_b16 a[126:127], v13 offset:30720
    s_waitcnt lgkmcnt(12)
    v_mfma_f32_16x16x32_bf16 v[36:39], v[160:163], a[84:87], v[36:39]
    ds_read_b64_tr_b16 a[104:105], v12 offset:24576
    ds_read_b64_tr_b16 a[106:107], v12 offset:26624
    v_mfma_f32_16x16x32_bf16 v[36:39], v[156:159], a[68:71], v[36:39]
    ds_read_b64_tr_b16 a[120:121], v12 offset:28672
    ds_read_b64_tr_b16 a[122:123], v12 offset:30720
    s_waitcnt lgkmcnt(12)
    v_mfma_f32_16x16x32_bf16 v[40:43], v[156:159], a[72:75], v[40:43]
    ds_read_b64_tr_b16 a[100:101], v11 offset:24576
    ds_read_b64_tr_b16 a[102:103], v11 offset:26624
    v_mfma_f32_16x16x32_bf16 v[40:43], v[160:163], a[88:91], v[40:43]
    ds_read_b64_tr_b16 a[116:117], v11 offset:28672
    ds_read_b64_tr_b16 a[118:119], v11 offset:30720
    s_waitcnt lgkmcnt(12)
    v_mfma_f32_16x16x32_bf16 v[44:47], v[160:163], a[92:95], v[44:47]
    ds_read_b64_tr_b16 a[96:97], v10 offset:24576
    ds_read_b64_tr_b16 a[98:99], v10 offset:26624
    v_mfma_f32_16x16x32_bf16 v[44:47], v[156:159], a[76:79], v[44:47]
    ds_read_b64_tr_b16 a[112:113], v10 offset:28672
    ds_read_b64_tr_b16 a[114:115], v10 offset:30720
    v_mfma_f32_16x16x32_bf16 v[96:99], a[64:67], a[64:67], v[96:99]
    s_add_u32 m0, s73, 57344
    s_add_u32 s72, s19, 57344
    v_mfma_f32_16x16x32_bf16 v[96:99], a[80:83], a[80:83], v[96:99]
    buffer_load_dwordx4 v4, s[8:11], s72 offen sc1 lds
    buffer_load_dwordx4 v4, s[8:11], s72 offen offset:1024 sc1 lds
    v_mfma_f32_16x16x32_bf16 v[100:103], v[64:67], a[64:67], v[100:103]
    buffer_load_dwordx4 v[188:191], v7, s[8:11], s16 offen offset:0 sc1
    buffer_load_dwordx4 v[192:195], v7, s[8:11], s16 offen offset:1024 sc1
    v_mfma_f32_16x16x32_bf16 v[100:103], v[64:67], a[80:83], v[100:103]
    s_waitcnt vmcnt(12)
    s_barrier
    s_waitcnt lgkmcnt(12)
    v_mfma_f32_16x16x32_bf16 v[44:47], v[164:167], a[108:111], v[44:47]
    ds_read_b64_tr_b16 a[128:129], v10 offset:32768
    ds_read_b64_tr_b16 a[130:131], v10 offset:34816
    v_mfma_f32_16x16x32_bf16 v[44:47], v[168:171], a[124:127], v[44:47]
    ds_read_b64_tr_b16 a[144:145], v10 offset:36864
    ds_read_b64_tr_b16 a[146:147], v10 offset:38912
    s_waitcnt lgkmcnt(12)
    v_mfma_f32_16x16x32_bf16 v[40:43], v[168:171], a[120:123], v[40:43]
    ds_read_b64_tr_b16 a[132:133], v11 offset:32768
    ds_read_b64_tr_b16 a[134:135], v11 offset:34816
    v_mfma_f32_16x16x32_bf16 v[40:43], v[164:167], a[104:107], v[40:43]
    ds_read_b64_tr_b16 a[148:149], v11 offset:36864
    ds_read_b64_tr_b16 a[150:151], v11 offset:38912
    s_waitcnt lgkmcnt(12)
    v_mfma_f32_16x16x32_bf16 v[36:39], v[164:167], a[100:103], v[36:39]
    ds_read_b64_tr_b16 a[136:137], v12 offset:32768
    ds_read_b64_tr_b16 a[138:139], v12 offset:34816
    v_mfma_f32_16x16x32_bf16 v[36:39], v[168:171], a[116:119], v[36:39]
    ds_read_b64_tr_b16 a[152:153], v12 offset:36864
    ds_read_b64_tr_b16 a[154:155], v12 offset:38912
    s_waitcnt lgkmcnt(12)
    v_mfma_f32_16x16x32_bf16 v[32:35], v[168:171], a[112:115], v[32:35]
    ds_read_b64_tr_b16 a[140:141], v13 offset:32768
    ds_read_b64_tr_b16 a[142:143], v13 offset:34816
    v_mfma_f32_16x16x32_bf16 v[32:35], v[164:167], a[96:99], v[32:35]
    ds_read_b64_tr_b16 a[156:157], v13 offset:36864
    ds_read_b64_tr_b16 a[158:159], v13 offset:38912
    v_mfma_f32_16x16x32_bf16 v[96:99], a[96:99], a[96:99], v[96:99]
    s_add_u32 m0, s73, 65536
    s_add_u32 s72, s19, 65536
    v_mfma_f32_16x16x32_bf16 v[96:99], a[112:115], a[112:115], v[96:99]
    buffer_load_dwordx4 v4, s[8:11], s72 offen sc1 lds
    buffer_load_dwordx4 v4, s[8:11], s72 offen offset:1024 sc1 lds
    v_mfma_f32_16x16x32_bf16 v[100:103], v[64:67], a[96:99], v[100:103]
    buffer_load_dwordx4 v[196:199], v7, s[8:11], s16 offen offset:2048 sc1
    buffer_load_dwordx4 v[200:203], v7, s[8:11], s16 offen offset:3072 sc1
    v_mfma_f32_16x16x32_bf16 v[100:103], v[64:67], a[112:115], v[100:103]
    s_waitcnt vmcnt(12)
    s_barrier
    s_waitcnt lgkmcnt(12)
    v_mfma_f32_16x16x32_bf16 v[32:35], v[172:175], a[128:131], v[32:35]
    ds_read_b64_tr_b16 a[172:173], v13 offset:40960
    ds_read_b64_tr_b16 a[174:175], v13 offset:43008
    v_mfma_f32_16x16x32_bf16 v[32:35], v[176:179], a[144:147], v[32:35]
    ds_read_b64_tr_b16 a[188:189], v13 offset:45056
    ds_read_b64_tr_b16 a[190:191], v13 offset:47104
    s_waitcnt lgkmcnt(12)
    v_mfma_f32_16x16x32_bf16 v[36:39], v[176:179], a[148:151], v[36:39]
    ds_read_b64_tr_b16 a[168:169], v12 offset:40960
    ds_read_b64_tr_b16 a[170:171], v12 offset:43008
    v_mfma_f32_16x16x32_bf16 v[36:39], v[172:175], a[132:135], v[36:39]
    ds_read_b64_tr_b16 a[184:185], v12 offset:45056
    ds_read_b64_tr_b16 a[186:187], v12 offset:47104
    s_waitcnt lgkmcnt(12)
    v_mfma_f32_16x16x32_bf16 v[40:43], v[172:175], a[136:139], v[40:43]
    ds_read_b64_tr_b16 a[164:165], v11 offset:40960
    ds_read_b64_tr_b16 a[166:167], v11 offset:43008
    v_mfma_f32_16x16x32_bf16 v[40:43], v[176:179], a[152:155], v[40:43]
    ds_read_b64_tr_b16 a[180:181], v11 offset:45056
    ds_read_b64_tr_b16 a[182:183], v11 offset:47104
    s_waitcnt lgkmcnt(12)
    v_mfma_f32_16x16x32_bf16 v[44:47], v[176:179], a[156:159], v[44:47]
    ds_read_b64_tr_b16 a[160:161], v10 offset:40960
    ds_read_b64_tr_b16 a[162:163], v10 offset:43008
    v_mfma_f32_16x16x32_bf16 v[44:47], v[172:175], a[140:143], v[44:47]
    ds_read_b64_tr_b16 a[176:177], v10 offset:45056
    ds_read_b64_tr_b16 a[178:179], v10 offset:47104
    v_mfma_f32_16x16x32_bf16 v[96:99], a[128:131], a[128:131], v[96:99]
    buffer_load_dwordx4 v[204:207], v8, s[8:11], s16 offen offset:0 sc1
    buffer_load_dwordx4 v[208:211], v8, s[8:11], s16 offen offset:1024 sc1
    v_mfma_f32_16x16x32_bf16 v[96:99], a[144:147], a[144:147], v[96:99]
    buffer_load_dwordx4 v[140:143], v4, s[8:11], s17 offen offset:0 sc1
    buffer_load_dwordx4 v[144:147], v4, s[8:11], s17 offen offset:1024 sc1
    v_mfma_f32_16x16x32_bf16 v[100:103], v[64:67], a[128:131], v[100:103]
    v_mfma_f32_16x16x32_bf16 v[100:103], v[64:67], a[144:147], v[100:103]
    s_waitcnt vmcnt(12)
    s_barrier
    s_waitcnt lgkmcnt(12)
    v_mfma_f32_16x16x32_bf16 v[44:47], v[180:183], a[172:175], v[44:47]
    ds_read_b64_tr_b16 a[192:193], v10 offset:49152
    ds_read_b64_tr_b16 a[194:195], v10 offset:51200
    v_mfma_f32_16x16x32_bf16 v[44:47], v[184:187], a[188:191], v[44:47]
    ds_read_b64_tr_b16 a[208:209], v10 offset:53248
    ds_read_b64_tr_b16 a[210:211], v10 offset:55296
    s_waitcnt lgkmcnt(12)
    v_mfma_f32_16x16x32_bf16 v[40:43], v[184:187], a[184:187], v[40:43]
    ds_read_b64_tr_b16 a[196:197], v11 offset:49152
    ds_read_b64_tr_b16 a[198:199], v11 offset:51200
    v_mfma_f32_16x16x32_bf16 v[40:43], v[180:183], a[168:171], v[40:43]
    ds_read_b64_tr_b16 a[212:213], v11 offset:53248
    ds_read_b64_tr_b16 a[214:215], v11 offset:55296
    s_waitcnt lgkmcnt(12)
    v_mfma_f32_16x16x32_bf16 v[36:39], v[180:183], a[164:167], v[36:39]
    ds_read_b64_tr_b16 a[200:201], v12 offset:49152
    ds_read_b64_tr_b16 a[202:203], v12 offset:51200
    v_mfma_f32_16x16x32_bf16 v[36:39], v[184:187], a[180:183], v[36:39]
    ds_read_b64_tr_b16 a[216:217], v12 offset:53248
    ds_read_b64_tr_b16 a[218:219], v12 offset:55296
    s_waitcnt lgkmcnt(12)
    v_mfma_f32_16x16x32_bf16 v[32:35], v[184:187], a[176:179], v[32:35]
    ds_read_b64_tr_b16 a[204:205], v13 offset:49152
    ds_read_b64_tr_b16 a[206:207], v13 offset:51200
    v_mfma_f32_16x16x32_bf16 v[32:35], v[180:183], a[160:163], v[32:35]
    ds_read_b64_tr_b16 a[220:221], v13 offset:53248
    ds_read_b64_tr_b16 a[222:223], v13 offset:55296
    v_mfma_f32_16x16x32_bf16 v[96:99], a[160:163], a[160:163], v[96:99]
    buffer_load_dwordx4 v[148:151], v4, s[8:11], s17 offen offset:2048 sc1
    buffer_load_dwordx4 v[152:155], v4, s[8:11], s17 offen offset:3072 sc1
    v_mfma_f32_16x16x32_bf16 v[96:99], a[176:179], a[176:179], v[96:99]
    buffer_load_dwordx4 v[156:159], v5, s[8:11], s17 offen offset:0 sc1
    buffer_load_dwordx4 v[160:163], v5, s[8:11], s17 offen offset:1024 sc1
    v_mfma_f32_16x16x32_bf16 v[100:103], v[64:67], a[160:163], v[100:103]
    v_mfma_f32_16x16x32_bf16 v[100:103], v[64:67], a[176:179], v[100:103]
    s_waitcnt vmcnt(12)
    s_barrier
    s_waitcnt lgkmcnt(12)
    v_mfma_f32_16x16x32_bf16 v[32:35], v[188:191], a[192:195], v[32:35]
    ds_read_b64_tr_b16 a[236:237], v13 offset:57344
    ds_read_b64_tr_b16 a[238:239], v13 offset:59392
    v_mfma_f32_16x16x32_bf16 v[32:35], v[192:195], a[208:211], v[32:35]
    ds_read_b64_tr_b16 a[252:253], v13 offset:61440
    ds_read_b64_tr_b16 a[254:255], v13 offset:63488
    s_waitcnt lgkmcnt(12)
    v_mfma_f32_16x16x32_bf16 v[36:39], v[192:195], a[212:215], v[36:39]
    ds_read_b64_tr_b16 a[232:233], v12 offset:57344
    ds_read_b64_tr_b16 a[234:235], v12 offset:59392
    v_mfma_f32_16x16x32_bf16 v[36:39], v[188:191], a[196:199], v[36:39]
    ds_read_b64_tr_b16 a[248:249], v12 offset:61440
    ds_read_b64_tr_b16 a[250:251], v12 offset:63488
    s_waitcnt lgkmcnt(12)
    v_mfma_f32_16x16x32_bf16 v[40:43], v[188:191], a[200:203], v[40:43]
    ds_read_b64_tr_b16 a[228:229], v11 offset:57344
    ds_read_b64_tr_b16 a[230:231], v11 offset:59392
    v_mfma_f32_16x16x32_bf16 v[40:43], v[192:195], a[216:219], v[40:43]
    ds_read_b64_tr_b16 a[244:245], v11 offset:61440
    ds_read_b64_tr_b16 a[246:247], v11 offset:63488
    s_waitcnt lgkmcnt(12)
    v_mfma_f32_16x16x32_bf16 v[44:47], v[192:195], a[220:223], v[44:47]
    ds_read_b64_tr_b16 a[224:225], v10 offset:57344
    ds_read_b64_tr_b16 a[226:227], v10 offset:59392
    v_mfma_f32_16x16x32_bf16 v[44:47], v[188:191], a[204:207], v[44:47]
    ds_read_b64_tr_b16 a[240:241], v10 offset:61440
    ds_read_b64_tr_b16 a[242:243], v10 offset:63488
    v_mfma_f32_16x16x32_bf16 v[96:99], a[192:195], a[192:195], v[96:99]
    buffer_load_dwordx4 v[164:167], v5, s[8:11], s17 offen offset:2048 sc1
    buffer_load_dwordx4 v[168:171], v5, s[8:11], s17 offen offset:3072 sc1
    v_mfma_f32_16x16x32_bf16 v[96:99], a[208:211], a[208:211], v[96:99]
    buffer_load_dwordx4 v[172:175], v6, s[8:11], s17 offen offset:0 sc1
    buffer_load_dwordx4 v[176:179], v6, s[8:11], s17 offen offset:1024 sc1
    v_mfma_f32_16x16x32_bf16 v[100:103], v[64:67], a[192:195], v[100:103]
    v_mfma_f32_16x16x32_bf16 v[100:103], v[64:67], a[208:211], v[100:103]
    s_waitcnt vmcnt(12)
    s_barrier
    s_waitcnt lgkmcnt(12)
    v_mfma_f32_16x16x32_bf16 v[44:47], v[196:199], a[236:239], v[44:47]
    v_add_u32 v10, 65536, v10
    ds_read_b64_tr_b16 v[108:109], v10 offset:0
    ds_read_b64_tr_b16 v[110:111], v10 offset:2048
    v_mfma_f32_16x16x32_bf16 v[44:47], v[200:203], a[252:255], v[44:47]
    ds_read_b64_tr_b16 v[124:125], v10 offset:4096
    ds_read_b64_tr_b16 v[126:127], v10 offset:6144
    s_waitcnt lgkmcnt(12)
    v_mfma_f32_16x16x32_bf16 v[40:43], v[200:203], a[248:251], v[40:43]
    v_add_u32 v11, 65536, v11
    ds_read_b64_tr_b16 v[112:113], v11 offset:0
    ds_read_b64_tr_b16 v[114:115], v11 offset:2048
    v_mfma_f32_16x16x32_bf16 v[40:43], v[196:199], a[232:235], v[40:43]
    ds_read_b64_tr_b16 v[128:129], v11 offset:4096
    ds_read_b64_tr_b16 v[130:131], v11 offset:6144
    s_waitcnt lgkmcnt(12)
    v_mfma_f32_16x16x32_bf16 v[36:39], v[196:199], a[228:231], v[36:39]
    v_add_u32 v12, 65536, v12
    ds_read_b64_tr_b16 v[116:117], v12 offset:0
    ds_read_b64_tr_b16 v[118:119], v12 offset:2048
    v_mfma_f32_16x16x32_bf16 v[36:39], v[200:203], a[244:247], v[36:39]
    ds_read_b64_tr_b16 v[132:133], v12 offset:4096
    ds_read_b64_tr_b16 v[134:135], v12 offset:6144
    s_waitcnt lgkmcnt(12)
    v_mfma_f32_16x16x32_bf16 v[32:35], v[200:203], a[240:243], v[32:35]
    v_add_u32 v13, 65536, v13
    ds_read_b64_tr_b16 v[120:121], v13 offset:0
    ds_read_b64_tr_b16 v[122:123], v13 offset:2048
    v_mfma_f32_16x16x32_bf16 v[32:35], v[196:199], a[224:227], v[32:35]
    ds_read_b64_tr_b16 v[136:137], v13 offset:4096
    ds_read_b64_tr_b16 v[138:139], v13 offset:6144
    v_mfma_f32_16x16x32_bf16 v[96:99], a[224:227], a[224:227], v[96:99]
    buffer_load_dwordx4 v[180:183], v6, s[8:11], s17 offen offset:2048 sc1
    buffer_load_dwordx4 v[184:187], v6, s[8:11], s17 offen offset:3072 sc1
    v_mfma_f32_16x16x32_bf16 v[96:99], a[240:243], a[240:243], v[96:99]
    buffer_load_dwordx4 v[188:191], v7, s[8:11], s17 offen offset:0 sc1
    buffer_load_dwordx4 v[192:195], v7, s[8:11], s17 offen offset:1024 sc1
    v_mfma_f32_16x16x32_bf16 v[100:103], v[64:67], a[224:227], v[100:103]
    v_mfma_f32_16x16x32_bf16 v[100:103], v[64:67], a[240:243], v[100:103]
    s_waitcnt vmcnt(14)
    s_waitcnt lgkmcnt(12)
    v_mfma_f32_16x16x32_bf16 v[32:35], v[204:207], v[108:111], v[32:35]
    v_mfma_f32_16x16x32_bf16 v[48:51], v[208:211], v[124:127], v[32:35]
    s_waitcnt lgkmcnt(8)
    v_mfma_f32_16x16x32_bf16 v[36:39], v[208:211], v[128:131], v[36:39]
    v_mfma_f32_16x16x32_bf16 v[52:55], v[204:207], v[112:115], v[36:39]
    s_waitcnt lgkmcnt(4)
    v_mfma_f32_16x16x32_bf16 v[40:43], v[204:207], v[116:119], v[40:43]
    v_mfma_f32_16x16x32_bf16 v[56:59], v[208:211], v[132:135], v[40:43]
    s_waitcnt lgkmcnt(0)
    v_mfma_f32_16x16x32_bf16 v[44:47], v[208:211], v[136:139], v[44:47]
    v_mfma_f32_16x16x32_bf16 v[60:63], v[204:207], v[120:123], v[44:47]
    v_mfma_f32_16x16x32_bf16 v[96:99], v[108:111], v[108:111], v[96:99]
    buffer_load_dwordx4 v[196:199], v7, s[8:11], s17 offen offset:2048 sc1
    buffer_load_dwordx4 v[200:203], v7, s[8:11], s17 offen offset:3072 sc1
    v_mfma_f32_16x16x32_bf16 v[96:99], v[124:127], v[124:127], v[96:99]
    v_mfma_f32_16x16x32_bf16 v[100:103], v[64:67], v[108:111], v[100:103]
    v_mfma_f32_16x16x32_bf16 v[100:103], v[64:67], v[124:127], v[100:103]
    s_mov_b32 s16, s17
    s_barrier
    s_add_u32 s17, s17, 73728
    buffer_atomic_add v24, v222, s[8:11], 0 offen sc1
    s_waitcnt vmcnt(15)
    v_mfma_f32_16x16x32_bf16 v[32:35], v[140:143], a[0:3], 0
    v_mfma_f32_16x16x32_bf16 v[32:35], v[144:147], a[16:19], v[32:35]
    buffer_load_dwordx4 v[204:207], v8, s[8:11], s16 offen offset:0 sc1
    v_mfma_f32_16x16x32_bf16 v[36:39], v[144:147], a[20:23], 0
    v_mfma_f32_16x16x32_bf16 v[36:39], v[140:143], a[4:7], v[36:39]
    v_mfma_f32_16x16x32_bf16 v[40:43], v[140:143], a[8:11], 0
    v_mfma_f32_16x16x32_bf16 v[40:43], v[144:147], a[24:27], v[40:43]
    buffer_load_dwordx4 v[208:211], v8, s[8:11], s16 offen offset:1024 sc1
    v_mfma_f32_16x16x32_bf16 v[44:47], v[144:147], a[28:31], 0
    v_mfma_f32_16x16x32_bf16 v[44:47], v[140:143], a[12:15], v[44:47]
    s_waitcnt vmcnt(15)
    v_mfma_f32_16x16x32_bf16 v[44:47], v[148:151], a[44:47], v[44:47]
    v_cvt_pk_bf16_f32 v64, v48, v49
    v_mfma_f32_16x16x32_bf16 v[44:47], v[152:155], a[60:63], v[44:47]
    buffer_load_dwordx4 v[140:143], v4, s[8:11], s17 offen offset:0 sc1
    v_cvt_pk_bf16_f32 v65, v50, v51
    v_mfma_f32_16x16x32_bf16 v[40:43], v[152:155], a[56:59], v[40:43]
    v_pk_max_i16 v64, v64, 0
    v_mfma_f32_16x16x32_bf16 v[40:43], v[148:151], a[40:43], v[40:43]
    v_pk_max_i16 v65, v65, 0
    v_mfma_f32_16x16x32_bf16 v[36:39], v[148:151], a[36:39], v[36:39]
    ds_write_b64 v14, v[64:65]
    v_mfma_f32_16x16x32_bf16 v[36:39], v[152:155], a[52:55], v[36:39]
    buffer_load_dwordx4 v[144:147], v4, s[8:11], s17 offen offset:1024 sc1
    v_add_u32 v14, 8192, v14
    v_mfma_f32_16x16x32_bf16 v[32:35], v[152:155], a[48:51], v[32:35]
    v_cvt_pk_bf16_f32 v66, v52, v53
    v_mfma_f32_16x16x32_bf16 v[32:35], v[148:151], a[32:35], v[32:35]
    v_cvt_pk_bf16_f32 v67, v54, v55
    s_waitcnt vmcnt(15)
    v_mfma_f32_16x16x32_bf16 v[32:35], v[156:159], a[64:67], v[32:35]
    v_pk_max_i16 v66, v66, 0
    v_mfma_f32_16x16x32_bf16 v[32:35], v[160:163], a[80:83], v[32:35]
    buffer_load_dwordx4 v[148:151], v4, s[8:11], s17 offen offset:2048 sc1
    v_pk_max_i16 v67, v67, 0
    v_mfma_f32_16x16x32_bf16 v[36:39], v[160:163], a[84:87], v[36:39]
    ds_write_b64 v15, v[66:67]
    v_mfma_f32_16x16x32_bf16 v[36:39], v[156:159], a[68:71], v[36:39]
    v_add_u32 v15, 8192, v15
    v_mfma_f32_16x16x32_bf16 v[40:43], v[156:159], a[72:75], v[40:43]
    v_cvt_pk_bf16_f32 v68, v56, v57
    v_mfma_f32_16x16x32_bf16 v[40:43], v[160:163], a[88:91], v[40:43]
    buffer_load_dwordx4 v[152:155], v4, s[8:11], s17 offen offset:3072 sc1
    v_cvt_pk_bf16_f32 v69, v58, v59
    v_mfma_f32_16x16x32_bf16 v[44:47], v[160:163], a[92:95], v[44:47]
    v_pk_max_i16 v68, v68, 0
    v_mfma_f32_16x16x32_bf16 v[44:47], v[156:159], a[76:79], v[44:47]
    v_pk_max_i16 v69, v69, 0
    s_waitcnt vmcnt(15)
    v_mfma_f32_16x16x32_bf16 v[44:47], v[164:167], a[108:111], v[44:47]
    ds_write_b64 v16, v[68:69]
    v_mfma_f32_16x16x32_bf16 v[44:47], v[168:171], a[124:127], v[44:47]
    buffer_load_dwordx4 v[156:159], v5, s[8:11], s17 offen offset:0 sc1
    v_add_u32 v16, 8192, v16
    v_mfma_f32_16x16x32_bf16 v[40:43], v[168:171], a[120:123], v[40:43]
    v_cvt_pk_bf16_f32 v70, v60, v61
    v_mfma_f32_16x16x32_bf16 v[40:43], v[164:167], a[104:107], v[40:43]
    v_cvt_pk_bf16_f32 v71, v62, v63
    v_mfma_f32_16x16x32_bf16 v[36:39], v[164:167], a[100:103], v[36:39]
    v_pk_max_i16 v70, v70, 0
    v_mfma_f32_16x16x32_bf16 v[36:39], v[168:171], a[116:119], v[36:39]
    buffer_load_dwordx4 v[160:163], v5, s[8:11], s17 offen offset:1024 sc1
    v_pk_max_i16 v71, v71, 0
    v_mfma_f32_16x16x32_bf16 v[32:35], v[168:171], a[112:115], v[32:35]
    ds_write_b64 v17, v[70:71]
    v_mfma_f32_16x16x32_bf16 v[32:35], v[164:167], a[96:99], v[32:35]
    v_add_u32 v17, 8192, v17
    s_waitcnt vmcnt(15)
    v_mfma_f32_16x16x32_bf16 v[32:35], v[172:175], a[128:131], v[32:35]
    v_cndmask_b32 v96, v96, v97, s[74:75]
    v_mfma_f32_16x16x32_bf16 v[32:35], v[176:179], a[144:147], v[32:35]
    buffer_load_dwordx4 v[164:167], v5, s[8:11], s17 offen offset:2048 sc1
    v_cndmask_b32 v98, v98, v99, s[74:75]
    v_mfma_f32_16x16x32_bf16 v[36:39], v[176:179], a[148:151], v[36:39]
    v_mul_f32 v100, 987991609, v100
    v_mfma_f32_16x16x32_bf16 v[36:39], v[172:175], a[132:135], v[36:39]
    v_cndmask_b32 v96, v96, v98, s[76:77]
    v_mfma_f32_16x16x32_bf16 v[40:43], v[172:175], a[136:139], v[40:43]
    v_and_b32_e64 v28, 15, v2
    v_mfma_f32_16x16x32_bf16 v[40:43], v[176:179], a[152:155], v[40:43]
    buffer_load_dwordx4 v[168:171], v5, s[8:11], s17 offen offset:3072 sc1
    v_mul_f32 v96, 987991609, v96
    v_mfma_f32_16x16x32_bf16 v[44:47], v[176:179], a[156:159], v[44:47]
    v_lshlrev_b32_e64 v28, 2, v28
    v_mfma_f32_16x16x32_bf16 v[44:47], v[172:175], a[140:143], v[44:47]
    v_fma_f32 v96, -v100, v100, v96
    s_waitcnt vmcnt(15)
    v_mfma_f32_16x16x32_bf16 v[44:47], v[180:183], a[172:175], v[44:47]
    v_add_u32 v28, 147456, v28
    v_mfma_f32_16x16x32_bf16 v[44:47], v[184:187], a[188:191], v[44:47]
    buffer_load_dwordx4 v[172:175], v6, s[8:11], s17 offen offset:0 sc1
    v_max_f32_e64 v96, 0, v96
    v_mfma_f32_16x16x32_bf16 v[40:43], v[184:187], a[184:187], v[40:43]
    s_lshl_b32 s72, s3, 6
    v_mfma_f32_16x16x32_bf16 v[40:43], v[180:183], a[168:171], v[40:43]
    v_add_f32 v96, 925353388, v96
    v_mfma_f32_16x16x32_bf16 v[36:39], v[180:183], a[164:167], v[36:39]
    v_add_u32_e64 v29, s72, v28
    v_mfma_f32_16x16x32_bf16 v[36:39], v[184:187], a[180:183], v[36:39]
    buffer_load_dwordx4 v[176:179], v6, s[8:11], s17 offen offset:1024 sc1
    v_rsq_f32_e64 v96, v96
    v_mfma_f32_16x16x32_bf16 v[32:35], v[184:187], a[176:179], v[32:35]
    v_add_u32 v30, 256, v29
    v_mfma_f32_16x16x32_bf16 v[32:35], v[180:183], a[160:163], v[32:35]
    v_cndmask_b32 v29, v30, v29, s[78:79]
    s_waitcnt vmcnt(15)
    v_mfma_f32_16x16x32_bf16 v[32:35], v[188:191], a[192:195], v[32:35]
    ds_write_b32 v29, v96
    v_mfma_f32_16x16x32_bf16 v[32:35], v[192:195], a[208:211], v[32:35]
    buffer_load_dwordx4 v[180:183], v6, s[8:11], s17 offen offset:2048 sc1
    v_mfma_f32_16x16x32_bf16 v[36:39], v[192:195], a[212:215], v[36:39]
    v_mfma_f32_16x16x32_bf16 v[36:39], v[188:191], a[196:199], v[36:39]
    v_mfma_f32_16x16x32_bf16 v[40:43], v[188:191], a[200:203], v[40:43]
    v_mfma_f32_16x16x32_bf16 v[40:43], v[192:195], a[216:219], v[40:43]
    buffer_load_dwordx4 v[184:187], v6, s[8:11], s17 offen offset:3072 sc1
    v_mfma_f32_16x16x32_bf16 v[44:47], v[192:195], a[220:223], v[44:47]
    v_mfma_f32_16x16x32_bf16 v[44:47], v[188:191], a[204:207], v[44:47]
    s_waitcnt vmcnt(15)
    v_mfma_f32_16x16x32_bf16 v[44:47], v[196:199], a[236:239], v[44:47]
    v_mfma_f32_16x16x32_bf16 v[44:47], v[200:203], a[252:255], v[44:47]
    buffer_load_dwordx4 v[188:191], v7, s[8:11], s17 offen offset:0 sc1
    v_mfma_f32_16x16x32_bf16 v[40:43], v[200:203], a[248:251], v[40:43]
    v_mfma_f32_16x16x32_bf16 v[40:43], v[196:199], a[232:235], v[40:43]
    v_mfma_f32_16x16x32_bf16 v[36:39], v[196:199], a[228:231], v[36:39]
    v_mfma_f32_16x16x32_bf16 v[36:39], v[200:203], a[244:247], v[36:39]
    buffer_load_dwordx4 v[192:195], v7, s[8:11], s17 offen offset:1024 sc1
    v_mfma_f32_16x16x32_bf16 v[32:35], v[200:203], a[240:243], v[32:35]
    v_mfma_f32_16x16x32_bf16 v[32:35], v[196:199], a[224:227], v[32:35]
    s_waitcnt vmcnt(14)
    v_mfma_f32_16x16x32_bf16 v[32:35], v[204:207], v[108:111], v[32:35]
    v_mfma_f32_16x16x32_bf16 v[48:51], v[208:211], v[124:127], v[32:35]
    buffer_load_dwordx4 v[196:199], v7, s[8:11], s17 offen offset:2048 sc1
    v_mfma_f32_16x16x32_bf16 v[36:39], v[208:211], v[128:131], v[36:39]
    v_mfma_f32_16x16x32_bf16 v[52:55], v[204:207], v[112:115], v[36:39]
    v_mfma_f32_16x16x32_bf16 v[40:43], v[204:207], v[116:119], v[40:43]
    v_mfma_f32_16x16x32_bf16 v[56:59], v[208:211], v[132:135], v[40:43]
    buffer_load_dwordx4 v[200:203], v7, s[8:11], s17 offen offset:3072 sc1
    v_mfma_f32_16x16x32_bf16 v[44:47], v[208:211], v[136:139], v[44:47]
    v_mfma_f32_16x16x32_bf16 v[60:63], v[204:207], v[120:123], v[44:47]
    s_mov_b32 s20, 5
L_k3_loop2:
    s_mov_b32 s16, s17
    s_barrier
    s_add_u32 s17, s17, 73728
    s_waitcnt vmcnt(14)
    v_mfma_f32_16x16x32_bf16 v[32:35], v[140:143], a[0:3], 0
    v_mfma_f32_16x16x32_bf16 v[32:35], v[144:147], a[16:19], v[32:35]
    buffer_load_dwordx4 v[204:207], v8, s[8:11], s16 offen offset:0 sc1
    v_mfma_f32_16x16x32_bf16 v[36:39], v[144:147], a[20:23], 0
    v_mfma_f32_16x16x32_bf16 v[36:39], v[140:143], a[4:7], v[36:39]
    v_mfma_f32_16x16x32_bf16 v[40:43], v[140:143], a[8:11], 0
    v_mfma_f32_16x16x32_bf16 v[40:43], v[144:147], a[24:27], v[40:43]
    buffer_load_dwordx4 v[208:211], v8, s[8:11], s16 offen offset:1024 sc1
    v_mfma_f32_16x16x32_bf16 v[44:47], v[144:147], a[28:31], 0
    v_mfma_f32_16x16x32_bf16 v[44:47], v[140:143], a[12:15], v[44:47]
    s_waitcnt vmcnt(14)
    v_mfma_f32_16x16x32_bf16 v[44:47], v[148:151], a[44:47], v[44:47]
    v_cvt_pk_bf16_f32 v64, v48, v49
    v_mfma_f32_16x16x32_bf16 v[44:47], v[152:155], a[60:63], v[44:47]
    buffer_load_dwordx4 v[140:143], v4, s[8:11], s17 offen offset:0 sc1
    v_cvt_pk_bf16_f32 v65, v50, v51
    v_mfma_f32_16x16x32_bf16 v[40:43], v[152:155], a[56:59], v[40:43]
    v_pk_max_i16 v64, v64, 0
    v_mfma_f32_16x16x32_bf16 v[40:43], v[148:151], a[40:43], v[40:43]
    v_pk_max_i16 v65, v65, 0
    v_mfma_f32_16x16x32_bf16 v[36:39], v[148:151], a[36:39], v[36:39]
    ds_write_b64 v14, v[64:65]
    v_mfma_f32_16x16x32_bf16 v[36:39], v[152:155], a[52:55], v[36:39]
    buffer_load_dwordx4 v[144:147], v4, s[8:11], s17 offen offset:1024 sc1
    v_add_u32 v14, 8192, v14
    v_mfma_f32_16x16x32_bf16 v[32:35], v[152:155], a[48:51], v[32:35]
    v_cvt_pk_bf16_f32 v66, v52, v53
    v_mfma_f32_16x16x32_bf16 v[32:35], v[148:151], a[32:35], v[32:35]
    v_cvt_pk_bf16_f32 v67, v54, v55
    s_waitcnt vmcnt(14)
    v_mfma_f32_16x16x32_bf16 v[32:35], v[156:159], a[64:67], v[32:35]
    v_pk_max_i16 v66, v66, 0
    v_mfma_f32_16x16x32_bf16 v[32:35], v[160:163], a[80:83], v[32:35]
    buffer_load_dwordx4 v[148:151], v4, s[8:11], s17 offen offset:2048 sc1
    v_pk_max_i16 v67, v67, 0
    v_mfma_f32_16x16x32_bf16 v[36:39], v[160:163], a[84:87], v[36:39]
    ds_write_b64 v15, v[66:67]
    v_mfma_f32_16x16x32_bf16 v[36:39], v[156:159], a[68:71], v[36:39]
    v_add_u32 v15, 8192, v15
    v_mfma_f32_16x16x32_bf16 v[40:43], v[156:159], a[72:75], v[40:43]
    v_cvt_pk_bf16_f32 v68, v56, v57
    v_mfma_f32_16x16x32_bf16 v[40:43], v[160:163], a[88:91], v[40:43]
    buffer_load_dwordx4 v[152:155], v4, s[8:11], s17 offen offset:3072 sc1
    v_cvt_pk_bf16_f32 v69, v58, v59
    v_mfma_f32_16x16x32_bf16 v[44:47], v[160:163], a[92:95], v[44:47]
    v_pk_max_i16 v68, v68, 0
    v_mfma_f32_16x16x32_bf16 v[44:47], v[156:159], a[76:79], v[44:47]
    v_pk_max_i16 v69, v69, 0
    s_waitcnt vmcnt(14)
    v_mfma_f32_16x16x32_bf16 v[44:47], v[164:167], a[108:111], v[44:47]
    ds_write_b64 v16, v[68:69]
    v_mfma_f32_16x16x32_bf16 v[44:47], v[168:171], a[124:127], v[44:47]
    buffer_load_dwordx4 v[156:159], v5, s[8:11], s17 offen offset:0 sc1
    v_add_u32 v16, 8192, v16
    v_mfma_f32_16x16x32_bf16 v[40:43], v[168:171], a[120:123], v[40:43]
    v_cvt_pk_bf16_f32 v70, v60, v61
    v_mfma_f32_16x16x32_bf16 v[40:43], v[164:167], a[104:107], v[40:43]
    v_cvt_pk_bf16_f32 v71, v62, v63
    v_mfma_f32_16x16x32_bf16 v[36:39], v[164:167], a[100:103], v[36:39]
    v_pk_max_i16 v70, v70, 0
    v_mfma_f32_16x16x32_bf16 v[36:39], v[168:171], a[116:119], v[36:39]
    buffer_load_dwordx4 v[160:163], v5, s[8:11], s17 offen offset:1024 sc1
    v_pk_max_i16 v71, v71, 0
    v_mfma_f32_16x16x32_bf16 v[32:35], v[168:171], a[112:115], v[32:35]
    ds_write_b64 v17, v[70:71]
    v_mfma_f32_16x16x32_bf16 v[32:35], v[164:167], a[96:99], v[32:35]
    v_add_u32 v17, 8192, v17
    s_waitcnt vmcnt(14)
    v_mfma_f32_16x16x32_bf16 v[32:35], v[172:175], a[128:131], v[32:35]
    v_mfma_f32_16x16x32_bf16 v[32:35], v[176:179], a[144:147], v[32:35]
    buffer_load_dwordx4 v[164:167], v5, s[8:11], s17 offen offset:2048 sc1
    v_mfma_f32_16x16x32_bf16 v[36:39], v[176:179], a[148:151], v[36:39]
    v_mfma_f32_16x16x32_bf16 v[36:39], v[172:175], a[132:135], v[36:39]
    v_mfma_f32_16x16x32_bf16 v[40:43], v[172:175], a[136:139], v[40:43]
    v_mfma_f32_16x16x32_bf16 v[40:43], v[176:179], a[152:155], v[40:43]
    buffer_load_dwordx4 v[168:171], v5, s[8:11], s17 offen offset:3072 sc1
    v_mfma_f32_16x16x32_bf16 v[44:47], v[176:179], a[156:159], v[44:47]
    v_mfma_f32_16x16x32_bf16 v[44:47], v[172:175], a[140:143], v[44:47]
    s_waitcnt vmcnt(14)
    v_mfma_f32_16x16x32_bf16 v[44:47], v[180:183], a[172:175], v[44:47]
    v_mfma_f32_16x16x32_bf16 v[44:47], v[184:187], a[188:191], v[44:47]
    buffer_load_dwordx4 v[172:175], v6, s[8:11], s17 offen offset:0 sc1
    v_mfma_f32_16x16x32_bf16 v[40:43], v[184:187], a[184:187], v[40:43]
    v_mfma_f32_16x16x32_bf16 v[40:43], v[180:183], a[168:171], v[40:43]
    v_mfma_f32_16x16x32_bf16 v[36:39], v[180:183], a[164:167], v[36:39]
    v_mfma_f32_16x16x32_bf16 v[36:39], v[184:187], a[180:183], v[36:39]
    buffer_load_dwordx4 v[176:179], v6, s[8:11], s17 offen offset:1024 sc1
    v_mfma_f32_16x16x32_bf16 v[32:35], v[184:187], a[176:179], v[32:35]
    v_mfma_f32_16x16x32_bf16 v[32:35], v[180:183], a[160:163], v[32:35]
    s_waitcnt vmcnt(14)
    v_mfma_f32_16x16x32_bf16 v[32:35], v[188:191], a[192:195], v[32:35]
    v_mfma_f32_16x16x32_bf16 v[32:35], v[192:195], a[208:211], v[32:35]
    buffer_load_dwordx4 v[180:183], v6, s[8:11], s17 offen offset:2048 sc1
    v_mfma_f32_16x16x32_bf16 v[36:39], v[192:195], a[212:215], v[36:39]
    v_mfma_f32_16x16x32_bf16 v[36:39], v[188:191], a[196:199], v[36:39]
    v_mfma_f32_16x16x32_bf16 v[40:43], v[188:191], a[200:203], v[40:43]
    v_mfma_f32_16x16x32_bf16 v[40:43], v[192:195], a[216:219], v[40:43]
    buffer_load_dwordx4 v[184:187], v6, s[8:11], s17 offen offset:3072 sc1
    v_mfma_f32_16x16x32_bf16 v[44:47], v[192:195], a[220:223], v[44:47]
    v_mfma_f32_16x16x32_bf16 v[44:47], v[188:191], a[204:207], v[44:47]
    s_waitcnt vmcnt(14)
    v_mfma_f32_16x16x32_bf16 v[44:47], v[196:199], a[236:239], v[44:47]
    v_mfma_f32_16x16x32_bf16 v[44:47], v[200:203], a[252:255], v[44:47]
    buffer_load_dwordx4 v[188:191], v7, s[8:11], s17 offen offset:0 sc1
    v_mfma_f32_16x16x32_bf16 v[40:43], v[200:203], a[248:251], v[40:43]
    v_mfma_f32_16x16x32_bf16 v[40:43], v[196:199], a[232:235], v[40:43]
    v_mfma_f32_16x16x32_bf16 v[36:39], v[196:199], a[228:231], v[36:39]
    v_mfma_f32_16x16x32_bf16 v[36:39], v[200:203], a[244:247], v[36:39]
    buffer_load_dwordx4 v[192:195], v7, s[8:11], s17 offen offset:1024 sc1
    v_mfma_f32_16x16x32_bf16 v[32:35], v[200:203], a[240:243], v[32:35]
    v_mfma_f32_16x16x32_bf16 v[32:35], v[196:199], a[224:227], v[32:35]
    s_waitcnt vmcnt(14)
    v_mfma_f32_16x16x32_bf16 v[32:35], v[204:207], v[108:111], v[32:35]
    v_mfma_f32_16x16x32_bf16 v[48:51], v[208:211], v[124:127], v[32:35]
    buffer_load_dwordx4 v[196:199], v7, s[8:11], s17 offen offset:2048 sc1
    v_mfma_f32_16x16x32_bf16 v[36:39], v[208:211], v[128:131], v[36:39]
    v_mfma_f32_16x16x32_bf16 v[52:55], v[204:207], v[112:115], v[36:39]
    v_mfma_f32_16x16x32_bf16 v[40:43], v[204:207], v[116:119], v[40:43]
    v_mfma_f32_16x16x32_bf16 v[56:59], v[208:211], v[132:135], v[40:43]
    buffer_load_dwordx4 v[200:203], v7, s[8:11], s17 offen offset:3072 sc1
    s_sub_u32 s20, s20, 1
    s_cmp_lg_u32 s20, 0
    v_mfma_f32_16x16x32_bf16 v[44:47], v[208:211], v[136:139], v[44:47]
    v_mfma_f32_16x16x32_bf16 v[60:63], v[204:207], v[120:123], v[44:47]
    s_cbranch_scc1 L_k3_loop2
    s_mov_b32 s16, s17
    s_barrier
    s_add_u32 s17, s17, 73728
    buffer_load_dword v25, v223, s[8:11], 0 offen sc1
    s_waitcnt vmcnt(15)
    v_mfma_f32_16x16x32_bf16 v[32:35], v[140:143], a[0:3], 0
    v_mfma_f32_16x16x32_bf16 v[32:35], v[144:147], a[16:19], v[32:35]
    buffer_load_dwordx4 v[204:207], v8, s[8:11], s16 offen offset:0 sc1
    v_mfma_f32_16x16x32_bf16 v[36:39], v[144:147], a[20:23], 0
    v_mfma_f32_16x16x32_bf16 v[36:39], v[140:143], a[4:7], v[36:39]
    v_mfma_f32_16x16x32_bf16 v[40:43], v[140:143], a[8:11], 0
    v_mfma_f32_16x16x32_bf16 v[40:43], v[144:147], a[24:27], v[40:43]
    buffer_load_dwordx4 v[208:211], v8, s[8:11], s16 offen offset:1024 sc1
    v_mfma_f32_16x16x32_bf16 v[44:47], v[144:147], a[28:31], 0
    v_mfma_f32_16x16x32_bf16 v[44:47], v[140:143], a[12:15], v[44:47]
    s_waitcnt vmcnt(15)
    v_mfma_f32_16x16x32_bf16 v[44:47], v[148:151], a[44:47], v[44:47]
    v_cvt_pk_bf16_f32 v64, v48, v49
    v_mfma_f32_16x16x32_bf16 v[44:47], v[152:155], a[60:63], v[44:47]
    buffer_load_dwordx4 v[140:143], v4, s[8:11], s17 offen offset:0 sc1
    v_cvt_pk_bf16_f32 v65, v50, v51
    v_mfma_f32_16x16x32_bf16 v[40:43], v[152:155], a[56:59], v[40:43]
    v_pk_max_i16 v64, v64, 0
    v_mfma_f32_16x16x32_bf16 v[40:43], v[148:151], a[40:43], v[40:43]
    v_pk_max_i16 v65, v65, 0
    v_mfma_f32_16x16x32_bf16 v[36:39], v[148:151], a[36:39], v[36:39]
    ds_write_b64 v14, v[64:65]
    v_mfma_f32_16x16x32_bf16 v[36:39], v[152:155], a[52:55], v[36:39]
    buffer_load_dwordx4 v[144:147], v4, s[8:11], s17 offen offset:1024 sc1
    v_add_u32 v14, 8192, v14
    v_mfma_f32_16x16x32_bf16 v[32:35], v[152:155], a[48:51], v[32:35]
    v_cvt_pk_bf16_f32 v66, v52, v53
    v_mfma_f32_16x16x32_bf16 v[32:35], v[148:151], a[32:35], v[32:35]
    v_cvt_pk_bf16_f32 v67, v54, v55
    s_waitcnt vmcnt(15)
    v_mfma_f32_16x16x32_bf16 v[32:35], v[156:159], a[64:67], v[32:35]
    v_pk_max_i16 v66, v66, 0
    v_mfma_f32_16x16x32_bf16 v[32:35], v[160:163], a[80:83], v[32:35]
    buffer_load_dwordx4 v[148:151], v4, s[8:11], s17 offen offset:2048 sc1
    v_pk_max_i16 v67, v67, 0
    v_mfma_f32_16x16x32_bf16 v[36:39], v[160:163], a[84:87], v[36:39]
    ds_write_b64 v15, v[66:67]
    v_mfma_f32_16x16x32_bf16 v[36:39], v[156:159], a[68:71], v[36:39]
    v_add_u32 v15, 8192, v15
    v_mfma_f32_16x16x32_bf16 v[40:43], v[156:159], a[72:75], v[40:43]
    v_cvt_pk_bf16_f32 v68, v56, v57
    v_mfma_f32_16x16x32_bf16 v[40:43], v[160:163], a[88:91], v[40:43]
    buffer_load_dwordx4 v[152:155], v4, s[8:11], s17 offen offset:3072 sc1
    v_cvt_pk_bf16_f32 v69, v58, v59
    v_mfma_f32_16x16x32_bf16 v[44:47], v[160:163], a[92:95], v[44:47]
    v_pk_max_i16 v68, v68, 0
    v_mfma_f32_16x16x32_bf16 v[44:47], v[156:159], a[76:79], v[44:47]
    v_pk_max_i16 v69, v69, 0
    s_waitcnt vmcnt(15)
    v_mfma_f32_16x16x32_bf16 v[44:47], v[164:167], a[108:111], v[44:47]
    ds_write_b64 v16, v[68:69]
    v_mfma_f32_16x16x32_bf16 v[44:47], v[168:171], a[124:127], v[44:47]
    buffer_load_dwordx4 v[156:159], v5, s[8:11], s17 offen offset:0 sc1
    v_add_u32 v16, 8192, v16
    v_mfma_f32_16x16x32_bf16 v[40:43], v[168:171], a[120:123], v[40:43]
    v_cvt_pk_bf16_f32 v70, v60, v61
    v_mfma_f32_16x16x32_bf16 v[40:43], v[164:167], a[104:107], v[40:43]
    v_cvt_pk_bf16_f32 v71, v62, v63
    v_mfma_f32_16x16x32_bf16 v[36:39], v[164:167], a[100:103], v[36:39]
    v_pk_max_i16 v70, v70, 0
    v_mfma_f32_16x16x32_bf16 v[36:39], v[168:171], a[116:119], v[36:39]
    buffer_load_dwordx4 v[160:163], v5, s[8:11], s17 offen offset:1024 sc1
    v_pk_max_i16 v71, v71, 0
    v_mfma_f32_16x16x32_bf16 v[32:35], v[168:171], a[112:115], v[32:35]
    ds_write_b64 v17, v[70:71]
    v_mfma_f32_16x16x32_bf16 v[32:35], v[164:167], a[96:99], v[32:35]
    v_add_u32 v17, 8192, v17
    s_waitcnt vmcnt(15)
    v_mfma_f32_16x16x32_bf16 v[32:35], v[172:175], a[128:131], v[32:35]
    v_mfma_f32_16x16x32_bf16 v[32:35], v[176:179], a[144:147], v[32:35]
    buffer_load_dwordx4 v[164:167], v5, s[8:11], s17 offen offset:2048 sc1
    v_mfma_f32_16x16x32_bf16 v[36:39], v[176:179], a[148:151], v[36:39]
    v_mfma_f32_16x16x32_bf16 v[36:39], v[172:175], a[132:135], v[36:39]
    v_mfma_f32_16x16x32_bf16 v[40:43], v[172:175], a[136:139], v[40:43]
    v_mfma_f32_16x16x32_bf16 v[40:43], v[176:179], a[152:155], v[40:43]
    buffer_load_dwordx4 v[168:171], v5, s[8:11], s17 offen offset:3072 sc1
    v_mfma_f32_16x16x32_bf16 v[44:47], v[176:179], a[156:159], v[44:47]
    v_mfma_f32_16x16x32_bf16 v[44:47], v[172:175], a[140:143], v[44:47]
    s_waitcnt vmcnt(15)
    v_mfma_f32_16x16x32_bf16 v[44:47], v[180:183], a[172:175], v[44:47]
    v_mfma_f32_16x16x32_bf16 v[44:47], v[184:187], a[188:191], v[44:47]
    buffer_load_dwordx4 v[172:175], v6, s[8:11], s17 offen offset:0 sc1
    v_mfma_f32_16x16x32_bf16 v[40:43], v[184:187], a[184:187], v[40:43]
    v_mfma_f32_16x16x32_bf16 v[40:43], v[180:183], a[168:171], v[40:43]
    v_mfma_f32_16x16x32_bf16 v[36:39], v[180:183], a[164:167], v[36:39]
    v_mfma_f32_16x16x32_bf16 v[36:39], v[184:187], a[180:183], v[36:39]
    buffer_load_dwordx4 v[176:179], v6, s[8:11], s17 offen offset:1024 sc1
    v_mfma_f32_16x16x32_bf16 v[32:35], v[184:187], a[176:179], v[32:35]
    v_mfma_f32_16x16x32_bf16 v[32:35], v[180:183], a[160:163], v[32:35]
    s_waitcnt vmcnt(15)
    v_mfma_f32_16x16x32_bf16 v[32:35], v[188:191], a[192:195], v[32:35]
    v_mfma_f32_16x16x32_bf16 v[32:35], v[192:195], a[208:211], v[32:35]
    buffer_load_dwordx4 v[180:183], v6, s[8:11], s17 offen offset:2048 sc1
    v_mfma_f32_16x16x32_bf16 v[36:39], v[192:195], a[212:215], v[36:39]
    v_mfma_f32_16x16x32_bf16 v[36:39], v[188:191], a[196:199], v[36:39]
    v_mfma_f32_16x16x32_bf16 v[40:43], v[188:191], a[200:203], v[40:43]
    v_mfma_f32_16x16x32_bf16 v[40:43], v[192:195], a[216:219], v[40:43]
    buffer_load_dwordx4 v[184:187], v6, s[8:11], s17 offen offset:3072 sc1
    v_mfma_f32_16x16x32_bf16 v[44:47], v[192:195], a[220:223], v[44:47]
    v_mfma_f32_16x16x32_bf16 v[44:47], v[188:191], a[204:207], v[44:47]
    s_waitcnt vmcnt(15)
    v_mfma_f32_16x16x32_bf16 v[44:47], v[196:199], a[236:239], v[44:47]
    v_mfma_f32_16x16x32_bf16 v[44:47], v[200:203], a[252:255], v[44:47]
    buffer_load_dwordx4 v[188:191], v7, s[8:11], s17 offen offset:0 sc1
    v_mfma_f32_16x16x32_bf16 v[40:43], v[200:203], a[248:251], v[40:43]
    v_mfma_f32_16x16x32_bf16 v[40:43], v[196:199], a[232:235], v[40:43]
    v_mfma_f32_16x16x32_bf16 v[36:39], v[196:199], a[228:231], v[36:39]
    v_mfma_f32_16x16x32_bf16 v[36:39], v[200:203], a[244:247], v[36:39]
    buffer_load_dwordx4 v[192:195], v7, s[8:11], s17 offen offset:1024 sc1
    v_mfma_f32_16x16x32_bf16 v[32:35], v[200:203], a[240:243], v[32:35]
    v_mfma_f32_16x16x32_bf16 v[32:35], v[196:199], a[224:227], v[32:35]
    s_waitcnt vmcnt(14)
    v_mfma_f32_16x16x32_bf16 v[32:35], v[204:207], v[108:111], v[32:35]
    v_mfma_f32_16x16x32_bf16 v[48:51], v[208:211], v[124:127], v[32:35]
    buffer_load_dwordx4 v[196:199], v7, s[8:11], s17 offen offset:2048 sc1
    v_mfma_f32_16x16x32_bf16 v[36:39], v[208:211], v[128:131], v[36:39]
    v_mfma_f32_16x16x32_bf16 v[52:55], v[204:207], v[112:115], v[36:39]
    v_mfma_f32_16x16x32_bf16 v[40:43], v[204:207], v[116:119], v[40:43]
    v_cmp_ne_u32_e64 vcc, 32, v25
    v_mfma_f32_16x16x32_bf16 v[56:59], v[208:211], v[132:135], v[40:43]
    buffer_load_dwordx4 v[200:203], v7, s[8:11], s17 offen offset:3072 sc1
    s_cbranch_vccnz L_k3_slow3
L_k3_back3:
    v_mfma_f32_16x16x32_bf16 v[44:47], v[208:211], v[136:139], v[44:47]
    v_mfma_f32_16x16x32_bf16 v[60:63], v[204:207], v[120:123], v[44:47]
    s_mov_b32 s16, s17
    s_add_u32 s17, s18, 589824
    s_mov_b32 s19, s4
    s_mov_b32 s31, 400000
    s_waitcnt lgkmcnt(0)
    s_barrier
    s_waitcnt vmcnt(14)
    v_mfma_f32_16x16x32_bf16 v[32:35], v[140:143], a[0:3], 0
    ds_read_b32 v20, v28 offset:0
    v_mfma_f32_16x16x32_bf16 v[32:35], v[144:147], a[16:19], v[32:35]
    buffer_load_dwordx4 v[204:207], v8, s[8:11], s16 offen offset:0 sc1
    ds_read_b32 v21, v28 offset:64
    v_mfma_f32_16x16x32_bf16 v[36:39], v[144:147], a[20:23], 0
    ds_read_b32 v22, v28 offset:128
    v_mfma_f32_16x16x32_bf16 v[36:39], v[140:143], a[4:7], v[36:39]
    ds_read_b32 v23, v28 offset:192
    v_mfma_f32_16x16x32_bf16 v[40:43], v[140:143], a[8:11], 0
    v_mfma_f32_16x16x32_bf16 v[40:43], v[144:147], a[24:27], v[40:43]
    buffer_load_dwordx4 v[208:211], v8, s[8:11], s16 offen offset:1024 sc1
    v_mfma_f32_16x16x32_bf16 v[44:47], v[144:147], a[28:31], 0
    v_mfma_f32_16x16x32_bf16 v[44:47], v[140:143], a[12:15], v[44:47]
    s_waitcnt vmcnt(14)
    ds_read_b128 a[0:3], v18 offset:0
    v_mfma_f32_16x16x32_bf16 v[44:47], v[148:151], a[44:47], v[44:47]
    v_cvt_pk_bf16_f32 v64, v48, v49
    ds_read_b128 a[4:7], v18 offset:1024
    v_mfma_f32_16x16x32_bf16 v[44:47], v[152:155], a[60:63], v[44:47]
    buffer_load_dwordx4 v[140:143], v4, s[8:11], s17 offen offset:0 sc1
    v_cvt_pk_bf16_f32 v65, v50, v51
    v_mfma_f32_16x16x32_bf16 v[40:43], v[152:155], a[56:59], v[40:43]
    v_pk_max_i16 v64, v64, 0
    ds_read_b128 a[8:11], v18 offset:2048
    v_mfma_f32_16x16x32_bf16 v[40:43], v[148:151], a[40:43], v[40:43]
    v_pk_max_i16 v65, v65, 0
    ds_read_b128 a[12:15], v18 offset:3072
    v_mfma_f32_16x16x32_bf16 v[36:39], v[148:151], a[36:39], v[36:39]
    ds_write_b64 v14, v[64:65]
    v_mfma_f32_16x16x32_bf16 v[36:39], v[152:155], a[52:55], v[36:39]
    buffer_load_dwordx4 v[144:147], v4, s[8:11], s17 offen offset:1024 sc1
    v_add_u32 v14, 8192, v14
    ds_read_b128 a[16:19], v18 offset:4096
    v_mfma_f32_16x16x32_bf16 v[32:35], v[152:155], a[48:51], v[32:35]
    v_cvt_pk_bf16_f32 v66, v52, v53
    v_mfma_f32_16x16x32_bf16 v[32:35], v[148:151], a[32:35], v[32:35]
    v_cvt_pk_bf16_f32 v67, v54, v55
    s_waitcnt vmcnt(14)
    ds_read_b128 a[20:23], v18 offset:5120
    v_mfma_f32_16x16x32_bf16 v[32:35], v[156:159], a[64:67], v[32:35]
    v_pk_max_i16 v66, v66, 0
    ds_read_b128 a[24:27], v18 offset:6144
    v_mfma_f32_16x16x32_bf16 v[32:35], v[160:163], a[80:83], v[32:35]
    buffer_load_dwordx4 v[148:151], v4, s[8:11], s17 offen offset:2048 sc1
    v_pk_max_i16 v67, v67, 0
    v_mfma_f32_16x16x32_bf16 v[36:39], v[160:163], a[84:87], v[36:39]
    ds_write_b64 v15, v[66:67]
    ds_read_b128 a[28:31], v18 offset:7168
    v_mfma_f32_16x16x32_bf16 v[36:39], v[156:159], a[68:71], v[36:39]
    v_add_u32 v15, 8192, v15
    v_mfma_f32_16x16x32_bf16 v[40:43], v[156:159], a[72:75], v[40:43]
    v_cvt_pk_bf16_f32 v68, v56, v57
    ds_read_b128 a[32:35], v18 offset:8192
    v_mfma_f32_16x16x32_bf16 v[40:43], v[160:163], a[88:91], v[40:43]
    buffer_load_dwordx4 v[152:155], v4, s[8:11], s17 offen offset:3072 sc1
    v_cvt_pk_bf16_f32 v69, v58, v59
    ds_read_b128 a[36:39], v18 offset:9216
    v_mfma_f32_16x16x32_bf16 v[44:47], v[160:163], a[92:95], v[44:47]
    v_pk_max_i16 v68, v68, 0
    v_mfma_f32_16x16x32_bf16 v[44:47], v[156:159], a[76:79], v[44:47]
    v_pk_max_i16 v69, v69, 0
    s_waitcnt vmcnt(14)
    ds_read_b128 a[40:43], v18 offset:10240
    v_mfma_f32_16x16x32_bf16 v[44:47], v[164:167], a[108:111], v[44:47]
    ds_write_b64 v16, v[68:69]
    ds_read_b128 a[44:47], v18 offset:11264
    v_mfma_f32_16x16x32_bf16 v[44:47], v[168:171], a[124:127], v[44:47]
    buffer_load_dwordx4 v[156:159], v5, s[8:11], s17 offen offset:0 sc1
    v_add_u32 v16, 8192, v16
    v_mfma_f32_16x16x32_bf16 v[40:43], v[168:171], a[120:123], v[40:43]
    v_cvt_pk_bf16_f32 v70, v60, v61
    ds_read_b128 a[48:51], v18 offset:12288
    v_mfma_f32_16x16x32_bf16 v[40:43], v[164:167], a[104:107], v[40:43]
    v_cvt_pk_bf16_f32 v71, v62, v63
    v_mfma_f32_16x16x32_bf16 v[36:39], v[164:167], a[100:103], v[36:39]
    v_pk_max_i16 v70, v70, 0
    ds_read_b128 a[52:55], v18 offset:13312
    v_mfma_f32_16x16x32_bf16 v[36:39], v[168:171], a[116:119], v[36:39]
    buffer_load_dwordx4 v[160:163], v5, s[8:11], s17 offen offset:1024 sc1
    v_pk_max_i16 v71, v71, 0
    ds_read_b128 a[56:59], v18 offset:14336
    v_mfma_f32_16x16x32_bf16 v[32:35], v[168:171], a[112:115], v[32:35]
    ds_write_b64 v17, v[70:71]
    v_mfma_f32_16x16x32_bf16 v[32:35], v[164:167], a[96:99], v[32:35]
    v_add_u32 v17, 8192, v17
    s_waitcnt vmcnt(14)
    ds_read_b128 a[60:63], v18 offset:15360
    v_mfma_f32_16x16x32_bf16 v[32:35], v[172:175], a[128:131], v[32:35]
    v_mfma_f32_16x16x32_bf16 v[32:35], v[176:179], a[144:147], v[32:35]
    buffer_load_dwordx4 v[164:167], v5, s[8:11], s17 offen offset:2048 sc1
    ds_read_b128 a[64:67], v18 offset:16384
    v_mfma_f32_16x16x32_bf16 v[36:39], v[176:179], a[148:151], v[36:39]
    ds_read_b128 a[68:71], v18 offset:17408
    v_mfma_f32_16x16x32_bf16 v[36:39], v[172:175], a[132:135], v[36:39]
    v_mfma_f32_16x16x32_bf16 v[40:43], v[172:175], a[136:139], v[40:43]
    ds_read_b128 a[72:75], v18 offset:18432
    v_mfma_f32_16x16x32_bf16 v[40:43], v[176:179], a[152:155], v[40:43]
    buffer_load_dwordx4 v[168:171], v5, s[8:11], s17 offen offset:3072 sc1
    ds_read_b128 a[76:79], v18 offset:19456
    v_mfma_f32_16x16x32_bf16 v[44:47], v[176:179], a[156:159], v[44:47]
    v_mfma_f32_16x16x32_bf16 v[44:47], v[172:175], a[140:143], v[44:47]
    s_waitcnt vmcnt(14)
    ds_read_b128 a[80:83], v18 offset:20480
    v_mfma_f32_16x16x32_bf16 v[44:47], v[180:183], a[172:175], v[44:47]
    v_mfma_f32_16x16x32_bf16 v[44:47], v[184:187], a[188:191], v[44:47]
    buffer_load_dwordx4 v[172:175], v6, s[8:11], s17 offen offset:0 sc1
    ds_read_b128 a[84:87], v18 offset:21504
    v_mfma_f32_16x16x32_bf16 v[40:43], v[184:187], a[184:187], v[40:43]
    ds_read_b128 a[88:91], v18 offset:22528
    v_mfma_f32_16x16x32_bf16 v[40:43], v[180:183], a[168:171], v[40:43]
    v_mfma_f32_16x16x32_bf16 v[36:39], v[180:183], a[164:167], v[36:39]
    ds_read_b128 a[92:95], v18 offset:23552
    v_mfma_f32_16x16x32_bf16 v[36:39], v[184:187], a[180:183], v[36:39]
    buffer_load_dwordx4 v[176:179], v6, s[8:11], s17 offen offset:1024 sc1
    v_mfma_f32_16x16x32_bf16 v[32:35], v[184:187], a[176:179], v[32:35]
    ds_read_b128 a[96:99], v18 offset:24576
    v_mfma_f32_16x16x32_bf16 v[32:35], v[180:183], a[160:163], v[32:35]
    s_waitcnt vmcnt(14)
    ds_read_b128 a[100:103], v18 offset:25600
    v_mfma_f32_16x16x32_bf16 v[32:35], v[188:191], a[192:195], v[32:35]
    v_mfma_f32_16x16x32_bf16 v[32:35], v[192:195], a[208:211], v[32:35]
    buffer_load_dwordx4 v[180:183], v6, s[8:11], s17 offen offset:2048 sc1
    ds_read_b128 a[104:107], v18 offset:26624
    v_mfma_f32_16x16x32_bf16 v[36:39], v[192:195], a[212:215], v[36:39]
    ds_read_b128 a[108:111], v18 offset:27648
    v_mfma_f32_16x16x32_bf16 v[36:39], v[188:191], a[196:199], v[36:39]
    v_mfma_f32_16x16x32_bf16 v[40:43], v[188:191], a[200:203], v[40:43]
    ds_read_b128 a[112:115], v18 offset:28672
    v_mfma_f32_16x16x32_bf16 v[40:43], v[192:195], a[216:219], v[40:43]
    buffer_load_dwordx4 v[184:187], v6, s[8:11], s17 offen offset:3072 sc1
    v_mfma_f32_16x16x32_bf16 v[44:47], v[192:195], a[220:223], v[44:47]
    ds_read_b128 a[116:119], v18 offset:29696
    v_mfma_f32_16x16x32_bf16 v[44:47], v[188:191], a[204:207], v[44:47]
    s_waitcnt lgkmcnt(15)
    s_barrier
    s_waitcnt vmcnt(14)
    ds_read_b128 a[120:123], v18 offset:30720
    v_mfma_f32_16x16x32_bf16 v[44:47], v[196:199], a[236:239], v[44:47]
    v_mfma_f32_16x16x32_bf16 v[44:47], v[200:203], a[252:255], v[44:47]
    buffer_load_dwordx4 v[188:191], v7, s[8:11], s17 offen offset:0 sc1
    ds_read_b128 a[124:127], v18 offset:31744
    v_mfma_f32_16x16x32_bf16 v[40:43], v[200:203], a[248:251], v[40:43]
    v_mfma_f32_16x16x32_bf16 v[40:43], v[196:199], a[232:235], v[40:43]
    ds_read_b128 a[128:131], v18 offset:32768
    v_mfma_f32_16x16x32_bf16 v[36:39], v[196:199], a[228:231], v[36:39]
    ds_read_b128 a[132:135], v18 offset:33792
    v_mfma_f32_16x16x32_bf16 v[36:39], v[200:203], a[244:247], v[36:39]
    buffer_load_dwordx4 v[192:195], v7, s[8:11], s17 offen offset:1024 sc1
    v_mfma_f32_16x16x32_bf16 v[32:35], v[200:203], a[240:243], v[32:35]
    ds_read_b128 a[136:139], v18 offset:34816
    v_mfma_f32_16x16x32_bf16 v[32:35], v[196:199], a[224:227], v[32:35]
    s_waitcnt vmcnt(14)
    ds_read_b128 a[140:143], v18 offset:35840
    v_mfma_f32_16x16x32_bf16 v[32:35], v[204:207], v[108:111], v[32:35]
    v_mfma_f32_16x16x32_bf16 v[48:51], v[208:211], v[124:127], v[32:35]
    buffer_load_dwordx4 v[196:199], v7, s[8:11], s17 offen offset:2048 sc1
    ds_read_b128 a[144:147], v19 offset:0
    v_mfma_f32_16x16x32_bf16 v[36:39], v[208:211], v[128:131], v[36:39]
    v_mfma_f32_16x16x32_bf16 v[52:55], v[204:207], v[112:115], v[36:39]
    ds_read_b128 a[148:151], v19 offset:1024
    v_mfma_f32_16x16x32_bf16 v[40:43], v[204:207], v[116:119], v[40:43]
    ds_read_b128 a[152:155], v19 offset:2048
    v_mfma_f32_16x16x32_bf16 v[56:59], v[208:211], v[132:135], v[40:43]
    buffer_load_dwordx4 v[200:203], v7, s[8:11], s17 offen offset:3072 sc1
    v_mfma_f32_16x16x32_bf16 v[44:47], v[208:211], v[136:139], v[44:47]
    ds_read_b128 a[156:159], v19 offset:3072
    v_mfma_f32_16x16x32_bf16 v[60:63], v[204:207], v[120:123], v[44:47]
    s_mov_b32 s16, s17
    s_add_u32 s19, s19, 1
    s_and_b32 s19, s19, 7
    s_mul_i32 s72, s19, 73728
    s_add_u32 s17, s18, s72
    s_waitcnt vmcnt(14)
    v_mfma_f32_16x16x32_bf16 v[32:35], v[140:143], a[0:3], 0
    s_lshl_b32 s73, s3, 5
    v_xor_b32 v10, s73, v10
    ds_read_b128 a[160:163], v19 offset:4096
    v_mfma_f32_16x16x32_bf16 v[32:35], v[144:147], a[16:19], v[32:35]
    buffer_load_dwordx4 v[204:207], v8, s[8:11], s16 offen offset:0 sc1
    v_xor_b32 v11, s73, v11
    v_xor_b32 v12, s73, v12
    ds_read_b128 a[164:167], v19 offset:5120
    v_mfma_f32_16x16x32_bf16 v[36:39], v[144:147], a[20:23], 0
    v_xor_b32 v13, s73, v13
    s_lshl_b32 s73, s3, 11
    v_mfma_f32_16x16x32_bf16 v[36:39], v[140:143], a[4:7], v[36:39]
    v_add_u32 v10, s73, v10
    v_add_u32 v11, s73, v11
    ds_read_b128 a[168:171], v19 offset:6144
    v_mfma_f32_16x16x32_bf16 v[40:43], v[140:143], a[8:11], 0
    v_add_u32_e64 v12, s73, v12
    v_add_u32_e64 v13, s73, v13
    ds_read_b128 a[172:175], v19 offset:7168
    v_mfma_f32_16x16x32_bf16 v[40:43], v[144:147], a[24:27], v[40:43]
    buffer_load_dwordx4 v[208:211], v8, s[8:11], s16 offen offset:1024 sc1
    ds_read_b64_tr_b16 v[72:73], v10
    ds_read_b64_tr_b16 v[74:75], v11
    v_mfma_f32_16x16x32_bf16 v[44:47], v[144:147], a[28:31], 0
    ds_read_b64_tr_b16 v[76:77], v12
    ds_read_b64_tr_b16 v[78:79], v13
    ds_read_b128 a[176:179], v19 offset:8192
    v_mfma_f32_16x16x32_bf16 v[44:47], v[140:143], a[12:15], v[44:47]
    s_waitcnt lgkmcnt(15)
    s_waitcnt vmcnt(14)
    v_mfma_f32_16x16x32_bf16 v[44:47], v[148:151], a[44:47], v[44:47]
    v_cvt_pk_bf16_f32 v64, v48, v49
    ds_read_b128 a[180:183], v19 offset:9216
    v_mfma_f32_16x16x32_bf16 v[44:47], v[152:155], a[60:63], v[44:47]
    buffer_load_dwordx4 v[140:143], v4, s[8:11], s17 offen offset:0 sc1
    v_cvt_pk_bf16_f32 v65, v50, v51
    ds_read_b128 a[184:187], v19 offset:10240
    v_mfma_f32_16x16x32_bf16 v[40:43], v[152:155], a[56:59], v[40:43]
    v_pk_max_i16 v64, v64, 0
    v_mfma_f32_16x16x32_bf16 v[40:43], v[148:151], a[40:43], v[40:43]
    v_pk_max_i16 v65, v65, 0
    ds_read_b128 a[188:191], v19 offset:11264
    v_mfma_f32_16x16x32_bf16 v[36:39], v[148:151], a[36:39], v[36:39]
    ds_write_b64 v14, v[64:65]
    v_mfma_f32_16x16x32_bf16 v[36:39], v[152:155], a[52:55], v[36:39]
    buffer_load_dwordx4 v[144:147], v4, s[8:11], s17 offen offset:1024 sc1
    v_add_u32 v14, 8192, v14
    ds_read_b128 a[192:195], v19 offset:12288
    v_mfma_f32_16x16x32_bf16 v[32:35], v[152:155], a[48:51], v[32:35]
    v_cvt_pk_bf16_f32 v66, v52, v53
    ds_read_b128 a[196:199], v19 offset:13312
    v_mfma_f32_16x16x32_bf16 v[32:35], v[148:151], a[32:35], v[32:35]
    v_cvt_pk_bf16_f32 v67, v54, v55
    s_waitcnt vmcnt(14)
    v_mfma_f32_16x16x32_bf16 v[32:35], v[156:159], a[64:67], v[32:35]
    v_pk_max_i16 v66, v66, 0
    ds_read_b128 a[200:203], v19 offset:14336
    v_mfma_f32_16x16x32_bf16 v[32:35], v[160:163], a[80:83], v[32:35]
    buffer_load_dwordx4 v[148:151], v4, s[8:11], s17 offen offset:2048 sc1
    v_pk_max_i16 v67, v67, 0
    ds_read_b128 a[204:207], v19 offset:15360
    v_mfma_f32_16x16x32_bf16 v[36:39], v[160:163], a[84:87], v[36:39]
    ds_write_b64 v15, v[66:67]
    v_mfma_f32_16x16x32_bf16 v[36:39], v[156:159], a[68:71], v[36:39]
    v_add_u32 v15, 8192, v15
    ds_read_b128 a[208:211], v19 offset:16384
    v_mfma_f32_16x16x32_bf16 v[40:43], v[156:159], a[72:75], v[40:43]
    v_cvt_pk_bf16_f32 v68, v56, v57
    v_mfma_f32_16x16x32_bf16 v[40:43], v[160:163], a[88:91], v[40:43]
    buffer_load_dwordx4 v[152:155], v4, s[8:11], s17 offen offset:3072 sc1
    v_cvt_pk_bf16_f32 v69, v58, v59
    ds_read_b128 a[212:215], v19 offset:17408
    v_mfma_f32_16x16x32_bf16 v[44:47], v[160:163], a[92:95], v[44:47]
    v_pk_max_i16 v68, v68, 0
    ds_read_b128 a[216:219], v19 offset:18432
    v_mfma_f32_16x16x32_bf16 v[44:47], v[156:159], a[76:79], v[44:47]
    v_pk_max_i16 v69, v69, 0
    s_waitcnt vmcnt(14)
    v_mfma_f32_16x16x32_bf16 v[44:47], v[164:167], a[108:111], v[44:47]
    ds_write_b64 v16, v[68:69]
    ds_read_b128 a[220:223], v19 offset:19456
    v_mfma_f32_16x16x32_bf16 v[44:47], v[168:171], a[124:127], v[44:47]
    buffer_load_dwordx4 v[156:159], v5, s[8:11], s17 offen offset:0 sc1
    v_add_u32 v16, 8192, v16
    v_mfma_f32_16x16x32_bf16 v[40:43], v[168:171], a[120:123], v[40:43]
    v_cvt_pk_bf16_f32 v70, v60, v61
    ds_read_b128 a[224:227], v19 offset:20480
    v_mfma_f32_16x16x32_bf16 v[40:43], v[164:167], a[104:107], v[40:43]
    v_cvt_pk_bf16_f32 v71, v62, v63
    ds_read_b128 a[228:231], v19 offset:21504
    v_mfma_f32_16x16x32_bf16 v[36:39], v[164:167], a[100:103], v[36:39]
    v_pk_max_i16 v70, v70, 0
    v_mfma_f32_16x16x32_bf16 v[36:39], v[168:171], a[116:119], v[36:39]
    buffer_load_dwordx4 v[160:163], v5, s[8:11], s17 offen offset:1024 sc1
    v_pk_max_i16 v71, v71, 0
    ds_read_b128 a[232:235], v19 offset:22528
    v_mfma_f32_16x16x32_bf16 v[32:35], v[168:171], a[112:115], v[32:35]
    ds_write_b64 v17, v[70:71]
    ds_read_b128 a[236:239], v19 offset:23552
    v_mfma_f32_16x16x32_bf16 v[32:35], v[164:167], a[96:99], v[32:35]
    v_add_u32 v17, 8192, v17
    s_waitcnt lgkmcnt(15)
    s_waitcnt vmcnt(14)
    v_mfma_f32_16x16x32_bf16 v[32:35], v[172:175], a[128:131], v[32:35]
    ds_read_b128 a[240:243], v19 offset:24576
    v_mfma_f32_16x16x32_bf16 v[32:35], v[176:179], a[144:147], v[32:35]
    buffer_load_dwordx4 v[164:167], v5, s[8:11], s17 offen offset:2048 sc1
    v_mfma_f32_16x16x32_bf16 v[36:39], v[176:179], a[148:151], v[36:39]
    ds_read_b128 a[244:247], v19 offset:25600
    v_mfma_f32_16x16x32_bf16 v[36:39], v[172:175], a[132:135], v[36:39]
    ds_read_b128 a[248:251], v19 offset:26624
    v_mfma_f32_16x16x32_bf16 v[40:43], v[172:175], a[136:139], v[40:43]
    v_mfma_f32_16x16x32_bf16 v[40:43], v[176:179], a[152:155], v[40:43]
    buffer_load_dwordx4 v[168:171], v5, s[8:11], s17 offen offset:3072 sc1
    ds_read_b128 a[252:255], v19 offset:27648
    v_mfma_f32_16x16x32_bf16 v[44:47], v[176:179], a[156:159], v[44:47]
    v_mfma_f32_16x16x32_bf16 v[44:47], v[172:175], a[140:143], v[44:47]
    s_waitcnt lgkmcnt(5)
    s_barrier
    s_waitcnt vmcnt(14)
    v_mfma_f32_16x16x32_bf16 v[44:47], v[180:183], a[172:175], v[44:47]
    ds_read_b128 v[108:111], v19 offset:28672
    v_mfma_f32_16x16x32_bf16 v[44:47], v[184:187], a[188:191], v[44:47]
    buffer_load_dwordx4 v[172:175], v6, s[8:11], s17 offen offset:0 sc1
    ds_read_b128 v[112:115], v19 offset:29696
    v_mfma_f32_16x16x32_bf16 v[40:43], v[184:187], a[184:187], v[40:43]
    ds_read_b128 v[116:119], v19 offset:30720
    v_mfma_f32_16x16x32_bf16 v[40:43], v[180:183], a[168:171], v[40:43]
    ds_read_b128 v[120:123], v19 offset:31744
    v_mfma_f32_16x16x32_bf16 v[36:39], v[180:183], a[164:167], v[36:39]
    ds_read_b128 v[124:127], v19 offset:32768
    v_mfma_f32_16x16x32_bf16 v[36:39], v[184:187], a[180:183], v[36:39]
    buffer_load_dwordx4 v[176:179], v6, s[8:11], s17 offen offset:1024 sc1
    ds_read_b128 v[128:131], v19 offset:33792
    v_mfma_f32_16x16x32_bf16 v[32:35], v[184:187], a[176:179], v[32:35]
    ds_read_b128 v[132:135], v19 offset:34816
    v_mfma_f32_16x16x32_bf16 v[32:35], v[180:183], a[160:163], v[32:35]
    ds_read_b128 v[136:139], v19 offset:35840
    s_waitcnt vmcnt(14)
    v_mfma_f32_16x16x32_bf16 v[32:35], v[188:191], a[192:195], v[32:35]
    v_lshlrev_b32_e64 v80, 16, v72
    v_and_b32 v81, 0xffff0000, v72
    v_mfma_f32_16x16x32_bf16 v[32:35], v[192:195], a[208:211], v[32:35]
    buffer_load_dwordx4 v[180:183], v6, s[8:11], s17 offen offset:2048 sc1
    v_lshlrev_b32_e64 v82, 16, v73
    v_and_b32 v83, 0xffff0000, v73
    v_mfma_f32_16x16x32_bf16 v[36:39], v[192:195], a[212:215], v[36:39]
    v_lshlrev_b32_e64 v84, 16, v74
    v_and_b32 v85, 0xffff0000, v74
    v_mfma_f32_16x16x32_bf16 v[36:39], v[188:191], a[196:199], v[36:39]
    v_lshlrev_b32 v86, 16, v75
    v_and_b32 v87, 0xffff0000, v75
    v_mfma_f32_16x16x32_bf16 v[40:43], v[188:191], a[200:203], v[40:43]
    v_lshlrev_b32 v88, 16, v76
    v_and_b32 v89, 0xffff0000, v76
    v_mfma_f32_16x16x32_bf16 v[40:43], v[192:195], a[216:219], v[40:43]
    buffer_load_dwordx4 v[184:187], v6, s[8:11], s17 offen offset:3072 sc1
    v_lshlrev_b32_e64 v90, 16, v77
    v_and_b32 v91, 0xffff0000, v77
    v_mfma_f32_16x16x32_bf16 v[44:47], v[192:195], a[220:223], v[44:47]
    v_lshlrev_b32_e64 v92, 16, v78
    v_and_b32 v93, 0xffff0000, v78
    v_mfma_f32_16x16x32_bf16 v[44:47], v[188:191], a[204:207], v[44:47]
    v_lshlrev_b32_e64 v94, 16, v79
    v_and_b32 v95, 0xffff0000, v79
    s_waitcnt lgkmcnt(8)
    s_waitcnt vmcnt(14)
    v_mfma_f32_16x16x32_bf16 v[44:47], v[196:199], a[236:239], v[44:47]
    v_mul_f32 v80, s30, v80
    v_mul_f32 v81, s30, v81
    v_mfma_f32_16x16x32_bf16 v[44:47], v[200:203], a[252:255], v[44:47]
    buffer_load_dwordx4 v[188:191], v7, s[8:11], s17 offen offset:0 sc1
    v_mul_f32 v82, s30, v82
    v_mul_f32 v83, s30, v83
    v_mfma_f32_16x16x32_bf16 v[40:43], v[200:203], a[248:251], v[40:43]
    v_mul_f32 v84, s30, v84
    v_mul_f32 v85, s30, v85
    v_mfma_f32_16x16x32_bf16 v[40:43], v[196:199], a[232:235], v[40:43]
    v_mul_f32 v86, s30, v86
    v_mul_f32 v87, s30, v87
    v_mfma_f32_16x16x32_bf16 v[36:39], v[196:199], a[228:231], v[36:39]
    v_mul_f32 v88, s30, v88
    v_mul_f32 v89, s30, v89
    v_mfma_f32_16x16x32_bf16 v[36:39], v[200:203], a[244:247], v[36:39]
    buffer_load_dwordx4 v[192:195], v7, s[8:11], s17 offen offset:1024 sc1
    v_mul_f32 v90, s30, v90
    v_mul_f32 v91, s30, v91
    v_mfma_f32_16x16x32_bf16 v[32:35], v[200:203], a[240:243], v[32:35]
    v_mul_f32_e64 v92, s30, v92
    v_mul_f32_e64 v93, s30, v93
    v_mfma_f32_16x16x32_bf16 v[32:35], v[196:199], a[224:227], v[32:35]
    v_mul_f32_e64 v94, s30, v94
    v_mul_f32_e64 v95, s30, v95
    s_waitcnt lgkmcnt(0)
    s_waitcnt vmcnt(14)
    v_mfma_f32_16x16x32_bf16 v[32:35], v[204:207], v[108:111], v[32:35]
    v_mfma_f32_16x16x32_bf16 v[48:51], v[208:211], v[124:127], v[32:35]
    buffer_load_dwordx4 v[196:199], v7, s[8:11], s17 offen offset:2048 sc1
    v_mfma_f32_16x16x32_bf16 v[36:39], v[208:211], v[128:131], v[36:39]
    v_mfma_f32_16x16x32_bf16 v[52:55], v[204:207], v[112:115], v[36:39]
    v_mfma_f32_16x16x32_bf16 v[40:43], v[204:207], v[116:119], v[40:43]
    v_mfma_f32_16x16x32_bf16 v[56:59], v[208:211], v[132:135], v[40:43]
    buffer_load_dwordx4 v[200:203], v7, s[8:11], s17 offen offset:3072 sc1
    v_mfma_f32_16x16x32_bf16 v[44:47], v[208:211], v[136:139], v[44:47]
    v_mfma_f32_16x16x32_bf16 v[60:63], v[204:207], v[120:123], v[44:47]
    s_mov_b32 s16, s17
    s_barrier
    s_add_u32 s19, s19, 1
    s_and_b32 s19, s19, 7
    s_mul_i32 s72, s19, 73728
    s_add_u32 s17, s18, s72
    s_waitcnt vmcnt(14)
    v_mfma_f32_16x16x32_bf16 v[32:35], v[140:143], a[0:3], 0
    s_lshl_b32 s73, s4, 13
    s_sub_u32 s73, s73, 65536
    v_mfma_f32_16x16x32_bf16 v[32:35], v[144:147], a[16:19], v[32:35]
    buffer_load_dwordx4 v[204:207], v8, s[8:11], s16 offen offset:0 sc1
    v_add_u32 v10, s73, v10
    v_add_u32_e64 v11, s73, v11
    v_mfma_f32_16x16x32_bf16 v[36:39], v[144:147], a[20:23], 0
    v_add_u32_e64 v12, s73, v12
    v_add_u32_e64 v13, s73, v13
    v_mfma_f32_16x16x32_bf16 v[36:39], v[140:143], a[4:7], v[36:39]
    ds_read_b64_tr_b16 v[72:73], v10
    ds_read_b64_tr_b16 v[74:75], v11
    v_mfma_f32_16x16x32_bf16 v[40:43], v[140:143], a[8:11], 0
    ds_read_b64_tr_b16 v[76:77], v12
    ds_read_b64_tr_b16 v[78:79], v13
    v_mfma_f32_16x16x32_bf16 v[40:43], v[144:147], a[24:27], v[40:43]
    buffer_load_dwordx4 v[208:211], v8, s[8:11], s16 offen offset:1024 sc1
    v_mfma_f32_16x16x32_bf16 v[44:47], v[144:147], a[28:31], 0
    v_mfma_f32_16x16x32_bf16 v[44:47], v[140:143], a[12:15], v[44:47]
    s_waitcnt vmcnt(14)
    v_mfma_f32_16x16x32_bf16 v[44:47], v[148:151], a[44:47], v[44:47]
    v_fma_f32 v48, v48, v20, v80
    v_fma_f32 v49, v49, v20, v81
    v_mfma_f32_16x16x32_bf16 v[44:47], v[152:155], a[60:63], v[44:47]
    buffer_load_dwordx4 v[140:143], v4, s[8:11], s17 offen offset:0 sc1
    v_fma_f32 v50, v50, v20, v82
    v_fma_f32 v51, v51, v20, v83
    v_mfma_f32_16x16x32_bf16 v[40:43], v[152:155], a[56:59], v[40:43]
    v_cvt_pk_bf16_f32 v64, v48, v49
    v_cvt_pk_bf16_f32 v65, v50, v51
    v_mfma_f32_16x16x32_bf16 v[40:43], v[148:151], a[40:43], v[40:43]
    ds_write_b64 v217, v[64:65] offset:0
    v_fma_f32 v52, v52, v21, v84
    v_mfma_f32_16x16x32_bf16 v[36:39], v[148:151], a[36:39], v[36:39]
    v_fma_f32 v53, v53, v21, v85
    v_fma_f32 v54, v54, v21, v86
    v_mfma_f32_16x16x32_bf16 v[36:39], v[152:155], a[52:55], v[36:39]
    buffer_load_dwordx4 v[144:147], v4, s[8:11], s17 offen offset:1024 sc1
    v_fma_f32 v55, v55, v21, v87
    v_cvt_pk_bf16_f32 v66, v52, v53
    v_mfma_f32_16x16x32_bf16 v[32:35], v[152:155], a[48:51], v[32:35]
    v_cvt_pk_bf16_f32 v67, v54, v55
    ds_write_b64 v217, v[66:67] offset:2048
    v_mfma_f32_16x16x32_bf16 v[32:35], v[148:151], a[32:35], v[32:35]
    v_fma_f32 v56, v56, v22, v88
    v_fma_f32 v57, v57, v22, v89
    s_waitcnt vmcnt(14)
    v_mfma_f32_16x16x32_bf16 v[32:35], v[156:159], a[64:67], v[32:35]
    v_fma_f32 v58, v58, v22, v90
    v_fma_f32 v59, v59, v22, v91
    v_mfma_f32_16x16x32_bf16 v[32:35], v[160:163], a[80:83], v[32:35]
    buffer_load_dwordx4 v[148:151], v4, s[8:11], s17 offen offset:2048 sc1
    v_cvt_pk_bf16_f32 v68, v56, v57
    v_cvt_pk_bf16_f32 v69, v58, v59
    v_mfma_f32_16x16x32_bf16 v[36:39], v[160:163], a[84:87], v[36:39]
    ds_write_b64 v217, v[68:69] offset:4096
    v_fma_f32 v60, v60, v23, v92
    v_mfma_f32_16x16x32_bf16 v[36:39], v[156:159], a[68:71], v[36:39]
    v_fma_f32 v61, v61, v23, v93
    v_fma_f32 v62, v62, v23, v94
    v_mfma_f32_16x16x32_bf16 v[40:43], v[156:159], a[72:75], v[40:43]
    v_fma_f32 v63, v63, v23, v95
    v_cvt_pk_bf16_f32 v70, v60, v61
    v_mfma_f32_16x16x32_bf16 v[40:43], v[160:163], a[88:91], v[40:43]
    buffer_load_dwordx4 v[152:155], v4, s[8:11], s17 offen offset:3072 sc1
    v_cvt_pk_bf16_f32 v71, v62, v63
    ds_write_b64 v217, v[70:71] offset:6144
    v_mfma_f32_16x16x32_bf16 v[44:47], v[160:163], a[92:95], v[44:47]
    s_waitcnt lgkmcnt(4)
    v_lshlrev_b32 v80, 16, v72
    v_and_b32 v81, 0xffff0000, v72
    v_mfma_f32_16x16x32_bf16 v[44:47], v[156:159], a[76:79], v[44:47]
    v_lshlrev_b32 v82, 16, v73
    v_and_b32 v83, 0xffff0000, v73
    s_waitcnt vmcnt(14)
    v_mfma_f32_16x16x32_bf16 v[44:47], v[164:167], a[108:111], v[44:47]
    v_lshlrev_b32 v84, 16, v74
    v_and_b32 v85, 0xffff0000, v74
    v_mfma_f32_16x16x32_bf16 v[44:47], v[168:171], a[124:127], v[44:47]
    buffer_load_dwordx4 v[156:159], v5, s[8:11], s17 offen offset:0 sc1
    v_lshlrev_b32 v86, 16, v75
    v_and_b32 v87, 0xffff0000, v75
    v_mfma_f32_16x16x32_bf16 v[40:43], v[168:171], a[120:123], v[40:43]
    v_lshlrev_b32_e64 v88, 16, v76
    v_and_b32 v89, 0xffff0000, v76
    v_mfma_f32_16x16x32_bf16 v[40:43], v[164:167], a[104:107], v[40:43]
    v_lshlrev_b32_e64 v90, 16, v77
    v_and_b32 v91, 0xffff0000, v77
    v_mfma_f32_16x16x32_bf16 v[36:39], v[164:167], a[100:103], v[36:39]
    v_lshlrev_b32_e64 v92, 16, v78
    v_and_b32 v93, 0xffff0000, v78
    v_mfma_f32_16x16x32_bf16 v[36:39], v[168:171], a[116:119], v[36:39]
    buffer_load_dwordx4 v[160:163], v5, s[8:11], s17 offen offset:1024 sc1
    v_lshlrev_b32 v94, 16, v79
    v_and_b32 v95, 0xffff0000, v79
    v_mfma_f32_16x16x32_bf16 v[32:35], v[168:171], a[112:115], v[32:35]
    v_mfma_f32_16x16x32_bf16 v[32:35], v[164:167], a[96:99], v[32:35]
    s_waitcnt lgkmcnt(0)
    s_barrier
    s_waitcnt vmcnt(14)
    v_mfma_f32_16x16x32_bf16 v[32:35], v[172:175], a[128:131], v[32:35]
    ds_read_b128 v[64:67], v218 offset:0
    v_mfma_f32_16x16x32_bf16 v[32:35], v[176:179], a[144:147], v[32:35]
    buffer_load_dwordx4 v[164:167], v5, s[8:11], s17 offen offset:2048 sc1
    ds_read_b128 v[68:71], v218 offset:1024
    v_mfma_f32_16x16x32_bf16 v[36:39], v[176:179], a[148:151], v[36:39]
    s_mov_b32 s74, 524288
    v_mfma_f32_16x16x32_bf16 v[36:39], v[172:175], a[132:135], v[36:39]
    v_mfma_f32_16x16x32_bf16 v[40:43], v[172:175], a[136:139], v[40:43]
    v_mfma_f32_16x16x32_bf16 v[40:43], v[176:179], a[152:155], v[40:43]
    buffer_load_dwordx4 v[168:171], v5, s[8:11], s17 offen offset:3072 sc1
    v_mfma_f32_16x16x32_bf16 v[44:47], v[176:179], a[156:159], v[44:47]
    v_mfma_f32_16x16x32_bf16 v[44:47], v[172:175], a[140:143], v[44:47]
    s_waitcnt vmcnt(14)
    v_mfma_f32_16x16x32_bf16 v[44:47], v[180:183], a[172:175], v[44:47]
    s_waitcnt lgkmcnt(0)
    buffer_store_dwordx4 v[64:67], v212, s[8:11], s74 offen offset:0 sc1
    v_mfma_f32_16x16x32_bf16 v[44:47], v[184:187], a[188:191], v[44:47]
    buffer_load_dwordx4 v[172:175], v6, s[8:11], s17 offen offset:0 sc1
    buffer_store_dwordx4 v[68:71], v212, s[8:11], s74 offen offset:1024 sc1
    v_mfma_f32_16x16x32_bf16 v[40:43], v[184:187], a[184:187], v[40:43]
    v_mfma_f32_16x16x32_bf16 v[40:43], v[180:183], a[168:171], v[40:43]
    v_mfma_f32_16x16x32_bf16 v[36:39], v[180:183], a[164:167], v[36:39]
    v_mfma_f32_16x16x32_bf16 v[36:39], v[184:187], a[180:183], v[36:39]
    buffer_load_dwordx4 v[176:179], v6, s[8:11], s17 offen offset:1024 sc1
    v_mfma_f32_16x16x32_bf16 v[32:35], v[184:187], a[176:179], v[32:35]
    v_mfma_f32_16x16x32_bf16 v[32:35], v[180:183], a[160:163], v[32:35]
    s_waitcnt vmcnt(16)
    v_mfma_f32_16x16x32_bf16 v[32:35], v[188:191], a[192:195], v[32:35]
    v_mfma_f32_16x16x32_bf16 v[32:35], v[192:195], a[208:211], v[32:35]
    buffer_load_dwordx4 v[180:183], v6, s[8:11], s17 offen offset:2048 sc1
    v_mfma_f32_16x16x32_bf16 v[36:39], v[192:195], a[212:215], v[36:39]
    v_mfma_f32_16x16x32_bf16 v[36:39], v[188:191], a[196:199], v[36:39]
    v_mfma_f32_16x16x32_bf16 v[40:43], v[188:191], a[200:203], v[40:43]
    v_mfma_f32_16x16x32_bf16 v[40:43], v[192:195], a[216:219], v[40:43]
    buffer_load_dwordx4 v[184:187], v6, s[8:11], s17 offen offset:3072 sc1
    v_mfma_f32_16x16x32_bf16 v[44:47], v[192:195], a[220:223], v[44:47]
    v_mfma_f32_16x16x32_bf16 v[44:47], v[188:191], a[204:207], v[44:47]
    s_waitcnt vmcnt(16)
    v_mfma_f32_16x16x32_bf16 v[44:47], v[196:199], a[236:239], v[44:47]
    v_mfma_f32_16x16x32_bf16 v[44:47], v[200:203], a[252:255], v[44:47]
    buffer_load_dwordx4 v[188:191], v7, s[8:11], s17 offen offset:0 sc1
    v_mfma_f32_16x16x32_bf16 v[40:43], v[200:203], a[248:251], v[40:43]
    v_mfma_f32_16x16x32_bf16 v[40:43], v[196:199], a[232:235], v[40:43]
    v_mfma_f32_16x16x32_bf16 v[36:39], v[196:199], a[228:231], v[36:39]
    v_mfma_f32_16x16x32_bf16 v[36:39], v[200:203], a[244:247], v[36:39]
    buffer_load_dwordx4 v[192:195], v7, s[8:11], s17 offen offset:1024 sc1
    v_mfma_f32_16x16x32_bf16 v[32:35], v[200:203], a[240:243], v[32:35]
    v_mfma_f32_16x16x32_bf16 v[32:35], v[196:199], a[224:227], v[32:35]
    s_waitcnt vmcnt(16)
    v_mfma_f32_16x16x32_bf16 v[32:35], v[204:207], v[108:111], v[32:35]
    v_mfma_f32_16x16x32_bf16 v[48:51], v[208:211], v[124:127], v[32:35]
    buffer_load_dwordx4 v[196:199], v7, s[8:11], s17 offen offset:2048 sc1
    v_mfma_f32_16x16x32_bf16 v[36:39], v[208:211], v[128:131], v[36:39]
    v_mfma_f32_16x16x32_bf16 v[52:55], v[204:207], v[112:115], v[36:39]
    v_mfma_f32_16x16x32_bf16 v[40:43], v[204:207], v[116:119], v[40:43]
    v_mfma_f32_16x16x32_bf16 v[56:59], v[208:211], v[132:135], v[40:43]
    buffer_load_dwordx4 v[200:203], v7, s[8:11], s17 offen offset:3072 sc1
    v_mfma_f32_16x16x32_bf16 v[44:47], v[208:211], v[136:139], v[44:47]
    v_mfma_f32_16x16x32_bf16 v[60:63], v[204:207], v[120:123], v[44:47]
    s_mov_b32 s16, s17
    s_barrier
    s_add_u32 s19, s19, 1
    s_and_b32 s19, s19, 7
    s_mul_i32 s72, s19, 73728
    s_add_u32 s17, s18, s72
    s_waitcnt vmcnt(16)
    v_mfma_f32_16x16x32_bf16 v[32:35], v[140:143], a[0:3], 0
    v_mfma_f32_16x16x32_bf16 v[32:35], v[144:147], a[16:19], v[32:35]
    buffer_load_dwordx4 v[204:207], v8, s[8:11], s16 offen offset:0 sc1
    v_mfma_f32_16x16x32_bf16 v[36:39], v[144:147], a[20:23], 0
    v_mfma_f32_16x16x32_bf16 v[36:39], v[140:143], a[4:7], v[36:39]
    v_mfma_f32_16x16x32_bf16 v[40:43], v[140:143], a[8:11], 0
    v_mfma_f32_16x16x32_bf16 v[40:43], v[144:147], a[24:27], v[40:43]
    buffer_load_dwordx4 v[208:211], v8, s[8:11], s16 offen offset:1024 sc1
    v_mfma_f32_16x16x32_bf16 v[44:47], v[144:147], a[28:31], 0
    v_mfma_f32_16x16x32_bf16 v[44:47], v[140:143], a[12:15], v[44:47]
    s_waitcnt vmcnt(16)
    v_mfma_f32_16x16x32_bf16 v[44:47], v[148:151], a[44:47], v[44:47]
    s_add_u32 s21, s21, 65536
    s_and_b32 s21, s21, 524287
    v_mfma_f32_16x16x32_bf16 v[44:47], v[152:155], a[60:63], v[44:47]
    buffer_load_dwordx4 v[140:143], v4, s[8:11], s17 offen offset:0 sc1
    v_mul_f32 v48, v48, v20
    v_mul_f32 v49, v49, v20
    v_mfma_f32_16x16x32_bf16 v[40:43], v[152:155], a[56:59], v[40:43]
    v_mul_f32 v50, v50, v20
    v_mul_f32 v51, v51, v20
    v_mfma_f32_16x16x32_bf16 v[40:43], v[148:151], a[40:43], v[40:43]
    v_cvt_pk_bf16_f32 v64, v48, v49
    v_cvt_pk_bf16_f32 v65, v50, v51
    v_mfma_f32_16x16x32_bf16 v[36:39], v[148:151], a[36:39], v[36:39]
    v_mul_f32 v52, v52, v21
    v_mul_f32 v53, v53, v21
    v_mfma_f32_16x16x32_bf16 v[36:39], v[152:155], a[52:55], v[36:39]
    buffer_load_dwordx4 v[144:147], v4, s[8:11], s17 offen offset:1024 sc1
    v_mul_f32_e64 v54, v54, v21
    v_mul_f32_e64 v55, v55, v21
    v_mfma_f32_16x16x32_bf16 v[32:35], v[152:155], a[48:51], v[32:35]
    v_cvt_pk_bf16_f32 v66, v52, v53
    v_cvt_pk_bf16_f32 v67, v54, v55
    v_mfma_f32_16x16x32_bf16 v[32:35], v[148:151], a[32:35], v[32:35]
    buffer_store_dwordx4 v[64:67], v212, s[8:11], s21 offen offset:0 sc1
    v_mul_f32 v56, v56, v22
    s_waitcnt vmcnt(17)
    v_mfma_f32_16x16x32_bf16 v[32:35], v[156:159], a[64:67], v[32:35]
    v_mul_f32 v57, v57, v22
    v_mul_f32_e64 v58, v58, v22
    s_waitcnt vmcnt(12)
    buffer_atomic_add v24, v9, s[8:11], s22 offen sc1
    v_mfma_f32_16x16x32_bf16 v[32:35], v[160:163], a[80:83], v[32:35]
    buffer_load_dwordx4 v[148:151], v4, s[8:11], s17 offen offset:2048 sc1
    v_mul_f32_e64 v59, v59, v22
    v_cvt_pk_bf16_f32 v68, v56, v57
    v_mfma_f32_16x16x32_bf16 v[36:39], v[160:163], a[84:87], v[36:39]
    v_cvt_pk_bf16_f32 v69, v58, v59
    v_mul_f32_e64 v60, v60, v23
    v_mfma_f32_16x16x32_bf16 v[36:39], v[156:159], a[68:71], v[36:39]
    v_mul_f32_e64 v61, v61, v23
    v_mul_f32_e64 v62, v62, v23
    v_mfma_f32_16x16x32_bf16 v[40:43], v[156:159], a[72:75], v[40:43]
    v_mul_f32_e64 v63, v63, v23
    v_cvt_pk_bf16_f32 v70, v60, v61
    v_mfma_f32_16x16x32_bf16 v[40:43], v[160:163], a[88:91], v[40:43]
    buffer_load_dwordx4 v[152:155], v4, s[8:11], s17 offen offset:3072 sc1
    v_cvt_pk_bf16_f32 v71, v62, v63
    buffer_store_dwordx4 v[68:71], v212, s[8:11], s21 offen offset:1024 sc1
    v_mfma_f32_16x16x32_bf16 v[44:47], v[160:163], a[92:95], v[44:47]
    v_mfma_f32_16x16x32_bf16 v[44:47], v[156:159], a[76:79], v[44:47]
    s_waitcnt vmcnt(19)
    v_mfma_f32_16x16x32_bf16 v[44:47], v[164:167], a[108:111], v[44:47]
    v_mfma_f32_16x16x32_bf16 v[44:47], v[168:171], a[124:127], v[44:47]
    buffer_load_dwordx4 v[156:159], v5, s[8:11], s17 offen offset:0 sc1
    v_mfma_f32_16x16x32_bf16 v[40:43], v[168:171], a[120:123], v[40:43]
    v_mfma_f32_16x16x32_bf16 v[40:43], v[164:167], a[104:107], v[40:43]
    v_mfma_f32_16x16x32_bf16 v[36:39], v[164:167], a[100:103], v[36:39]
    v_mfma_f32_16x16x32_bf16 v[36:39], v[168:171], a[116:119], v[36:39]
    buffer_load_dwordx4 v[160:163], v5, s[8:11], s17 offen offset:1024 sc1
    v_mfma_f32_16x16x32_bf16 v[32:35], v[168:171], a[112:115], v[32:35]
    v_mfma_f32_16x16x32_bf16 v[32:35], v[164:167], a[96:99], v[32:35]
    s_waitcnt vmcnt(17)
    v_mfma_f32_16x16x32_bf16 v[32:35], v[172:175], a[128:131], v[32:35]
    v_mfma_f32_16x16x32_bf16 v[32:35], v[176:179], a[144:147], v[32:35]
    buffer_load_dwordx4 v[164:167], v5, s[8:11], s17 offen offset:2048 sc1
    v_mfma_f32_16x16x32_bf16 v[36:39], v[176:179], a[148:151], v[36:39]
    v_mfma_f32_16x16x32_bf16 v[36:39], v[172:175], a[132:135], v[36:39]
    v_mfma_f32_16x16x32_bf16 v[40:43], v[172:175], a[136:139], v[40:43]
    v_mfma_f32_16x16x32_bf16 v[40:43], v[176:179], a[152:155], v[40:43]
    buffer_load_dwordx4 v[168:171], v5, s[8:11], s17 offen offset:3072 sc1
    v_mfma_f32_16x16x32_bf16 v[44:47], v[176:179], a[156:159], v[44:47]
    v_mfma_f32_16x16x32_bf16 v[44:47], v[172:175], a[140:143], v[44:47]
    s_waitcnt vmcnt(17)
    v_mfma_f32_16x16x32_bf16 v[44:47], v[180:183], a[172:175], v[44:47]
    v_mfma_f32_16x16x32_bf16 v[44:47], v[184:187], a[188:191], v[44:47]
    buffer_load_dwordx4 v[172:175], v6, s[8:11], s17 offen offset:0 sc1
    v_mfma_f32_16x16x32_bf16 v[40:43], v[184:187], a[184:187], v[40:43]
    v_mfma_f32_16x16x32_bf16 v[40:43], v[180:183], a[168:171], v[40:43]
    v_mfma_f32_16x16x32_bf16 v[36:39], v[180:183], a[164:167], v[36:39]
    v_mfma_f32_16x16x32_bf16 v[36:39], v[184:187], a[180:183], v[36:39]
    buffer_load_dwordx4 v[176:179], v6, s[8:11], s17 offen offset:1024 sc1
    v_mfma_f32_16x16x32_bf16 v[32:35], v[184:187], a[176:179], v[32:35]
    v_mfma_f32_16x16x32_bf16 v[32:35], v[180:183], a[160:163], v[32:35]
    s_waitcnt vmcnt(17)
    v_mfma_f32_16x16x32_bf16 v[32:35], v[188:191], a[192:195], v[32:35]
    v_mfma_f32_16x16x32_bf16 v[32:35], v[192:195], a[208:211], v[32:35]
    buffer_load_dwordx4 v[180:183], v6, s[8:11], s17 offen offset:2048 sc1
    v_mfma_f32_16x16x32_bf16 v[36:39], v[192:195], a[212:215], v[36:39]
    v_mfma_f32_16x16x32_bf16 v[36:39], v[188:191], a[196:199], v[36:39]
    v_mfma_f32_16x16x32_bf16 v[40:43], v[188:191], a[200:203], v[40:43]
    v_mfma_f32_16x16x32_bf16 v[40:43], v[192:195], a[216:219], v[40:43]
    buffer_load_dwordx4 v[184:187], v6, s[8:11], s17 offen offset:3072 sc1
    v_mfma_f32_16x16x32_bf16 v[44:47], v[192:195], a[220:223], v[44:47]
    v_mfma_f32_16x16x32_bf16 v[44:47], v[188:191], a[204:207], v[44:47]
    s_waitcnt vmcnt(17)
    v_mfma_f32_16x16x32_bf16 v[44:47], v[196:199], a[236:239], v[44:47]
    v_mfma_f32_16x16x32_bf16 v[44:47], v[200:203], a[252:255], v[44:47]
    buffer_load_dwordx4 v[188:191], v7, s[8:11], s17 offen offset:0 sc1
    v_mfma_f32_16x16x32_bf16 v[40:43], v[200:203], a[248:251], v[40:43]
    v_mfma_f32_16x16x32_bf16 v[40:43], v[196:199], a[232:235], v[40:43]
    v_mfma_f32_16x16x32_bf16 v[36:39], v[196:199], a[228:231], v[36:39]
    v_mfma_f32_16x16x32_bf16 v[36:39], v[200:203], a[244:247], v[36:39]
    buffer_load_dwordx4 v[192:195], v7, s[8:11], s17 offen offset:1024 sc1
    v_mfma_f32_16x16x32_bf16 v[32:35], v[200:203], a[240:243], v[32:35]
    v_mfma_f32_16x16x32_bf16 v[32:35], v[196:199], a[224:227], v[32:35]
    s_waitcnt vmcnt(17)
    v_mfma_f32_16x16x32_bf16 v[32:35], v[204:207], v[108:111], v[32:35]
    v_mfma_f32_16x16x32_bf16 v[48:51], v[208:211], v[124:127], v[32:35]
    buffer_load_dwordx4 v[196:199], v7, s[8:11], s17 offen offset:2048 sc1
    v_mfma_f32_16x16x32_bf16 v[36:39], v[208:211], v[128:131], v[36:39]
    v_mfma_f32_16x16x32_bf16 v[52:55], v[204:207], v[112:115], v[36:39]
    v_mfma_f32_16x16x32_bf16 v[40:43], v[204:207], v[116:119], v[40:43]
    v_mov_b32_e64 v25, 0
    buffer_atomic_add v25, v26, s[8:11], s26 offen sc0 sc1
    v_mfma_f32_16x16x32_bf16 v[56:59], v[208:211], v[132:135], v[40:43]
    buffer_load_dwordx4 v[200:203], v7, s[8:11], s17 offen offset:3072 sc1
    v_mfma_f32_16x16x32_bf16 v[44:47], v[208:211], v[136:139], v[44:47]
    v_mfma_f32_16x16x32_bf16 v[60:63], v[204:207], v[120:123], v[44:47]
    s_mov_b32 s16, s17
    s_barrier
    s_add_u32 s19, s19, 1
    s_and_b32 s19, s19, 7
    s_mul_i32 s72, s19, 73728
    s_add_u32 s17, s18, s72
    s_waitcnt vmcnt(18)
    v_mfma_f32_16x16x32_bf16 v[32:35], v[140:143], a[0:3], 0
    v_mfma_f32_16x16x32_bf16 v[32:35], v[144:147], a[16:19], v[32:35]
    buffer_load_dwordx4 v[204:207], v8, s[8:11], s16 offen offset:0 sc1
    v_mfma_f32_16x16x32_bf16 v[36:39], v[144:147], a[20:23], 0
    v_mfma_f32_16x16x32_bf16 v[36:39], v[140:143], a[4:7], v[36:39]
    v_mfma_f32_16x16x32_bf16 v[40:43], v[140:143], a[8:11], 0
    v_mfma_f32_16x16x32_bf16 v[40:43], v[144:147], a[24:27], v[40:43]
    buffer_load_dwordx4 v[208:211], v8, s[8:11], s16 offen offset:1024 sc1
    v_mfma_f32_16x16x32_bf16 v[44:47], v[144:147], a[28:31], 0
    v_mfma_f32_16x16x32_bf16 v[44:47], v[140:143], a[12:15], v[44:47]
    s_waitcnt vmcnt(16)
    v_mfma_f32_16x16x32_bf16 v[44:47], v[148:151], a[44:47], v[44:47]
    s_add_u32 s21, s21, 65536
    s_and_b32 s21, s21, 524287
    v_mfma_f32_16x16x32_bf16 v[44:47], v[152:155], a[60:63], v[44:47]
    buffer_load_dwordx4 v[140:143], v4, s[8:11], s17 offen offset:0 sc1
    v_mul_f32 v48, v48, v20
    v_mul_f32 v49, v49, v20
    v_mfma_f32_16x16x32_bf16 v[40:43], v[152:155], a[56:59], v[40:43]
    v_mul_f32 v50, v50, v20
    v_mul_f32_e64 v51, v51, v20
    v_mfma_f32_16x16x32_bf16 v[40:43], v[148:151], a[40:43], v[40:43]
    v_cvt_pk_bf16_f32 v64, v48, v49
    v_cvt_pk_bf16_f32 v65, v50, v51
    v_mfma_f32_16x16x32_bf16 v[36:39], v[148:151], a[36:39], v[36:39]
    v_mul_f32 v52, v52, v21
    v_mul_f32 v53, v53, v21
    v_mfma_f32_16x16x32_bf16 v[36:39], v[152:155], a[52:55], v[36:39]
    buffer_load_dwordx4 v[144:147], v4, s[8:11], s17 offen offset:1024 sc1
    v_mul_f32 v54, v54, v21
    v_mul_f32 v55, v55, v21
    v_mfma_f32_16x16x32_bf16 v[32:35], v[152:155], a[48:51], v[32:35]
    v_cvt_pk_bf16_f32 v66, v52, v53
    v_cvt_pk_bf16_f32 v67, v54, v55
    v_mfma_f32_16x16x32_bf16 v[32:35], v[148:151], a[32:35], v[32:35]
    buffer_store_dwordx4 v[64:67], v212, s[8:11], s21 offen offset:0 sc1
    v_mul_f32 v56, v56, v22
    s_waitcnt vmcnt(16)
    v_mfma_f32_16x16x32_bf16 v[32:35], v[156:159], a[64:67], v[32:35]
    v_mul_f32_e64 v57, v57, v22
    v_mul_f32_e64 v58, v58, v22
    s_add_u32 s22, s22, 128
    s_and_b32 s22, s22, 1023
    v_mfma_f32_16x16x32_bf16 v[32:35], v[160:163], a[80:83], v[32:35]
    buffer_load_dwordx4 v[148:151], v4, s[8:11], s17 offen offset:2048 sc1
    v_mul_f32_e64 v59, v59, v22
    v_cvt_pk_bf16_f32 v68, v56, v57
    buffer_atomic_add v24, v9, s[8:11], s22 offen sc1
    v_mfma_f32_16x16x32_bf16 v[36:39], v[160:163], a[84:87], v[36:39]
    v_cvt_pk_bf16_f32 v69, v58, v59
    v_mul_f32_e64 v60, v60, v23
    v_mfma_f32_16x16x32_bf16 v[36:39], v[156:159], a[68:71], v[36:39]
    v_mul_f32_e64 v61, v61, v23
    v_mul_f32_e64 v62, v62, v23
    v_mfma_f32_16x16x32_bf16 v[40:43], v[156:159], a[72:75], v[40:43]
    v_mul_f32_e64 v63, v63, v23
    v_cvt_pk_bf16_f32 v70, v60, v61
    v_mfma_f32_16x16x32_bf16 v[40:43], v[160:163], a[88:91], v[40:43]
    buffer_load_dwordx4 v[152:155], v4, s[8:11], s17 offen offset:3072 sc1
    v_cvt_pk_bf16_f32 v71, v62, v63
    buffer_store_dwordx4 v[68:71], v212, s[8:11], s21 offen offset:1024 sc1
    v_mfma_f32_16x16x32_bf16 v[44:47], v[160:163], a[92:95], v[44:47]
    v_mfma_f32_16x16x32_bf16 v[44:47], v[156:159], a[76:79], v[44:47]
    s_waitcnt vmcnt(18)
    v_mfma_f32_16x16x32_bf16 v[44:47], v[164:167], a[108:111], v[44:47]
    v_mfma_f32_16x16x32_bf16 v[44:47], v[168:171], a[124:127], v[44:47]
    buffer_load_dwordx4 v[156:159], v5, s[8:11], s17 offen offset:0 sc1
    v_mfma_f32_16x16x32_bf16 v[40:43], v[168:171], a[120:123], v[40:43]
    v_mfma_f32_16x16x32_bf16 v[40:43], v[164:167], a[104:107], v[40:43]
    v_mfma_f32_16x16x32_bf16 v[36:39], v[164:167], a[100:103], v[36:39]
    v_mfma_f32_16x16x32_bf16 v[36:39], v[168:171], a[116:119], v[36:39]
    buffer_load_dwordx4 v[160:163], v5, s[8:11], s17 offen offset:1024 sc1
    v_mfma_f32_16x16x32_bf16 v[32:35], v[168:171], a[112:115], v[32:35]
    v_mfma_f32_16x16x32_bf16 v[32:35], v[164:167], a[96:99], v[32:35]
    s_waitcnt vmcnt(18)
    v_mfma_f32_16x16x32_bf16 v[32:35], v[172:175], a[128:131], v[32:35]
    v_mfma_f32_16x16x32_bf16 v[32:35], v[176:179], a[144:147], v[32:35]
    buffer_load_dwordx4 v[164:167], v5, s[8:11], s17 offen offset:2048 sc1
    v_mfma_f32_16x16x32_bf16 v[36:39], v[176:179], a[148:151], v[36:39]
    v_mfma_f32_16x16x32_bf16 v[36:39], v[172:175], a[132:135], v[36:39]
    v_mfma_f32_16x16x32_bf16 v[40:43], v[172:175], a[136:139], v[40:43]
    v_mfma_f32_16x16x32_bf16 v[40:43], v[176:179], a[152:155], v[40:43]
    buffer_load_dwordx4 v[168:171], v5, s[8:11], s17 offen offset:3072 sc1
    v_mfma_f32_16x16x32_bf16 v[44:47], v[176:179], a[156:159], v[44:47]
    v_mfma_f32_16x16x32_bf16 v[44:47], v[172:175], a[140:143], v[44:47]
    s_waitcnt vmcnt(18)
    v_mfma_f32_16x16x32_bf16 v[44:47], v[180:183], a[172:175], v[44:47]
    v_mfma_f32_16x16x32_bf16 v[44:47], v[184:187], a[188:191], v[44:47]
    buffer_load_dwordx4 v[172:175], v6, s[8:11], s17 offen offset:0 sc1
    v_mfma_f32_16x16x32_bf16 v[40:43], v[184:187], a[184:187], v[40:43]
    v_mfma_f32_16x16x32_bf16 v[40:43], v[180:183], a[168:171], v[40:43]
    v_mfma_f32_16x16x32_bf16 v[36:39], v[180:183], a[164:167], v[36:39]
    v_mfma_f32_16x16x32_bf16 v[36:39], v[184:187], a[180:183], v[36:39]
    buffer_load_dwordx4 v[176:179], v6, s[8:11], s17 offen offset:1024 sc1
    v_mfma_f32_16x16x32_bf16 v[32:35], v[184:187], a[176:179], v[32:35]
    v_mfma_f32_16x16x32_bf16 v[32:35], v[180:183], a[160:163], v[32:35]
    s_waitcnt vmcnt(18)
    v_mfma_f32_16x16x32_bf16 v[32:35], v[188:191], a[192:195], v[32:35]
    v_mfma_f32_16x16x32_bf16 v[32:35], v[192:195], a[208:211], v[32:35]
    buffer_load_dwordx4 v[180:183], v6, s[8:11], s17 offen offset:2048 sc1
    v_mfma_f32_16x16x32_bf16 v[36:39], v[192:195], a[212:215], v[36:39]
    v_mfma_f32_16x16x32_bf16 v[36:39], v[188:191], a[196:199], v[36:39]
    v_mfma_f32_16x16x32_bf16 v[40:43], v[188:191], a[200:203], v[40:43]
    v_mfma_f32_16x16x32_bf16 v[40:43], v[192:195], a[216:219], v[40:43]
    buffer_load_dwordx4 v[184:187], v6, s[8:11], s17 offen offset:3072 sc1
    v_mfma_f32_16x16x32_bf16 v[44:47], v[192:195], a[220:223], v[44:47]
    v_mfma_f32_16x16x32_bf16 v[44:47], v[188:191], a[204:207], v[44:47]
    s_waitcnt vmcnt(17)
    v_mfma_f32_16x16x32_bf16 v[44:47], v[196:199], a[236:239], v[44:47]
    v_mfma_f32_16x16x32_bf16 v[44:47], v[200:203], a[252:255], v[44:47]
    buffer_load_dwordx4 v[188:191], v7, s[8:11], s17 offen offset:0 sc1
    v_mfma_f32_16x16x32_bf16 v[40:43], v[200:203], a[248:251], v[40:43]
    v_mfma_f32_16x16x32_bf16 v[40:43], v[196:199], a[232:235], v[40:43]
    v_mfma_f32_16x16x32_bf16 v[36:39], v[196:199], a[228:231], v[36:39]
    v_cmp_ne_u32_e64 vcc, 1, v25
    s_nop 0
    s_and_b32 s24, vcc_lo, 255
    s_cbranch_scc1 L_k3_slows12
L_k3_backs12:
    v_mfma_f32_16x16x32_bf16 v[36:39], v[200:203], a[244:247], v[36:39]
    buffer_load_dwordx4 v[192:195], v7, s[8:11], s17 offen offset:1024 sc1
    s_add_u32 s75, s27, 524288
    buffer_load_dword v72, v215, s[8:11], s75 offen sc1
    v_mfma_f32_16x16x32_bf16 v[32:35], v[200:203], a[240:243], v[32:35]
    s_add_u32 s75, s27, 532480
    buffer_load_dword v73, v215, s[8:11], s75 offen sc1
    v_mfma_f32_16x16x32_bf16 v[32:35], v[196:199], a[224:227], v[32:35]
    s_add_u32 s75, s27, 540672
    buffer_load_dword v74, v215, s[8:11], s75 offen sc1
    s_waitcnt vmcnt(20)
    v_mfma_f32_16x16x32_bf16 v[32:35], v[204:207], v[108:111], v[32:35]
    s_add_u32 s75, s27, 548864
    buffer_load_dword v75, v215, s[8:11], s75 offen sc1
    v_mfma_f32_16x16x32_bf16 v[48:51], v[208:211], v[124:127], v[32:35]
    buffer_load_dwordx4 v[196:199], v7, s[8:11], s17 offen offset:2048 sc1
    s_add_u32 s75, s27, 557056
    buffer_load_dword v76, v215, s[8:11], s75 offen sc1
    v_mfma_f32_16x16x32_bf16 v[36:39], v[208:211], v[128:131], v[36:39]
    s_add_u32 s75, s27, 565248
    buffer_load_dword v77, v215, s[8:11], s75 offen sc1
    v_mfma_f32_16x16x32_bf16 v[52:55], v[204:207], v[112:115], v[36:39]
    s_add_u32 s75, s27, 573440
    buffer_load_dword v78, v215, s[8:11], s75 offen sc1
    v_mfma_f32_16x16x32_bf16 v[40:43], v[204:207], v[116:119], v[40:43]
    s_add_u32 s75, s27, 581632
    buffer_load_dword v79, v215, s[8:11], s75 offen sc1
    s_sub_u32 s23, s23, 16
    s_and_b32 s23, s23, 127
    v_mfma_f32_16x16x32_bf16 v[56:59], v[208:211], v[132:135], v[40:43]
    buffer_load_dwordx4 v[200:203], v7, s[8:11], s17 offen offset:3072 sc1
    v_mov_b32 v25, 0
    buffer_atomic_add v25, v214, s[8:11], s23 offen sc0 sc1
    v_mfma_f32_16x16x32_bf16 v[44:47], v[208:211], v[136:139], v[44:47]
    v_mfma_f32_16x16x32_bf16 v[60:63], v[204:207], v[120:123], v[44:47]
    s_mov_b32 s16, s17
    s_barrier
    s_add_u32 s19, s19, 1
    s_and_b32 s19, s19, 7
    s_mul_i32 s72, s19, 73728
    s_add_u32 s17, s18, s72
    s_waitcnt vmcnt(26)
    v_mfma_f32_16x16x32_bf16 v[32:35], v[140:143], a[0:3], 0
    v_mfma_f32_16x16x32_bf16 v[32:35], v[144:147], a[16:19], v[32:35]
    buffer_load_dwordx4 v[204:207], v8, s[8:11], s16 offen offset:0 sc1
    v_mfma_f32_16x16x32_bf16 v[36:39], v[144:147], a[20:23], 0
    v_mfma_f32_16x16x32_bf16 v[36:39], v[140:143], a[4:7], v[36:39]
    v_mfma_f32_16x16x32_bf16 v[40:43], v[140:143], a[8:11], 0
    v_mfma_f32_16x16x32_bf16 v[40:43], v[144:147], a[24:27], v[40:43]
    buffer_load_dwordx4 v[208:211], v8, s[8:11], s16 offen offset:1024 sc1
    v_mfma_f32_16x16x32_bf16 v[44:47], v[144:147], a[28:31], 0
    v_mfma_f32_16x16x32_bf16 v[44:47], v[140:143], a[12:15], v[44:47]
    s_waitcnt vmcnt(24)
    v_mfma_f32_16x16x32_bf16 v[44:47], v[148:151], a[44:47], v[44:47]
    s_add_u32 s21, s21, 65536
    s_and_b32 s21, s21, 524287
    v_mfma_f32_16x16x32_bf16 v[44:47], v[152:155], a[60:63], v[44:47]
    buffer_load_dwordx4 v[140:143], v4, s[8:11], s17 offen offset:0 sc1
    v_mul_f32 v48, v48, v20
    v_mul_f32_e64 v49, v49, v20
    v_mfma_f32_16x16x32_bf16 v[40:43], v[152:155], a[56:59], v[40:43]
    v_mul_f32 v50, v50, v20
    v_mul_f32 v51, v51, v20
    v_mfma_f32_16x16x32_bf16 v[40:43], v[148:151], a[40:43], v[40:43]
    v_cvt_pk_bf16_f32 v64, v48, v49
    v_cvt_pk_bf16_f32 v65, v50, v51
    v_mfma_f32_16x16x32_bf16 v[36:39], v[148:151], a[36:39], v[36:39]
    v_mul_f32 v52, v52, v21
    v_mul_f32 v53, v53, v21
    v_mfma_f32_16x16x32_bf16 v[36:39], v[152:155], a[52:55], v[36:39]
    buffer_load_dwordx4 v[144:147], v4, s[8:11], s17 offen offset:1024 sc1
    v_mul_f32 v54, v54, v21
    v_mul_f32 v55, v55, v21
    v_mfma_f32_16x16x32_bf16 v[32:35], v[152:155], a[48:51], v[32:35]
    v_cvt_pk_bf16_f32 v66, v52, v53
    v_cvt_pk_bf16_f32 v67, v54, v55
    v_mfma_f32_16x16x32_bf16 v[32:35], v[148:151], a[32:35], v[32:35]
    buffer_store_dwordx4 v[64:67], v212, s[8:11], s21 offen offset:0 sc1
    v_mul_f32 v56, v56, v22
    s_waitcnt vmcnt(24)
    v_mfma_f32_16x16x32_bf16 v[32:35], v[156:159], a[64:67], v[32:35]
    v_mul_f32 v57, v57, v22
    v_mul_f32 v58, v58, v22
    s_add_u32 s22, s22, 128
    s_and_b32 s22, s22, 1023
    v_mfma_f32_16x16x32_bf16 v[32:35], v[160:163], a[80:83], v[32:35]
    buffer_load_dwordx4 v[148:151], v4, s[8:11], s17 offen offset:2048 sc1
    v_mul_f32_e64 v59, v59, v22
    v_cvt_pk_bf16_f32 v68, v56, v57
    buffer_atomic_add v24, v9, s[8:11], s22 offen sc1
    v_mfma_f32_16x16x32_bf16 v[36:39], v[160:163], a[84:87], v[36:39]
    v_cvt_pk_bf16_f32 v69, v58, v59
    v_mul_f32_e64 v60, v60, v23
    v_mfma_f32_16x16x32_bf16 v[36:39], v[156:159], a[68:71], v[36:39]
    v_mul_f32_e64 v61, v61, v23
    v_mul_f32_e64 v62, v62, v23
    v_mfma_f32_16x16x32_bf16 v[40:43], v[156:159], a[72:75], v[40:43]
    v_mul_f32_e64 v63, v63, v23
    v_cvt_pk_bf16_f32 v70, v60, v61
    v_mfma_f32_16x16x32_bf16 v[40:43], v[160:163], a[88:91], v[40:43]
    buffer_load_dwordx4 v[152:155], v4, s[8:11], s17 offen offset:3072 sc1
    v_cvt_pk_bf16_f32 v71, v62, v63
    buffer_store_dwordx4 v[68:71], v212, s[8:11], s21 offen offset:1024 sc1
    v_mfma_f32_16x16x32_bf16 v[44:47], v[160:163], a[92:95], v[44:47]
    v_mfma_f32_16x16x32_bf16 v[44:47], v[156:159], a[76:79], v[44:47]
    s_waitcnt vmcnt(26)
    v_mfma_f32_16x16x32_bf16 v[44:47], v[164:167], a[108:111], v[44:47]
    v_mfma_f32_16x16x32_bf16 v[44:47], v[168:171], a[124:127], v[44:47]
    buffer_load_dwordx4 v[156:159], v5, s[8:11], s17 offen offset:0 sc1
    v_mfma_f32_16x16x32_bf16 v[40:43], v[168:171], a[120:123], v[40:43]
    v_mfma_f32_16x16x32_bf16 v[40:43], v[164:167], a[104:107], v[40:43]
    v_mfma_f32_16x16x32_bf16 v[36:39], v[164:167], a[100:103], v[36:39]
    v_mfma_f32_16x16x32_bf16 v[36:39], v[168:171], a[116:119], v[36:39]
    buffer_load_dwordx4 v[160:163], v5, s[8:11], s17 offen offset:1024 sc1
    v_mfma_f32_16x16x32_bf16 v[32:35], v[168:171], a[112:115], v[32:35]
    v_mfma_f32_16x16x32_bf16 v[32:35], v[164:167], a[96:99], v[32:35]
    s_waitcnt vmcnt(26)
    v_mfma_f32_16x16x32_bf16 v[32:35], v[172:175], a[128:131], v[32:35]
    v_mfma_f32_16x16x32_bf16 v[32:35], v[176:179], a[144:147], v[32:35]
    buffer_load_dwordx4 v[164:167], v5, s[8:11], s17 offen offset:2048 sc1
    v_mfma_f32_16x16x32_bf16 v[36:39], v[176:179], a[148:151], v[36:39]
    v_mfma_f32_16x16x32_bf16 v[36:39], v[172:175], a[132:135], v[36:39]
    v_mfma_f32_16x16x32_bf16 v[40:43], v[172:175], a[136:139], v[40:43]
    v_mfma_f32_16x16x32_bf16 v[40:43], v[176:179], a[152:155], v[40:43]
    buffer_load_dwordx4 v[168:171], v5, s[8:11], s17 offen offset:3072 sc1
    v_mfma_f32_16x16x32_bf16 v[44:47], v[176:179], a[156:159], v[44:47]
    v_mfma_f32_16x16x32_bf16 v[44:47], v[172:175], a[140:143], v[44:47]
    s_waitcnt vmcnt(26)
    v_mfma_f32_16x16x32_bf16 v[44:47], v[180:183], a[172:175], v[44:47]
    v_mfma_f32_16x16x32_bf16 v[44:47], v[184:187], a[188:191], v[44:47]
    buffer_load_dwordx4 v[172:175], v6, s[8:11], s17 offen offset:0 sc1
    v_mfma_f32_16x16x32_bf16 v[40:43], v[184:187], a[184:187], v[40:43]
    v_mfma_f32_16x16x32_bf16 v[40:43], v[180:183], a[168:171], v[40:43]
    v_mfma_f32_16x16x32_bf16 v[36:39], v[180:183], a[164:167], v[36:39]
    v_mfma_f32_16x16x32_bf16 v[36:39], v[184:187], a[180:183], v[36:39]
    buffer_load_dwordx4 v[176:179], v6, s[8:11], s17 offen offset:1024 sc1
    v_mfma_f32_16x16x32_bf16 v[32:35], v[184:187], a[176:179], v[32:35]
    v_mfma_f32_16x16x32_bf16 v[32:35], v[180:183], a[160:163], v[32:35]
    s_waitcnt vmcnt(26)
    v_mfma_f32_16x16x32_bf16 v[32:35], v[188:191], a[192:195], v[32:35]
    v_mfma_f32_16x16x32_bf16 v[32:35], v[192:195], a[208:211], v[32:35]
    buffer_load_dwordx4 v[180:183], v6, s[8:11], s17 offen offset:2048 sc1
    v_mfma_f32_16x16x32_bf16 v[36:39], v[192:195], a[212:215], v[36:39]
    v_mfma_f32_16x16x32_bf16 v[36:39], v[188:191], a[196:199], v[36:39]
    v_mfma_f32_16x16x32_bf16 v[40:43], v[188:191], a[200:203], v[40:43]
    s_waitcnt vmcnt(18)
    v_lshlrev_b32 v220, 16, v72
    v_and_b32 v221, 0xffff0000, v72
    v_mfma_f32_16x16x32_bf16 v[40:43], v[192:195], a[216:219], v[40:43]
    buffer_load_dwordx4 v[184:187], v6, s[8:11], s17 offen offset:3072 sc1
    v_lshlrev_b32_e64 v222, 16, v73
    v_and_b32 v223, 0xffff0000, v73
    v_mfma_f32_16x16x32_bf16 v[44:47], v[192:195], a[220:223], v[44:47]
    v_lshlrev_b32 v224, 16, v74
    v_and_b32 v225, 0xffff0000, v74
    v_mfma_f32_16x16x32_bf16 v[44:47], v[188:191], a[204:207], v[44:47]
    v_lshlrev_b32 v226, 16, v75
    v_and_b32 v227, 0xffff0000, v75
    s_waitcnt vmcnt(18)
    v_mfma_f32_16x16x32_bf16 v[44:47], v[196:199], a[236:239], v[44:47]
    v_lshlrev_b32 v228, 16, v76
    v_and_b32 v229, 0xffff0000, v76
    v_mfma_f32_16x16x32_bf16 v[44:47], v[200:203], a[252:255], v[44:47]
    buffer_load_dwordx4 v[188:191], v7, s[8:11], s17 offen offset:0 sc1
    v_lshlrev_b32_e64 v230, 16, v77
    v_and_b32 v231, 0xffff0000, v77
    v_mfma_f32_16x16x32_bf16 v[40:43], v[200:203], a[248:251], v[40:43]
    v_lshlrev_b32 v232, 16, v78
    v_and_b32 v233, 0xffff0000, v78
    v_mfma_f32_16x16x32_bf16 v[40:43], v[196:199], a[232:235], v[40:43]
    v_lshlrev_b32 v234, 16, v79
    v_and_b32 v235, 0xffff0000, v79
    v_mfma_f32_16x16x32_bf16 v[36:39], v[196:199], a[228:231], v[36:39]
    v_add_f32 v220, v220, v228
    v_add_f32 v221, v221, v229
    s_waitcnt vmcnt(18)
    v_cmp_ne_u32 vcc, 1, v25
    s_nop 0
    s_and_b32 s24, vcc_lo, 1
    s_cbranch_scc1 L_k3_slows13
L_k3_backs13:
    v_mfma_f32_16x16x32_bf16 v[36:39], v[200:203], a[244:247], v[36:39]
    buffer_load_dwordx4 v[192:195], v7, s[8:11], s17 offen offset:1024 sc1
    v_add_f32 v222, v222, v230
    v_add_f32 v223, v223, v231
    s_sub_u32 s25, s25, 8192
    s_and_b32 s25, s25, 65535
    v_mfma_f32_16x16x32_bf16 v[32:35], v[200:203], a[240:243], v[32:35]
    v_add_f32 v224, v224, v232
    v_add_f32 v225, v225, v233
    buffer_load_dwordx4 v[72:75], v213, s[8:11], s25 offen offset:0 sc1
    buffer_load_dwordx4 v[76:79], v213, s[8:11], s25 offen offset:1024 sc1
    v_mfma_f32_16x16x32_bf16 v[32:35], v[196:199], a[224:227], v[32:35]
    v_add_f32 v226, v226, v234
    v_add_f32 v227, v227, v235
    s_waitcnt vmcnt(19)
    v_mfma_f32_16x16x32_bf16 v[32:35], v[204:207], v[108:111], v[32:35]
    v_add_f32 v220, v220, v224
    v_add_f32 v221, v221, v225
    v_mfma_f32_16x16x32_bf16 v[48:51], v[208:211], v[124:127], v[32:35]
    buffer_load_dwordx4 v[196:199], v7, s[8:11], s17 offen offset:2048 sc1
    v_add_f32 v222, v222, v226
    v_add_f32 v223, v223, v227
    v_mfma_f32_16x16x32_bf16 v[36:39], v[208:211], v[128:131], v[36:39]
    v_add_f32 v220, v220, v222
    v_add_f32 v221, v221, v223
    v_mfma_f32_16x16x32_bf16 v[52:55], v[204:207], v[112:115], v[36:39]
    v_cvt_pk_bf16_f32 v96, v220, v221
    buffer_store_dword v96, v216, s[12:15], s28 offen offset:1024 nt
    v_mfma_f32_16x16x32_bf16 v[40:43], v[204:207], v[116:119], v[40:43]
    s_sub_u32 s23, s23, 16
    s_and_b32 s23, s23, 127
    v_mfma_f32_16x16x32_bf16 v[56:59], v[208:211], v[132:135], v[40:43]
    buffer_load_dwordx4 v[200:203], v7, s[8:11], s17 offen offset:3072 sc1
    v_mov_b32 v25, 0
    buffer_atomic_add v25, v214, s[8:11], s23 offen sc0 sc1
    v_mfma_f32_16x16x32_bf16 v[44:47], v[208:211], v[136:139], v[44:47]
    v_mfma_f32_16x16x32_bf16 v[60:63], v[204:207], v[120:123], v[44:47]
    s_mov_b32 s16, s17
    s_barrier
    s_add_u32 s19, s19, 1
    s_and_b32 s19, s19, 7
    s_mul_i32 s72, s19, 73728
    s_add_u32 s17, s18, s72
    s_waitcnt vmcnt(21)
    v_mfma_f32_16x16x32_bf16 v[32:35], v[140:143], a[0:3], 0
    v_mfma_f32_16x16x32_bf16 v[32:35], v[144:147], a[16:19], v[32:35]
    buffer_load_dwordx4 v[204:207], v8, s[8:11], s16 offen offset:0 sc1
    v_mfma_f32_16x16x32_bf16 v[36:39], v[144:147], a[20:23], 0
    v_mfma_f32_16x16x32_bf16 v[36:39], v[140:143], a[4:7], v[36:39]
    v_mfma_f32_16x16x32_bf16 v[40:43], v[140:143], a[8:11], 0
    v_mfma_f32_16x16x32_bf16 v[40:43], v[144:147], a[24:27], v[40:43]
    buffer_load_dwordx4 v[208:211], v8, s[8:11], s16 offen offset:1024 sc1
    v_mfma_f32_16x16x32_bf16 v[44:47], v[144:147], a[28:31], 0
    v_mfma_f32_16x16x32_bf16 v[44:47], v[140:143], a[12:15], v[44:47]
    s_waitcnt vmcnt(19)
    v_mfma_f32_16x16x32_bf16 v[44:47], v[148:151], a[44:47], v[44:47]
    s_add_u32 s21, s21, 65536
    s_and_b32 s21, s21, 524287
    v_mfma_f32_16x16x32_bf16 v[44:47], v[152:155], a[60:63], v[44:47]
    buffer_load_dwordx4 v[140:143], v4, s[8:11], s17 offen offset:0 sc1
    v_mul_f32 v48, v48, v20
    v_mul_f32_e64 v49, v49, v20
    v_mfma_f32_16x16x32_bf16 v[40:43], v[152:155], a[56:59], v[40:43]
    v_mul_f32 v50, v50, v20
    v_mul_f32 v51, v51, v20
    v_mfma_f32_16x16x32_bf16 v[40:43], v[148:151], a[40:43], v[40:43]
    v_cvt_pk_bf16_f32 v64, v48, v49
    v_cvt_pk_bf16_f32 v65, v50, v51
    v_mfma_f32_16x16x32_bf16 v[36:39], v[148:151], a[36:39], v[36:39]
    v_mul_f32 v52, v52, v21
    v_mul_f32 v53, v53, v21
    v_mfma_f32_16x16x32_bf16 v[36:39], v[152:155], a[52:55], v[36:39]
    buffer_load_dwordx4 v[144:147], v4, s[8:11], s17 offen offset:1024 sc1
    v_mul_f32 v54, v54, v21
    v_mul_f32 v55, v55, v21
    v_mfma_f32_16x16x32_bf16 v[32:35], v[152:155], a[48:51], v[32:35]
    v_cvt_pk_bf16_f32 v66, v52, v53
    v_cvt_pk_bf16_f32 v67, v54, v55
    v_mfma_f32_16x16x32_bf16 v[32:35], v[148:151], a[32:35], v[32:35]
    buffer_store_dwordx4 v[64:67], v212, s[8:11], s21 offen offset:0 sc1
    v_mul_f32 v56, v56, v22
    s_waitcnt vmcnt(19)
    v_mfma_f32_16x16x32_bf16 v[32:35], v[156:159], a[64:67], v[32:35]
    v_mul_f32 v57, v57, v22
    v_mul_f32 v58, v58, v22
    s_add_u32 s22, s22, 128
    s_and_b32 s22, s22, 1023
    v_mfma_f32_16x16x32_bf16 v[32:35], v[160:163], a[80:83], v[32:35]
    buffer_load_dwordx4 v[148:151], v4, s[8:11], s17 offen offset:2048 sc1
    v_mul_f32_e64 v59, v59, v22
    v_cvt_pk_bf16_f32 v68, v56, v57
    buffer_atomic_add v24, v9, s[8:11], s22 offen sc1
    v_mfma_f32_16x16x32_bf16 v[36:39], v[160:163], a[84:87], v[36:39]
    v_cvt_pk_bf16_f32 v69, v58, v59
    v_mul_f32_e64 v60, v60, v23
    v_mfma_f32_16x16x32_bf16 v[36:39], v[156:159], a[68:71], v[36:39]
    v_mul_f32_e64 v61, v61, v23
    v_mul_f32_e64 v62, v62, v23
    v_mfma_f32_16x16x32_bf16 v[40:43], v[156:159], a[72:75], v[40:43]
    v_mul_f32_e64 v63, v63, v23
    v_cvt_pk_bf16_f32 v70, v60, v61
    v_mfma_f32_16x16x32_bf16 v[40:43], v[160:163], a[88:91], v[40:43]
    buffer_load_dwordx4 v[152:155], v4, s[8:11], s17 offen offset:3072 sc1
    v_cvt_pk_bf16_f32 v71, v62, v63
    buffer_store_dwordx4 v[68:71], v212, s[8:11], s21 offen offset:1024 sc1
    v_mfma_f32_16x16x32_bf16 v[44:47], v[160:163], a[92:95], v[44:47]
    v_mfma_f32_16x16x32_bf16 v[44:47], v[156:159], a[76:79], v[44:47]
    s_waitcnt vmcnt(21)
    v_mfma_f32_16x16x32_bf16 v[44:47], v[164:167], a[108:111], v[44:47]
    v_mfma_f32_16x16x32_bf16 v[44:47], v[168:171], a[124:127], v[44:47]
    buffer_load_dwordx4 v[156:159], v5, s[8:11], s17 offen offset:0 sc1
    v_mfma_f32_16x16x32_bf16 v[40:43], v[168:171], a[120:123], v[40:43]
    v_mfma_f32_16x16x32_bf16 v[40:43], v[164:167], a[104:107], v[40:43]
    v_mfma_f32_16x16x32_bf16 v[36:39], v[164:167], a[100:103], v[36:39]
    v_mfma_f32_16x16x32_bf16 v[36:39], v[168:171], a[116:119], v[36:39]
    buffer_load_dwordx4 v[160:163], v5, s[8:11], s17 offen offset:1024 sc1
    v_mfma_f32_16x16x32_bf16 v[32:35], v[168:171], a[112:115], v[32:35]
    v_mfma_f32_16x16x32_bf16 v[32:35], v[164:167], a[96:99], v[32:35]
    s_waitcnt vmcnt(21)
    v_mfma_f32_16x16x32_bf16 v[32:35], v[172:175], a[128:131], v[32:35]
    v_mfma_f32_16x16x32_bf16 v[32:35], v[176:179], a[144:147], v[32:35]
    buffer_load_dwordx4 v[164:167], v5, s[8:11], s17 offen offset:2048 sc1
    v_mfma_f32_16x16x32_bf16 v[36:39], v[176:179], a[148:151], v[36:39]
    v_mfma_f32_16x16x32_bf16 v[36:39], v[172:175], a[132:135], v[36:39]
    v_mfma_f32_16x16x32_bf16 v[40:43], v[172:175], a[136:139], v[40:43]
    v_mfma_f32_16x16x32_bf16 v[40:43], v[176:179], a[152:155], v[40:43]
    buffer_load_dwordx4 v[168:171], v5, s[8:11], s17 offen offset:3072 sc1
    v_mfma_f32_16x16x32_bf16 v[44:47], v[176:179], a[156:159], v[44:47]
    v_mfma_f32_16x16x32_bf16 v[44:47], v[172:175], a[140:143], v[44:47]
    s_waitcnt vmcnt(21)
    v_mfma_f32_16x16x32_bf16 v[44:47], v[180:183], a[172:175], v[44:47]
    v_mfma_f32_16x16x32_bf16 v[44:47], v[184:187], a[188:191], v[44:47]
    buffer_load_dwordx4 v[172:175], v6, s[8:11], s17 offen offset:0 sc1
    v_mfma_f32_16x16x32_bf16 v[40:43], v[184:187], a[184:187], v[40:43]
    v_mfma_f32_16x16x32_bf16 v[40:43], v[180:183], a[168:171], v[40:43]
    v_mfma_f32_16x16x32_bf16 v[36:39], v[180:183], a[164:167], v[36:39]
    v_mfma_f32_16x16x32_bf16 v[36:39], v[184:187], a[180:183], v[36:39]
    buffer_load_dwordx4 v[176:179], v6, s[8:11], s17 offen offset:1024 sc1
    v_mfma_f32_16x16x32_bf16 v[32:35], v[184:187], a[176:179], v[32:35]
    v_mfma_f32_16x16x32_bf16 v[32:35], v[180:183], a[160:163], v[32:35]
    s_waitcnt vmcnt(21)
    v_mfma_f32_16x16x32_bf16 v[32:35], v[188:191], a[192:195], v[32:35]
    v_mfma_f32_16x16x32_bf16 v[32:35], v[192:195], a[208:211], v[32:35]
    buffer_load_dwordx4 v[180:183], v6, s[8:11], s17 offen offset:2048 sc1
    v_mfma_f32_16x16x32_bf16 v[36:39], v[192:195], a[212:215], v[36:39]
    v_mfma_f32_16x16x32_bf16 v[36:39], v[188:191], a[196:199], v[36:39]
    v_mfma_f32_16x16x32_bf16 v[40:43], v[188:191], a[200:203], v[40:43]
    s_waitcnt vmcnt(20)
    v_lshlrev_b32 v220, 16, v72
    v_and_b32 v221, 0xffff0000, v72
    v_mfma_f32_16x16x32_bf16 v[40:43], v[192:195], a[216:219], v[40:43]
    buffer_load_dwordx4 v[184:187], v6, s[8:11], s17 offen offset:3072 sc1
    v_lshlrev_b32_e64 v222, 16, v73
    v_and_b32 v223, 0xffff0000, v73
    v_mfma_f32_16x16x32_bf16 v[44:47], v[192:195], a[220:223], v[44:47]
    v_lshlrev_b32 v224, 16, v74
    v_and_b32 v225, 0xffff0000, v74
    v_mfma_f32_16x16x32_bf16 v[44:47], v[188:191], a[204:207], v[44:47]
    v_lshlrev_b32 v226, 16, v75
    v_and_b32 v227, 0xffff0000, v75
    s_waitcnt vmcnt(18)
    v_mfma_f32_16x16x32_bf16 v[44:47], v[196:199], a[236:239], v[44:47]
    v_lshlrev_b32 v228, 16, v76
    v_and_b32 v229, 0xffff0000, v76
    v_mfma_f32_16x16x32_bf16 v[44:47], v[200:203], a[252:255], v[44:47]
    buffer_load_dwordx4 v[188:191], v7, s[8:11], s17 offen offset:0 sc1
    v_lshlrev_b32_e64 v230, 16, v77
    v_and_b32 v231, 0xffff0000, v77
    v_mfma_f32_16x16x32_bf16 v[40:43], v[200:203], a[248:251], v[40:43]
    v_lshlrev_b32 v232, 16, v78
    v_and_b32 v233, 0xffff0000, v78
    v_mfma_f32_16x16x32_bf16 v[40:43], v[196:199], a[232:235], v[40:43]
    v_lshlrev_b32 v234, 16, v79
    v_and_b32 v235, 0xffff0000, v79
    v_mfma_f32_16x16x32_bf16 v[36:39], v[196:199], a[228:231], v[36:39]
    v_add_f32 v80, v80, v220
    v_add_f32 v81, v81, v221
    s_waitcnt vmcnt(18)
    v_cmp_ne_u32 vcc, 1, v25
    s_nop 0
    s_and_b32 s24, vcc_lo, 1
    s_cbranch_scc1 L_k3_slows14
L_k3_backs14:
    v_mfma_f32_16x16x32_bf16 v[36:39], v[200:203], a[244:247], v[36:39]
    buffer_load_dwordx4 v[192:195], v7, s[8:11], s17 offen offset:1024 sc1
    v_add_f32 v82, v82, v222
    v_add_f32 v83, v83, v223
    s_sub_u32 s25, s25, 8192
    s_and_b32 s25, s25, 65535
    v_mfma_f32_16x16x32_bf16 v[32:35], v[200:203], a[240:243], v[32:35]
    v_add_f32 v84, v84, v224
    v_add_f32 v85, v85, v225
    buffer_load_dwordx4 v[72:75], v213, s[8:11], s25 offen offset:0 sc1
    buffer_load_dwordx4 v[76:79], v213, s[8:11], s25 offen offset:1024 sc1
    v_mfma_f32_16x16x32_bf16 v[32:35], v[196:199], a[224:227], v[32:35]
    v_add_f32 v86, v86, v226
    v_add_f32 v87, v87, v227
    s_waitcnt vmcnt(19)
    v_mfma_f32_16x16x32_bf16 v[32:35], v[204:207], v[108:111], v[32:35]
    v_add_f32 v88, v88, v228
    v_add_f32 v89, v89, v229
    v_mfma_f32_16x16x32_bf16 v[48:51], v[208:211], v[124:127], v[32:35]
    buffer_load_dwordx4 v[196:199], v7, s[8:11], s17 offen offset:2048 sc1
    v_add_f32 v90, v90, v230
    v_add_f32 v91, v91, v231
    v_mfma_f32_16x16x32_bf16 v[36:39], v[208:211], v[128:131], v[36:39]
    v_add_f32 v92, v92, v232
    v_add_f32 v93, v93, v233
    v_mfma_f32_16x16x32_bf16 v[52:55], v[204:207], v[112:115], v[36:39]
    v_add_f32 v94, v94, v234
    v_add_f32_e64 v95, v95, v235
    v_mfma_f32_16x16x32_bf16 v[40:43], v[204:207], v[116:119], v[40:43]
    s_sub_u32 s23, s23, 16
    s_and_b32 s23, s23, 127
    v_mfma_f32_16x16x32_bf16 v[56:59], v[208:211], v[132:135], v[40:43]
    buffer_load_dwordx4 v[200:203], v7, s[8:11], s17 offen offset:3072 sc1
    v_mov_b32_e64 v25, 0
    buffer_atomic_add v25, v214, s[8:11], s23 offen sc0 sc1
    v_mfma_f32_16x16x32_bf16 v[44:47], v[208:211], v[136:139], v[44:47]
    v_mfma_f32_16x16x32_bf16 v[60:63], v[204:207], v[120:123], v[44:47]
    s_mov_b32 s16, s17
    s_barrier
    s_add_u32 s19, s19, 1
    s_and_b32 s19, s19, 7
    s_mul_i32 s72, s19, 73728
    s_add_u32 s17, s18, s72
    s_waitcnt vmcnt(20)
    v_mfma_f32_16x16x32_bf16 v[32:35], v[140:143], a[0:3], 0
    v_mfma_f32_16x16x32_bf16 v[32:35], v[144:147], a[16:19], v[32:35]
    buffer_load_dwordx4 v[204:207], v8, s[8:11], s16 offen offset:0 sc1
    v_mfma_f32_16x16x32_bf16 v[36:39], v[144:147], a[20:23], 0
    v_mfma_f32_16x16x32_bf16 v[36:39], v[140:143], a[4:7], v[36:39]
    v_mfma_f32_16x16x32_bf16 v[40:43], v[140:143], a[8:11], 0
    v_mfma_f32_16x16x32_bf16 v[40:43], v[144:147], a[24:27], v[40:43]
    buffer_load_dwordx4 v[208:211], v8, s[8:11], s16 offen offset:1024 sc1
    v_mfma_f32_16x16x32_bf16 v[44:47], v[144:147], a[28:31], 0
    v_mfma_f32_16x16x32_bf16 v[44:47], v[140:143], a[12:15], v[44:47]
    s_waitcnt vmcnt(18)
    v_mfma_f32_16x16x32_bf16 v[44:47], v[148:151], a[44:47], v[44:47]
    s_add_u32 s21, s21, 65536
    s_and_b32 s21, s21, 524287
    v_mfma_f32_16x16x32_bf16 v[44:47], v[152:155], a[60:63], v[44:47]
    buffer_load_dwordx4 v[140:143], v4, s[8:11], s17 offen offset:0 sc1
    v_mul_f32 v48, v48, v20
    v_mul_f32_e64 v49, v49, v20
    v_mfma_f32_16x16x32_bf16 v[40:43], v[152:155], a[56:59], v[40:43]
    v_mul_f32 v50, v50, v20
    v_mul_f32 v51, v51, v20
    v_mfma_f32_16x16x32_bf16 v[40:43], v[148:151], a[40:43], v[40:43]
    v_cvt_pk_bf16_f32 v64, v48, v49
    v_cvt_pk_bf16_f32 v65, v50, v51
    v_mfma_f32_16x16x32_bf16 v[36:39], v[148:151], a[36:39], v[36:39]
    v_mul_f32 v52, v52, v21
    v_mul_f32 v53, v53, v21
    v_mfma_f32_16x16x32_bf16 v[36:39], v[152:155], a[52:55], v[36:39]
    buffer_load_dwordx4 v[144:147], v4, s[8:11], s17 offen offset:1024 sc1
    v_mul_f32 v54, v54, v21
    v_mul_f32 v55, v55, v21
    v_mfma_f32_16x16x32_bf16 v[32:35], v[152:155], a[48:51], v[32:35]
    v_cvt_pk_bf16_f32 v66, v52, v53
    v_cvt_pk_bf16_f32 v67, v54, v55
    v_mfma_f32_16x16x32_bf16 v[32:35], v[148:151], a[32:35], v[32:35]
    buffer_store_dwordx4 v[64:67], v212, s[8:11], s21 offen offset:0 sc1
    v_mul_f32 v56, v56, v22
    s_waitcnt vmcnt(18)
    v_mfma_f32_16x16x32_bf16 v[32:35], v[156:159], a[64:67], v[32:35]
    v_mul_f32 v57, v57, v22
    v_mul_f32 v58, v58, v22
    s_add_u32 s22, s22, 128
    s_and_b32 s22, s22, 1023
    v_mfma_f32_16x16x32_bf16 v[32:35], v[160:163], a[80:83], v[32:35]
    buffer_load_dwordx4 v[148:151], v4, s[8:11], s17 offen offset:2048 sc1
    v_mul_f32_e64 v59, v59, v22
    v_cvt_pk_bf16_f32 v68, v56, v57
    buffer_atomic_add v24, v9, s[8:11], s22 offen sc1
    v_mfma_f32_16x16x32_bf16 v[36:39], v[160:163], a[84:87], v[36:39]
    v_cvt_pk_bf16_f32 v69, v58, v59
    v_mul_f32_e64 v60, v60, v23
    v_mfma_f32_16x16x32_bf16 v[36:39], v[156:159], a[68:71], v[36:39]
    v_mul_f32_e64 v61, v61, v23
    v_mul_f32_e64 v62, v62, v23
    v_mfma_f32_16x16x32_bf16 v[40:43], v[156:159], a[72:75], v[40:43]
    v_mul_f32_e64 v63, v63, v23
    v_cvt_pk_bf16_f32 v70, v60, v61
    v_mfma_f32_16x16x32_bf16 v[40:43], v[160:163], a[88:91], v[40:43]
    buffer_load_dwordx4 v[152:155], v4, s[8:11], s17 offen offset:3072 sc1
    v_cvt_pk_bf16_f32 v71, v62, v63
    buffer_store_dwordx4 v[68:71], v212, s[8:11], s21 offen offset:1024 sc1
    v_mfma_f32_16x16x32_bf16 v[44:47], v[160:163], a[92:95], v[44:47]
    v_mfma_f32_16x16x32_bf16 v[44:47], v[156:159], a[76:79], v[44:47]
    s_waitcnt vmcnt(20)
    v_mfma_f32_16x16x32_bf16 v[44:47], v[164:167], a[108:111], v[44:47]
    v_mfma_f32_16x16x32_bf16 v[44:47], v[168:171], a[124:127], v[44:47]
    buffer_load_dwordx4 v[156:159], v5, s[8:11], s17 offen offset:0 sc1
    v_mfma_f32_16x16x32_bf16 v[40:43], v[168:171], a[120:123], v[40:43]
    v_mfma_f32_16x16x32_bf16 v[40:43], v[164:167], a[104:107], v[40:43]
    v_mfma_f32_16x16x32_bf16 v[36:39], v[164:167], a[100:103], v[36:39]
    v_mfma_f32_16x16x32_bf16 v[36:39], v[168:171], a[116:119], v[36:39]
    buffer_load_dwordx4 v[160:163], v5, s[8:11], s17 offen offset:1024 sc1
    v_mfma_f32_16x16x32_bf16 v[32:35], v[168:171], a[112:115], v[32:35]
    v_mfma_f32_16x16x32_bf16 v[32:35], v[164:167], a[96:99], v[32:35]
    s_waitcnt vmcnt(20)
    v_mfma_f32_16x16x32_bf16 v[32:35], v[172:175], a[128:131], v[32:35]
    v_mfma_f32_16x16x32_bf16 v[32:35], v[176:179], a[144:147], v[32:35]
    buffer_load_dwordx4 v[164:167], v5, s[8:11], s17 offen offset:2048 sc1
    v_mfma_f32_16x16x32_bf16 v[36:39], v[176:179], a[148:151], v[36:39]
    v_mfma_f32_16x16x32_bf16 v[36:39], v[172:175], a[132:135], v[36:39]
    v_mfma_f32_16x16x32_bf16 v[40:43], v[172:175], a[136:139], v[40:43]
    v_mfma_f32_16x16x32_bf16 v[40:43], v[176:179], a[152:155], v[40:43]
    buffer_load_dwordx4 v[168:171], v5, s[8:11], s17 offen offset:3072 sc1
    v_mfma_f32_16x16x32_bf16 v[44:47], v[176:179], a[156:159], v[44:47]
    v_mfma_f32_16x16x32_bf16 v[44:47], v[172:175], a[140:143], v[44:47]
    s_waitcnt vmcnt(20)
    v_mfma_f32_16x16x32_bf16 v[44:47], v[180:183], a[172:175], v[44:47]
    v_mfma_f32_16x16x32_bf16 v[44:47], v[184:187], a[188:191], v[44:47]
    buffer_load_dwordx4 v[172:175], v6, s[8:11], s17 offen offset:0 sc1
    v_mfma_f32_16x16x32_bf16 v[40:43], v[184:187], a[184:187], v[40:43]
    v_mfma_f32_16x16x32_bf16 v[40:43], v[180:183], a[168:171], v[40:43]
    v_mfma_f32_16x16x32_bf16 v[36:39], v[180:183], a[164:167], v[36:39]
    v_mfma_f32_16x16x32_bf16 v[36:39], v[184:187], a[180:183], v[36:39]
    buffer_load_dwordx4 v[176:179], v6, s[8:11], s17 offen offset:1024 sc1
    v_mfma_f32_16x16x32_bf16 v[32:35], v[184:187], a[176:179], v[32:35]
    v_mfma_f32_16x16x32_bf16 v[32:35], v[180:183], a[160:163], v[32:35]
    s_waitcnt vmcnt(20)
    v_mfma_f32_16x16x32_bf16 v[32:35], v[188:191], a[192:195], v[32:35]
    v_mfma_f32_16x16x32_bf16 v[32:35], v[192:195], a[208:211], v[32:35]
    buffer_load_dwordx4 v[180:183], v6, s[8:11], s17 offen offset:2048 sc1
    v_mfma_f32_16x16x32_bf16 v[36:39], v[192:195], a[212:215], v[36:39]
    v_mfma_f32_16x16x32_bf16 v[36:39], v[188:191], a[196:199], v[36:39]
    v_mfma_f32_16x16x32_bf16 v[40:43], v[188:191], a[200:203], v[40:43]
    s_waitcnt vmcnt(19)
    v_lshlrev_b32 v220, 16, v72
    v_and_b32 v221, 0xffff0000, v72
    v_mfma_f32_16x16x32_bf16 v[40:43], v[192:195], a[216:219], v[40:43]
    buffer_load_dwordx4 v[184:187], v6, s[8:11], s17 offen offset:3072 sc1
    v_lshlrev_b32_e64 v222, 16, v73
    v_and_b32 v223, 0xffff0000, v73
    v_mfma_f32_16x16x32_bf16 v[44:47], v[192:195], a[220:223], v[44:47]
    v_lshlrev_b32 v224, 16, v74
    v_and_b32 v225, 0xffff0000, v74
    v_mfma_f32_16x16x32_bf16 v[44:47], v[188:191], a[204:207], v[44:47]
    v_lshlrev_b32 v226, 16, v75
    v_and_b32 v227, 0xffff0000, v75
    s_waitcnt vmcnt(18)
    v_mfma_f32_16x16x32_bf16 v[44:47], v[196:199], a[236:239], v[44:47]
    v_lshlrev_b32 v228, 16, v76
    v_and_b32 v229, 0xffff0000, v76
    v_mfma_f32_16x16x32_bf16 v[44:47], v[200:203], a[252:255], v[44:47]
    buffer_load_dwordx4 v[188:191], v7, s[8:11], s17 offen offset:0 sc1
    v_lshlrev_b32_e64 v230, 16, v77
    v_and_b32 v231, 0xffff0000, v77
    v_mfma_f32_16x16x32_bf16 v[40:43], v[200:203], a[248:251], v[40:43]
    v_lshlrev_b32 v232, 16, v78
    v_and_b32 v233, 0xffff0000, v78
    v_mfma_f32_16x16x32_bf16 v[40:43], v[196:199], a[232:235], v[40:43]
    v_lshlrev_b32 v234, 16, v79
    v_and_b32 v235, 0xffff0000, v79
    v_mfma_f32_16x16x32_bf16 v[36:39], v[196:199], a[228:231], v[36:39]
    v_add_f32 v80, v80, v220
    v_add_f32 v81, v81, v221
    s_waitcnt vmcnt(18)
    v_cmp_ne_u32 vcc, 1, v25
    s_nop 0
    s_and_b32 s24, vcc_lo, 1
    s_cbranch_scc1 L_k3_slows15
L_k3_backs15:
    v_mfma_f32_16x16x32_bf16 v[36:39], v[200:203], a[244:247], v[36:39]
    buffer_load_dwordx4 v[192:195], v7, s[8:11], s17 offen offset:1024 sc1
    v_add_f32 v82, v82, v222
    v_add_f32 v83, v83, v223
    s_sub_u32 s25, s25, 8192
    s_and_b32 s25, s25, 65535
    v_mfma_f32_16x16x32_bf16 v[32:35], v[200:203], a[240:243], v[32:35]
    v_add_f32 v84, v84, v224
    v_add_f32 v85, v85, v225
    buffer_load_dwordx4 v[72:75], v213, s[8:11], s25 offen offset:0 sc1
    buffer_load_dwordx4 v[76:79], v213, s[8:11], s25 offen offset:1024 sc1
    v_mfma_f32_16x16x32_bf16 v[32:35], v[196:199], a[224:227], v[32:35]
    v_add_f32 v86, v86, v226
    v_add_f32 v87, v87, v227
    s_waitcnt vmcnt(19)
    v_mfma_f32_16x16x32_bf16 v[32:35], v[204:207], v[108:111], v[32:35]
    v_add_f32 v88, v88, v228
    v_add_f32 v89, v89, v229
    v_mfma_f32_16x16x32_bf16 v[48:51], v[208:211], v[124:127], v[32:35]
    buffer_load_dwordx4 v[196:199], v7, s[8:11], s17 offen offset:2048 sc1
    v_add_f32 v90, v90, v230
    v_add_f32 v91, v91, v231
    v_mfma_f32_16x16x32_bf16 v[36:39], v[208:211], v[128:131], v[36:39]
    v_add_f32 v92, v92, v232
    v_add_f32 v93, v93, v233
    v_mfma_f32_16x16x32_bf16 v[52:55], v[204:207], v[112:115], v[36:39]
    v_add_f32 v94, v94, v234
    v_add_f32_e64 v95, v95, v235
    v_mfma_f32_16x16x32_bf16 v[40:43], v[204:207], v[116:119], v[40:43]
    s_sub_u32 s23, s23, 16
    s_and_b32 s23, s23, 127
    v_mfma_f32_16x16x32_bf16 v[56:59], v[208:211], v[132:135], v[40:43]
    buffer_load_dwordx4 v[200:203], v7, s[8:11], s17 offen offset:3072 sc1
    v_mov_b32_e64 v25, 0
    buffer_atomic_add v25, v214, s[8:11], s23 offen sc0 sc1
    v_mfma_f32_16x16x32_bf16 v[44:47], v[208:211], v[136:139], v[44:47]
    v_mfma_f32_16x16x32_bf16 v[60:63], v[204:207], v[120:123], v[44:47]
    s_mov_b32 s16, s17
    s_barrier
    s_add_u32 s19, s19, 1
    s_and_b32 s19, s19, 7
    s_mul_i32 s72, s19, 73728
    s_add_u32 s17, s18, s72
    s_waitcnt vmcnt(20)
    v_mfma_f32_16x16x32_bf16 v[32:35], v[140:143], a[0:3], 0
    v_mfma_f32_16x16x32_bf16 v[32:35], v[144:147], a[16:19], v[32:35]
    v_mfma_f32_16x16x32_bf16 v[36:39], v[144:147], a[20:23], 0
    v_mfma_f32_16x16x32_bf16 v[36:39], v[140:143], a[4:7], v[36:39]
    v_mfma_f32_16x16x32_bf16 v[40:43], v[140:143], a[8:11], 0
    v_mfma_f32_16x16x32_bf16 v[40:43], v[144:147], a[24:27], v[40:43]
    v_mfma_f32_16x16x32_bf16 v[44:47], v[144:147], a[28:31], 0
    v_mfma_f32_16x16x32_bf16 v[44:47], v[140:143], a[12:15], v[44:47]
    s_waitcnt vmcnt(16)
    v_mfma_f32_16x16x32_bf16 v[44:47], v[148:151], a[44:47], v[44:47]
    s_add_u32 s21, s21, 65536
    s_and_b32 s21, s21, 524287
    v_mfma_f32_16x16x32_bf16 v[44:47], v[152:155], a[60:63], v[44:47]
    v_mul_f32 v48, v48, v20
    v_mul_f32 v49, v49, v20
    v_mfma_f32_16x16x32_bf16 v[40:43], v[152:155], a[56:59], v[40:43]
    v_mul_f32 v50, v50, v20
    v_mul_f32_e64 v51, v51, v20
    v_mfma_f32_16x16x32_bf16 v[40:43], v[148:151], a[40:43], v[40:43]
    v_cvt_pk_bf16_f32 v64, v48, v49
    v_cvt_pk_bf16_f32 v65, v50, v51
    v_mfma_f32_16x16x32_bf16 v[36:39], v[148:151], a[36:39], v[36:39]
    v_mul_f32 v52, v52, v21
    v_mul_f32 v53, v53, v21
    v_mfma_f32_16x16x32_bf16 v[36:39], v[152:155], a[52:55], v[36:39]
    v_mul_f32 v54, v54, v21
    v_mul_f32 v55, v55, v21
    v_mfma_f32_16x16x32_bf16 v[32:35], v[152:155], a[48:51], v[32:35]
    v_cvt_pk_bf16_f32 v66, v52, v53
    v_cvt_pk_bf16_f32 v67, v54, v55
    v_mfma_f32_16x16x32_bf16 v[32:35], v[148:151], a[32:35], v[32:35]
    buffer_store_dwordx4 v[64:67], v212, s[8:11], s21 offen offset:0 sc1
    v_mul_f32 v56, v56, v22
    s_waitcnt vmcnt(14)
    v_mfma_f32_16x16x32_bf16 v[32:35], v[156:159], a[64:67], v[32:35]
    v_mul_f32 v57, v57, v22
    v_mul_f32 v58, v58, v22
    s_add_u32 s22, s22, 128
    s_and_b32 s22, s22, 1023
    v_mfma_f32_16x16x32_bf16 v[32:35], v[160:163], a[80:83], v[32:35]
    v_mul_f32_e64 v59, v59, v22
    v_cvt_pk_bf16_f32 v68, v56, v57
    buffer_atomic_add v24, v9, s[8:11], s22 offen sc1
    v_mfma_f32_16x16x32_bf16 v[36:39], v[160:163], a[84:87], v[36:39]
    v_cvt_pk_bf16_f32 v69, v58, v59
    v_mul_f32 v60, v60, v23
    v_mfma_f32_16x16x32_bf16 v[36:39], v[156:159], a[68:71], v[36:39]
    v_mul_f32 v61, v61, v23
    v_mul_f32_e64 v62, v62, v23
    v_mfma_f32_16x16x32_bf16 v[40:43], v[156:159], a[72:75], v[40:43]
    v_mul_f32_e64 v63, v63, v23
    v_cvt_pk_bf16_f32 v70, v60, v61
    v_mfma_f32_16x16x32_bf16 v[40:43], v[160:163], a[88:91], v[40:43]
    v_cvt_pk_bf16_f32 v71, v62, v63
    buffer_store_dwordx4 v[68:71], v212, s[8:11], s21 offen offset:1024 sc1
    v_mfma_f32_16x16x32_bf16 v[44:47], v[160:163], a[92:95], v[44:47]
    v_mfma_f32_16x16x32_bf16 v[44:47], v[156:159], a[76:79], v[44:47]
    s_waitcnt vmcnt(14)
    v_mfma_f32_16x16x32_bf16 v[44:47], v[164:167], a[108:111], v[44:47]
    v_mfma_f32_16x16x32_bf16 v[44:47], v[168:171], a[124:127], v[44:47]
    v_mfma_f32_16x16x32_bf16 v[40:43], v[168:171], a[120:123], v[40:43]
    v_mfma_f32_16x16x32_bf16 v[40:43], v[164:167], a[104:107], v[40:43]
    v_mfma_f32_16x16x32_bf16 v[36:39], v[164:167], a[100:103], v[36:39]
    v_mfma_f32_16x16x32_bf16 v[36:39], v[168:171], a[116:119], v[36:39]
    v_mfma_f32_16x16x32_bf16 v[32:35], v[168:171], a[112:115], v[32:35]
    v_mfma_f32_16x16x32_bf16 v[32:35], v[164:167], a[96:99], v[32:35]
    s_waitcnt vmcnt(12)
    v_mfma_f32_16x16x32_bf16 v[32:35], v[172:175], a[128:131], v[32:35]
    v_mfma_f32_16x16x32_bf16 v[32:35], v[176:179], a[144:147], v[32:35]
    buffer_load_dwordx4 v[204:207], v8, s[8:11], s16 offen offset:0 sc1
    v_mfma_f32_16x16x32_bf16 v[36:39], v[176:179], a[148:151], v[36:39]
    v_mfma_f32_16x16x32_bf16 v[36:39], v[172:175], a[132:135], v[36:39]
    v_mfma_f32_16x16x32_bf16 v[40:43], v[172:175], a[136:139], v[40:43]
    v_mfma_f32_16x16x32_bf16 v[40:43], v[176:179], a[152:155], v[40:43]
    buffer_load_dwordx4 v[208:211], v8, s[8:11], s16 offen offset:1024 sc1
    v_mfma_f32_16x16x32_bf16 v[44:47], v[176:179], a[156:159], v[44:47]
    v_mfma_f32_16x16x32_bf16 v[44:47], v[172:175], a[140:143], v[44:47]
    s_waitcnt vmcnt(12)
    v_mfma_f32_16x16x32_bf16 v[44:47], v[180:183], a[172:175], v[44:47]
    v_mfma_f32_16x16x32_bf16 v[44:47], v[184:187], a[188:191], v[44:47]
    buffer_load_dwordx4 v[140:143], v4, s[8:11], s17 offen offset:0 sc1
    v_mfma_f32_16x16x32_bf16 v[40:43], v[184:187], a[184:187], v[40:43]
    v_mfma_f32_16x16x32_bf16 v[40:43], v[180:183], a[168:171], v[40:43]
    v_mfma_f32_16x16x32_bf16 v[36:39], v[180:183], a[164:167], v[36:39]
    v_mfma_f32_16x16x32_bf16 v[36:39], v[184:187], a[180:183], v[36:39]
    buffer_load_dwordx4 v[144:147], v4, s[8:11], s17 offen offset:1024 sc1
    v_mfma_f32_16x16x32_bf16 v[32:35], v[184:187], a[176:179], v[32:35]
    v_mfma_f32_16x16x32_bf16 v[32:35], v[180:183], a[160:163], v[32:35]
    s_waitcnt vmcnt(12)
    v_mfma_f32_16x16x32_bf16 v[32:35], v[188:191], a[192:195], v[32:35]
    v_mfma_f32_16x16x32_bf16 v[32:35], v[192:195], a[208:211], v[32:35]
    buffer_load_dwordx4 v[148:151], v4, s[8:11], s17 offen offset:2048 sc1
    v_mfma_f32_16x16x32_bf16 v[36:39], v[192:195], a[212:215], v[36:39]
    v_mfma_f32_16x16x32_bf16 v[36:39], v[188:191], a[196:199], v[36:39]
    v_mfma_f32_16x16x32_bf16 v[40:43], v[188:191], a[200:203], v[40:43]
    s_waitcnt vmcnt(11)
    v_lshlrev_b32 v220, 16, v72
    v_and_b32 v221, 0xffff0000, v72
    v_mfma_f32_16x16x32_bf16 v[40:43], v[192:195], a[216:219], v[40:43]
    buffer_load_dwordx4 v[152:155], v4, s[8:11], s17 offen offset:3072 sc1
    v_lshlrev_b32 v222, 16, v73
    v_and_b32 v223, 0xffff0000, v73
    v_mfma_f32_16x16x32_bf16 v[44:47], v[192:195], a[220:223], v[44:47]
    v_lshlrev_b32 v224, 16, v74
    v_and_b32 v225, 0xffff0000, v74
    v_mfma_f32_16x16x32_bf16 v[44:47], v[188:191], a[204:207], v[44:47]
    v_lshlrev_b32 v226, 16, v75
    v_and_b32 v227, 0xffff0000, v75
    s_waitcnt vmcnt(10)
    v_mfma_f32_16x16x32_bf16 v[44:47], v[196:199], a[236:239], v[44:47]
    v_lshlrev_b32_e64 v228, 16, v76
    v_and_b32 v229, 0xffff0000, v76
    v_mfma_f32_16x16x32_bf16 v[44:47], v[200:203], a[252:255], v[44:47]
    buffer_load_dwordx4 v[156:159], v5, s[8:11], s17 offen offset:0 sc1
    v_lshlrev_b32 v230, 16, v77
    v_and_b32 v231, 0xffff0000, v77
    v_mfma_f32_16x16x32_bf16 v[40:43], v[200:203], a[248:251], v[40:43]
    v_lshlrev_b32 v232, 16, v78
    v_and_b32 v233, 0xffff0000, v78
    v_mfma_f32_16x16x32_bf16 v[40:43], v[196:199], a[232:235], v[40:43]
    v_lshlrev_b32_e64 v234, 16, v79
    v_and_b32 v235, 0xffff0000, v79
    v_mfma_f32_16x16x32_bf16 v[36:39], v[196:199], a[228:231], v[36:39]
    v_add_f32 v80, v80, v220
    v_add_f32 v81, v81, v221
    s_waitcnt vmcnt(10)
    v_cmp_ne_u32 vcc, 1, v25
    s_nop 0
    s_and_b32 s24, vcc_lo, 1
    s_cbranch_scc1 L_k3_slows16
L_k3_backs16:
    v_mfma_f32_16x16x32_bf16 v[36:39], v[200:203], a[244:247], v[36:39]
    buffer_load_dwordx4 v[160:163], v5, s[8:11], s17 offen offset:1024 sc1
    v_add_f32 v82, v82, v222
    v_add_f32_e64 v83, v83, v223
    s_sub_u32 s25, s25, 8192
    s_and_b32 s25, s25, 65535
    v_mfma_f32_16x16x32_bf16 v[32:35], v[200:203], a[240:243], v[32:35]
    v_add_f32 v84, v84, v224
    v_add_f32 v85, v85, v225
    buffer_load_dwordx4 v[72:75], v213, s[8:11], s25 offen offset:0 sc1
    buffer_load_dwordx4 v[76:79], v213, s[8:11], s25 offen offset:1024 sc1
    v_mfma_f32_16x16x32_bf16 v[32:35], v[196:199], a[224:227], v[32:35]
    v_add_f32 v86, v86, v226
    v_add_f32 v87, v87, v227
    s_waitcnt vmcnt(8)
    v_mfma_f32_16x16x32_bf16 v[32:35], v[204:207], v[108:111], v[32:35]
    v_add_f32 v88, v88, v228
    v_add_f32_e64 v89, v89, v229
    v_mfma_f32_16x16x32_bf16 v[48:51], v[208:211], v[124:127], v[32:35]
    buffer_load_dwordx4 v[164:167], v5, s[8:11], s17 offen offset:2048 sc1
    v_add_f32 v90, v90, v230
    v_add_f32 v91, v91, v231
    v_mfma_f32_16x16x32_bf16 v[36:39], v[208:211], v[128:131], v[36:39]
    v_add_f32_e64 v92, v92, v232
    v_add_f32 v93, v93, v233
    v_mfma_f32_16x16x32_bf16 v[52:55], v[204:207], v[112:115], v[36:39]
    v_add_f32_e64 v94, v94, v234
    v_add_f32_e64 v95, v95, v235
    v_mfma_f32_16x16x32_bf16 v[40:43], v[204:207], v[116:119], v[40:43]
    s_sub_u32 s23, s23, 16
    s_and_b32 s23, s23, 127
    v_mfma_f32_16x16x32_bf16 v[56:59], v[208:211], v[132:135], v[40:43]
    buffer_load_dwordx4 v[168:171], v5, s[8:11], s17 offen offset:3072 sc1
    v_mov_b32 v25, 0
    buffer_atomic_add v25, v214, s[8:11], s23 offen sc0 sc1
    v_mfma_f32_16x16x32_bf16 v[44:47], v[208:211], v[136:139], v[44:47]
    v_mfma_f32_16x16x32_bf16 v[60:63], v[204:207], v[120:123], v[44:47]
    s_mov_b32 s16, s17
    s_barrier
    s_waitcnt vmcnt(9)
    v_mfma_f32_16x16x32_bf16 v[32:35], v[140:143], a[0:3], 0
    v_mfma_f32_16x16x32_bf16 v[32:35], v[144:147], a[16:19], v[32:35]
    buffer_load_dwordx4 v[172:175], v6, s[8:11], s16 offen offset:0 sc1
    v_mfma_f32_16x16x32_bf16 v[36:39], v[144:147], a[20:23], 0
    v_mfma_f32_16x16x32_bf16 v[36:39], v[140:143], a[4:7], v[36:39]
    v_mfma_f32_16x16x32_bf16 v[40:43], v[140:143], a[8:11], 0
    v_mfma_f32_16x16x32_bf16 v[40:43], v[144:147], a[24:27], v[40:43]
    buffer_load_dwordx4 v[176:179], v6, s[8:11], s16 offen offset:1024 sc1
    v_mfma_f32_16x16x32_bf16 v[44:47], v[144:147], a[28:31], 0
    s_add_u32 s21, s21, 65536
    s_and_b32 s21, s21, 524287
    v_mfma_f32_16x16x32_bf16 v[44:47], v[140:143], a[12:15], v[44:47]
    v_mul_f32 v48, v48, v20
    v_mul_f32 v49, v49, v20
    s_waitcnt vmcnt(9)
    v_mfma_f32_16x16x32_bf16 v[44:47], v[148:151], a[44:47], v[44:47]
    v_mul_f32 v50, v50, v20
    v_mul_f32_e64 v51, v51, v20
    v_mfma_f32_16x16x32_bf16 v[44:47], v[152:155], a[60:63], v[44:47]
    buffer_load_dwordx4 v[180:183], v6, s[8:11], s16 offen offset:2048 sc1
    v_cvt_pk_bf16_f32 v64, v48, v49
    v_cvt_pk_bf16_f32 v65, v50, v51
    v_mfma_f32_16x16x32_bf16 v[40:43], v[152:155], a[56:59], v[40:43]
    v_mul_f32 v52, v52, v21
    v_mul_f32 v53, v53, v21
    v_mfma_f32_16x16x32_bf16 v[40:43], v[148:151], a[40:43], v[40:43]
    v_mul_f32 v54, v54, v21
    v_mul_f32 v55, v55, v21
    v_mfma_f32_16x16x32_bf16 v[36:39], v[148:151], a[36:39], v[36:39]
    v_cvt_pk_bf16_f32 v66, v52, v53
    v_cvt_pk_bf16_f32 v67, v54, v55
    v_mfma_f32_16x16x32_bf16 v[36:39], v[152:155], a[52:55], v[36:39]
    buffer_load_dwordx4 v[184:187], v6, s[8:11], s16 offen offset:3072 sc1
    buffer_store_dwordx4 v[64:67], v212, s[8:11], s21 offen offset:0 sc1
    v_mul_f32_e64 v56, v56, v22
    v_mfma_f32_16x16x32_bf16 v[32:35], v[152:155], a[48:51], v[32:35]
    v_mul_f32 v57, v57, v22
    v_mul_f32 v58, v58, v22
    v_mfma_f32_16x16x32_bf16 v[32:35], v[148:151], a[32:35], v[32:35]
    v_mul_f32_e64 v59, v59, v22
    v_cvt_pk_bf16_f32 v68, v56, v57
    s_waitcnt vmcnt(10)
    v_mfma_f32_16x16x32_bf16 v[32:35], v[156:159], a[64:67], v[32:35]
    v_cvt_pk_bf16_f32 v69, v58, v59
    v_mul_f32 v60, v60, v23
    v_mfma_f32_16x16x32_bf16 v[32:35], v[160:163], a[80:83], v[32:35]
    buffer_load_dwordx4 v[188:191], v7, s[8:11], s16 offen offset:0 sc1
    v_mul_f32 v61, v61, v23
    v_mul_f32 v62, v62, v23
    v_mfma_f32_16x16x32_bf16 v[36:39], v[160:163], a[84:87], v[36:39]
    v_mul_f32_e64 v63, v63, v23
    v_cvt_pk_bf16_f32 v70, v60, v61
    v_mfma_f32_16x16x32_bf16 v[36:39], v[156:159], a[68:71], v[36:39]
    v_cvt_pk_bf16_f32 v71, v62, v63
    buffer_store_dwordx4 v[68:71], v212, s[8:11], s21 offen offset:1024 sc1
    v_mfma_f32_16x16x32_bf16 v[40:43], v[156:159], a[72:75], v[40:43]
    s_waitcnt vmcnt(7)
    v_cmp_ne_u32_e64 vcc, 1, v25
    s_nop 0
    s_and_b32 s24, vcc_lo, 1
    s_cbranch_scc1 L_k3_slowt5
L_k3_backt5:
    v_mfma_f32_16x16x32_bf16 v[40:43], v[160:163], a[88:91], v[40:43]
    buffer_load_dwordx4 v[192:195], v7, s[8:11], s16 offen offset:1024 sc1
    s_sub_u32 s25, s25, 8192
    s_and_b32 s25, s25, 65535
    v_mfma_f32_16x16x32_bf16 v[44:47], v[160:163], a[92:95], v[44:47]
    buffer_load_dwordx4 v[236:239], v213, s[8:11], s25 offen offset:0 sc1
    buffer_load_dwordx4 v[240:243], v213, s[8:11], s25 offen offset:1024 sc1
    v_mfma_f32_16x16x32_bf16 v[44:47], v[156:159], a[76:79], v[44:47]
    s_waitcnt vmcnt(11)
    v_mfma_f32_16x16x32_bf16 v[44:47], v[164:167], a[108:111], v[44:47]
    v_mfma_f32_16x16x32_bf16 v[44:47], v[168:171], a[124:127], v[44:47]
    buffer_load_dwordx4 v[196:199], v7, s[8:11], s16 offen offset:2048 sc1
    v_mfma_f32_16x16x32_bf16 v[40:43], v[168:171], a[120:123], v[40:43]
    v_mfma_f32_16x16x32_bf16 v[40:43], v[164:167], a[104:107], v[40:43]
    v_mfma_f32_16x16x32_bf16 v[36:39], v[164:167], a[100:103], v[36:39]
    v_lshlrev_b32 v220, 16, v72
    v_and_b32 v221, 0xffff0000, v72
    v_mfma_f32_16x16x32_bf16 v[36:39], v[168:171], a[116:119], v[36:39]
    buffer_load_dwordx4 v[200:203], v7, s[8:11], s16 offen offset:3072 sc1
    v_lshlrev_b32_e64 v222, 16, v73
    v_and_b32 v223, 0xffff0000, v73
    v_mfma_f32_16x16x32_bf16 v[32:35], v[168:171], a[112:115], v[32:35]
    v_lshlrev_b32_e64 v224, 16, v74
    v_and_b32 v225, 0xffff0000, v74
    v_mfma_f32_16x16x32_bf16 v[32:35], v[164:167], a[96:99], v[32:35]
    v_lshlrev_b32 v226, 16, v75
    v_and_b32 v227, 0xffff0000, v75
    s_waitcnt vmcnt(10)
    v_mfma_f32_16x16x32_bf16 v[32:35], v[172:175], a[128:131], v[32:35]
    v_lshlrev_b32 v228, 16, v76
    v_and_b32 v229, 0xffff0000, v76
    v_mfma_f32_16x16x32_bf16 v[32:35], v[176:179], a[144:147], v[32:35]
    buffer_load_dwordx4 v[204:207], v8, s[8:11], s16 offen offset:0 sc1
    v_lshlrev_b32 v230, 16, v77
    v_and_b32 v231, 0xffff0000, v77
    v_mfma_f32_16x16x32_bf16 v[36:39], v[176:179], a[148:151], v[36:39]
    v_lshlrev_b32_e64 v232, 16, v78
    v_and_b32 v233, 0xffff0000, v78
    v_mfma_f32_16x16x32_bf16 v[36:39], v[172:175], a[132:135], v[36:39]
    v_lshlrev_b32 v234, 16, v79
    v_and_b32 v235, 0xffff0000, v79
    v_mfma_f32_16x16x32_bf16 v[40:43], v[172:175], a[136:139], v[40:43]
    v_add_f32 v80, v80, v220
    v_add_f32 v81, v81, v221
    v_mfma_f32_16x16x32_bf16 v[40:43], v[176:179], a[152:155], v[40:43]
    buffer_load_dwordx4 v[208:211], v8, s[8:11], s16 offen offset:1024 sc1
    v_add_f32 v82, v82, v222
    v_add_f32_e64 v83, v83, v223
    v_mfma_f32_16x16x32_bf16 v[44:47], v[176:179], a[156:159], v[44:47]
    v_add_f32 v84, v84, v224
    v_add_f32 v85, v85, v225
    v_mfma_f32_16x16x32_bf16 v[44:47], v[172:175], a[140:143], v[44:47]
    v_add_f32 v86, v86, v226
    v_add_f32 v87, v87, v227
    s_waitcnt vmcnt(10)
    v_mfma_f32_16x16x32_bf16 v[44:47], v[180:183], a[172:175], v[44:47]
    v_add_f32 v88, v88, v228
    v_add_f32_e64 v89, v89, v229
    s_sub_u32 s25, s25, 8192
    s_and_b32 s25, s25, 65535
    v_mfma_f32_16x16x32_bf16 v[44:47], v[184:187], a[188:191], v[44:47]
    v_add_f32 v90, v90, v230
    v_add_f32_e64 v91, v91, v231
    s_mov_b32 s74, s25
    buffer_load_dwordx4 v[140:143], v213, s[8:11], s25 offen offset:0 sc1
    v_mfma_f32_16x16x32_bf16 v[40:43], v[184:187], a[184:187], v[40:43]
    v_add_f32 v92, v92, v232
    v_add_f32 v93, v93, v233
    buffer_load_dwordx4 v[144:147], v213, s[8:11], s25 offen offset:1024 sc1
    v_mfma_f32_16x16x32_bf16 v[40:43], v[180:183], a[168:171], v[40:43]
    v_add_f32 v94, v94, v234
    v_add_f32 v95, v95, v235
    v_mfma_f32_16x16x32_bf16 v[36:39], v[180:183], a[164:167], v[36:39]
    s_waitcnt vmcnt(6)
    v_lshlrev_b32 v220, 16, v236
    v_and_b32 v221, 0xffff0000, v236
    v_mfma_f32_16x16x32_bf16 v[36:39], v[184:187], a[180:183], v[36:39]
    v_lshlrev_b32_e64 v222, 16, v237
    v_and_b32 v223, 0xffff0000, v237
    v_mfma_f32_16x16x32_bf16 v[32:35], v[184:187], a[176:179], v[32:35]
    v_lshlrev_b32 v224, 16, v238
    v_and_b32 v225, 0xffff0000, v238
    v_mfma_f32_16x16x32_bf16 v[32:35], v[180:183], a[160:163], v[32:35]
    v_lshlrev_b32 v226, 16, v239
    v_and_b32 v227, 0xffff0000, v239
    s_waitcnt vmcnt(8)
    v_mfma_f32_16x16x32_bf16 v[32:35], v[188:191], a[192:195], v[32:35]
    v_lshlrev_b32 v228, 16, v240
    v_and_b32 v229, 0xffff0000, v240
    v_mfma_f32_16x16x32_bf16 v[32:35], v[192:195], a[208:211], v[32:35]
    v_lshlrev_b32 v230, 16, v241
    v_and_b32 v231, 0xffff0000, v241
    v_mfma_f32_16x16x32_bf16 v[36:39], v[192:195], a[212:215], v[36:39]
    v_lshlrev_b32 v232, 16, v242
    v_and_b32 v233, 0xffff0000, v242
    v_mfma_f32_16x16x32_bf16 v[36:39], v[188:191], a[196:199], v[36:39]
    v_lshlrev_b32_e64 v234, 16, v243
    v_and_b32 v235, 0xffff0000, v243
    v_mfma_f32_16x16x32_bf16 v[40:43], v[188:191], a[200:203], v[40:43]
    v_add_f32 v80, v80, v220
    v_add_f32 v81, v81, v221
    v_mfma_f32_16x16x32_bf16 v[40:43], v[192:195], a[216:219], v[40:43]
    v_add_f32 v82, v82, v222
    v_add_f32 v83, v83, v223
    v_mfma_f32_16x16x32_bf16 v[44:47], v[192:195], a[220:223], v[44:47]
    v_add_f32 v84, v84, v224
    v_add_f32 v85, v85, v225
    v_mfma_f32_16x16x32_bf16 v[44:47], v[188:191], a[204:207], v[44:47]
    v_add_f32 v86, v86, v226
    v_add_f32 v87, v87, v227
    s_waitcnt vmcnt(4)
    v_mfma_f32_16x16x32_bf16 v[44:47], v[196:199], a[236:239], v[44:47]
    v_add_f32 v88, v88, v228
    v_add_f32 v89, v89, v229
    v_mfma_f32_16x16x32_bf16 v[44:47], v[200:203], a[252:255], v[44:47]
    v_add_f32 v90, v90, v230
    v_add_f32_e64 v91, v91, v231
    v_mfma_f32_16x16x32_bf16 v[40:43], v[200:203], a[248:251], v[40:43]
    v_add_f32_e64 v92, v92, v232
    v_add_f32_e64 v93, v93, v233
    v_mfma_f32_16x16x32_bf16 v[40:43], v[196:199], a[232:235], v[40:43]
    v_add_f32_e64 v94, v94, v234
    v_add_f32_e64 v95, v95, v235
    v_mfma_f32_16x16x32_bf16 v[36:39], v[196:199], a[228:231], v[36:39]
    v_mfma_f32_16x16x32_bf16 v[36:39], v[200:203], a[244:247], v[36:39]
    v_mfma_f32_16x16x32_bf16 v[32:35], v[200:203], a[240:243], v[32:35]
    v_mfma_f32_16x16x32_bf16 v[32:35], v[196:199], a[224:227], v[32:35]
    s_waitcnt vmcnt(2)
    v_mfma_f32_16x16x32_bf16 v[32:35], v[204:207], v[108:111], v[32:35]
    v_mfma_f32_16x16x32_bf16 v[48:51], v[208:211], v[124:127], v[32:35]
    v_mfma_f32_16x16x32_bf16 v[36:39], v[208:211], v[128:131], v[36:39]
    v_mfma_f32_16x16x32_bf16 v[52:55], v[204:207], v[112:115], v[36:39]
    v_mfma_f32_16x16x32_bf16 v[40:43], v[204:207], v[116:119], v[40:43]
    s_sub_u32 s25, s25, 8192
    s_and_b32 s25, s25, 65535
    v_mfma_f32_16x16x32_bf16 v[56:59], v[208:211], v[132:135], v[40:43]
    s_mov_b32 s75, s25
    buffer_load_dwordx4 v[148:151], v213, s[8:11], s25 offen offset:0 sc1
    v_mfma_f32_16x16x32_bf16 v[44:47], v[208:211], v[136:139], v[44:47]
    buffer_load_dwordx4 v[152:155], v213, s[8:11], s25 offen offset:1024 sc1
    v_mfma_f32_16x16x32_bf16 v[60:63], v[204:207], v[120:123], v[44:47]
    v_fma_f32 v80, v48, v20, v80
    v_fma_f32 v81, v49, v20, v81
    v_fma_f32 v82, v50, v20, v82
    v_fma_f32 v83, v51, v20, v83
    v_fma_f32 v84, v52, v21, v84
    v_fma_f32 v85, v53, v21, v85
    v_fma_f32 v86, v54, v21, v86
    v_fma_f32 v87, v55, v21, v87
    v_fma_f32 v88, v56, v22, v88
    v_fma_f32 v89, v57, v22, v89
    v_fma_f32 v90, v58, v22, v90
    v_fma_f32 v91, v59, v22, v91
    v_fma_f32 v92, v60, v23, v92
    v_fma_f32 v93, v61, v23, v93
    v_fma_f32 v94, v62, v23, v94
    v_fma_f32 v95, v63, v23, v95
    s_waitcnt vmcnt(2)
    v_max3_u32 v104, v140, v141, v142
    v_max3_u32 v105, v143, v144, v145
    v_max3_u32 v104, v104, v146, v147
    v_max_u32 v104, v104, v105
    v_cmp_eq_u32 vcc, -1, v104
    s_cbranch_vccnz L_k3_slowq6
L_k3_backq6:
    v_lshlrev_b32 v220, 16, v140
    v_and_b32 v221, 0xffff0000, v140
    v_lshlrev_b32 v222, 16, v141
    v_and_b32 v223, 0xffff0000, v141
    v_lshlrev_b32 v224, 16, v142
    v_and_b32 v225, 0xffff0000, v142
    v_lshlrev_b32 v226, 16, v143
    v_and_b32 v227, 0xffff0000, v143
    v_lshlrev_b32_e64 v228, 16, v144
    v_and_b32 v229, 0xffff0000, v144
    v_lshlrev_b32 v230, 16, v145
    v_and_b32 v231, 0xffff0000, v145
    v_lshlrev_b32 v232, 16, v146
    v_and_b32 v233, 0xffff0000, v146
    v_lshlrev_b32 v234, 16, v147
    v_and_b32 v235, 0xffff0000, v147
    v_add_f32 v80, v80, v220
    v_add_f32 v81, v81, v221
    v_add_f32 v82, v82, v222
    v_add_f32 v83, v83, v223
    v_add_f32 v84, v84, v224
    v_add_f32 v85, v85, v225
    v_add_f32 v86, v86, v226
    v_add_f32 v87, v87, v227
    v_add_f32 v88, v88, v228
    v_add_f32 v89, v89, v229
    v_add_f32 v90, v90, v230
    v_add_f32 v91, v91, v231
    v_add_f32 v92, v92, v232
    v_add_f32 v93, v93, v233
    v_add_f32 v94, v94, v234
    v_add_f32 v95, v95, v235
    s_waitcnt vmcnt(0)
    v_max3_u32 v104, v148, v149, v150
    v_max3_u32 v105, v151, v152, v153
    v_max3_u32 v104, v104, v154, v155
    v_max_u32 v104, v104, v105
    v_cmp_eq_u32 vcc, -1, v104
    s_cbranch_vccnz L_k3_slowq7
L_k3_backq7:
    v_lshlrev_b32 v220, 16, v148
    v_and_b32 v221, 0xffff0000, v148
    v_lshlrev_b32 v222, 16, v149
    v_and_b32 v223, 0xffff0000, v149
    v_lshlrev_b32 v224, 16, v150
    v_and_b32 v225, 0xffff0000, v150
    v_lshlrev_b32_e64 v226, 16, v151
    v_and_b32 v227, 0xffff0000, v151
    v_lshlrev_b32 v228, 16, v152
    v_and_b32 v229, 0xffff0000, v152
    v_lshlrev_b32 v230, 16, v153
    v_and_b32 v231, 0xffff0000, v153
    v_lshlrev_b32 v232, 16, v154
    v_and_b32 v233, 0xffff0000, v154
    v_lshlrev_b32 v234, 16, v155
    v_and_b32 v235, 0xffff0000, v155
    v_add_f32 v80, v80, v220
    v_add_f32 v81, v81, v221
    v_add_f32 v82, v82, v222
    v_add_f32 v83, v83, v223
    v_add_f32 v84, v84, v224
    v_add_f32 v85, v85, v225
    v_add_f32 v86, v86, v226
    v_add_f32 v87, v87, v227
    v_add_f32 v88, v88, v228
    v_add_f32 v89, v89, v229
    v_add_f32 v90, v90, v230
    v_add_f32 v91, v91, v231
    v_add_f32 v92, v92, v232
    v_add_f32 v93, v93, v233
    v_add_f32_e64 v94, v94, v234
    v_add_f32_e64 v95, v95, v235
    v_cvt_pk_bf16_f32 v64, v80, v81
    v_cvt_pk_bf16_f32 v65, v82, v83
    ds_write_b64 v217, v[64:65] offset:0
    v_cvt_pk_bf16_f32 v66, v84, v85
    v_cvt_pk_bf16_f32 v67, v86, v87
    ds_write_b64 v217, v[66:67] offset:2048
    v_cvt_pk_bf16_f32 v68, v88, v89
    v_cvt_pk_bf16_f32 v69, v90, v91
    ds_write_b64 v217, v[68:69] offset:4096
    v_cvt_pk_bf16_f32 v70, v92, v93
    v_cvt_pk_bf16_f32 v71, v94, v95
    ds_write_b64 v217, v[70:71] offset:6144
    s_add_u32 s72, s29, 9216
    s_waitcnt lgkmcnt(0)
    s_barrier
    ds_read_b128 v[64:67], v218 offset:0
    ds_read_b128 v[68:71], v218 offset:1024
    s_waitcnt lgkmcnt(1)
    buffer_store_dwordx4 v[64:67], v27, s[12:15], s29 offen nt
    s_waitcnt lgkmcnt(0)
    buffer_store_dwordx4 v[68:71], v27, s[12:15], s72 offen nt
L_exit:
    s_endpgm
L_k3_slow3:
    s_cmp_eq_u32 s31, 0
    s_cbranch_scc1 L_k3_back3
    s_sub_u32 s31, s31, 1
    s_sleep 8
    buffer_load_dword v25, v223, s[8:11], 0 offen sc1
    s_waitcnt vmcnt(0)
    v_cmp_ne_u32 vcc, 32, v25
    s_cbranch_vccnz L_k3_slow3
    s_branch L_k3_back3
L_k3_slowt5:
    s_cmp_eq_u32 s31, 0
    s_cbranch_scc1 L_k3_backt5
    s_sub_u32 s31, s31, 1
    v_mov_b32 v25, 0
    buffer_atomic_add v25, v214, s[8:11], s23 offen sc0 sc1
    s_waitcnt vmcnt(0)
    v_cmp_ne_u32_e64 vcc, 1, v25
    s_nop 0
    s_and_b32 s24, vcc_lo, 1
    s_cbranch_scc1 L_k3_slowt5
    s_branch L_k3_backt5
L_k3_slowq6:
    s_cmp_eq_u32 s31, 0
    s_cbranch_scc1 L_k3_backq6
    s_sub_u32 s31, s31, 1
    buffer_load_dwordx4 v[140:143], v213, s[8:11], s74 offen offset:0 sc1
    buffer_load_dwordx4 v[144:147], v213, s[8:11], s74 offen offset:1024 sc1
    s_waitcnt vmcnt(0)
    v_max3_u32 v104, v140, v141, v142
    v_max3_u32 v105, v143, v144, v145
    v_max3_u32 v104, v104, v146, v147
    v_max_u32 v104, v104, v105
    v_cmp_eq_u32 vcc, -1, v104
    s_cbranch_vccnz L_k3_slowq6
    s_branch L_k3_backq6
L_k3_slowq7:
    s_cmp_eq_u32 s31, 0
    s_cbranch_scc1 L_k3_backq7
    s_sub_u32 s31, s31, 1
    buffer_load_dwordx4 v[148:151], v213, s[8:11], s75 offen offset:0 sc1
    buffer_load_dwordx4 v[152:155], v213, s[8:11], s75 offen offset:1024 sc1
    s_waitcnt vmcnt(0)
    v_max3_u32 v104, v148, v149, v150
    v_max3_u32 v105, v151, v152, v153
    v_max3_u32 v104, v104, v154, v155
    v_max_u32 v104, v104, v105
    v_cmp_eq_u32 vcc, -1, v104
    s_cbranch_vccnz L_k3_slowq7
    s_branch L_k3_backq7
L_k3_slows12:
    s_cmp_eq_u32 s31, 0
    s_cbranch_scc1 L_k3_backs12
    s_sub_u32 s31, s31, 1
    v_mov_b32 v25, 0
    buffer_atomic_add v25, v26, s[8:11], s26 offen sc0 sc1
    s_waitcnt vmcnt(0)
    v_cmp_ne_u32 vcc, 1, v25
    s_nop 0
    s_and_b32 s24, vcc_lo, 255
    s_cbranch_scc1 L_k3_slows12
    s_branch L_k3_backs12
L_k3_slows13:
    s_cmp_eq_u32 s31, 0
    s_cbranch_scc1 L_k3_backs13
    s_sub_u32 s31, s31, 1
    v_mov_b32 v25, 0
    buffer_atomic_add v25, v214, s[8:11], s23 offen sc0 sc1
    s_waitcnt vmcnt(0)
    v_cmp_ne_u32 vcc, 1, v25
    s_nop 0
    s_and_b32 s24, vcc_lo, 1
    s_cbranch_scc1 L_k3_slows13
    s_branch L_k3_backs13
L_k3_slows14:
    s_cmp_eq_u32 s31, 0
    s_cbranch_scc1 L_k3_backs14
    s_sub_u32 s31, s31, 1
    v_mov_b32_e64 v25, 0
    buffer_atomic_add v25, v214, s[8:11], s23 offen sc0 sc1
    s_waitcnt vmcnt(0)
    v_cmp_ne_u32 vcc, 1, v25
    s_nop 0
    s_and_b32 s24, vcc_lo, 1
    s_cbranch_scc1 L_k3_slows14
    s_branch L_k3_backs14
L_k3_slows15:
    s_cmp_eq_u32 s31, 0
    s_cbranch_scc1 L_k3_backs15
    s_sub_u32 s31, s31, 1
    v_mov_b32 v25, 0
    buffer_atomic_add v25, v214, s[8:11], s23 offen sc0 sc1
    s_waitcnt vmcnt(0)
    v_cmp_ne_u32 vcc, 1, v25
    s_nop 0
    s_and_b32 s24, vcc_lo, 1
    s_cbranch_scc1 L_k3_slows15
    s_branch L_k3_backs15
L_k3_slows16:
    s_cmp_eq_u32 s31, 0
    s_cbranch_scc1 L_k3_backs16
    s_sub_u32 s31, s31, 1
    v_mov_b32 v25, 0
    buffer_atomic_add v25, v214, s[8:11], s23 offen sc0 sc1
    s_waitcnt vmcnt(0)
    v_cmp_ne_u32 vcc, 1, v25
    s_nop 0
    s_and_b32 s24, vcc_lo, 1
    s_cbranch_scc1 L_k3_slows16
    s_branch L_k3_backs16
L_aux:
    s_cmp_ge_u32 s2, 216
    s_cbranch_scc1 L_aux_st
    s_sub_u32 s62, s2, 144
    v_mov_b32 v5, 1
    s_mov_b32 s80, 1
    s_cmp_lg_u32 s62, 0
    s_cbranch_scc1 L_aux_0
    v_lshlrev_b32 v1, 4, v0
    s_mov_b32 s27, 38338560
    buffer_store_dwordx4 v[92:95], v1, s[8:11], s27 offen sc1
    s_mov_b32 s27, 38342656
    buffer_store_dwordx4 v[92:95], v1, s[8:11], s27 offen sc1
    s_mov_b32 s27, 38346752
    buffer_store_dwordx4 v[92:95], v1, s[8:11], s27 offen sc1
    s_mov_b32 s27, 38350848
    buffer_store_dwordx4 v[92:95], v1, s[8:11], s27 offen sc1
    v_min_u32 v1, 1, v0
    v_lshlrev_b32 v1, 31, v1
    s_waitcnt vmcnt(0)
    s_barrier
    buffer_store_dword v5, v1, s[4:7], 0 offen sc1
    s_branch L_aux_1
L_aux_0:
    s_mov_b32 s80, 0
    s_cmp_lg_u32 s3, 3
    s_cbranch_scc1 L_aux_1
    s_cmp_gt_u32 s62, 25
    s_cbranch_scc1 L_aux_1
    s_mov_b32 s80, 1
    v_lshlrev_b32 v1, 4, v2
    s_lshl_b32 s28, s62, 11
    s_add_u32 s28, s28, 38352896
    buffer_store_dwordx4 v[92:95], v1, s[8:11], s28 offen sc1
    buffer_store_dwordx4 v[92:95], v1, s[8:11], s28 offen offset:1024 sc1
    s_waitcnt vmcnt(0)
    s_mov_b64 exec, 1
    buffer_atomic_add v5, off, s[4:7], 0 offset:128 sc1
    s_mov_b64 exec, -1
L_aux_1:
    s_and_b32 s28, s62, 7
    s_mul_i32 s28, s28, 9
    s_lshr_b32 s62, s62, 3
    s_add_u32 s62, s62, s28
    s_mov_b32 s20, s52
    s_and_b32 s21, s53, 0xffff
    s_mov_b32 s22, 5308416
    s_mov_b32 s23, 0x20000
    s_lshl_b32 s64, s62, 7
    s_add_u32 s28, s64, s20
    s_bfe_u32 s28, s28, 0x30007
    s_cmp_eq_u32 s28, 3
    s_cselect_b32 s80, 1, s80
    s_mul_i32 s65, s3, 294912
    s_add_u32 s64, s64, s65
    s_mov_b32 s63, 9216
    s_mov_b32 s68, 73728
    s_mov_b32 s69, 958464
    s_lshl_b32 s66, s3, 12
    v_lshrrev_b32 v1, 3, v2
    v_mul_u32_u24 v124, s63, v1
    v_lshrrev_b32 v1, 4, v2
    v_lshlrev_b32 v1, 1, v1
    v_xor_b32 v1, v1, v2
    v_and_b32 v1, 7, v1
    v_lshl_add_u32 v124, v1, 4, v124
    v_lshrrev_b32 v1, 2, v2
    v_lshl_add_u32 v120, v1, 7, s66
    v_bfe_u32 v1, v2, 3, 2
    v_lshl_add_u32 v120, v1, 5, v120
    v_and_b32_e64 v1, 3, v2
    v_lshl_add_u32 v120, v1, 3, v120
    v_xor_b32_e64 v121, 32, v120
    v_xor_b32_e64 v122, 64, v120
    v_xor_b32 v123, 96, v120
    v_lshlrev_b32_e64 v125, 4, v2
    s_add_u32 m0, s66, 0
    s_nop 0
    buffer_load_dwordx4 v124, s[20:23], s64 offen nt lds
    s_add_u32 m0, s66, 1024
    s_add_u32 s64, s64, s68
    buffer_load_dwordx4 v124, s[20:23], s64 offen nt lds
    s_add_u32 m0, s66, 2048
    s_add_u32 s64, s64, s68
    buffer_load_dwordx4 v124, s[20:23], s64 offen nt lds
    s_add_u32 m0, s66, 3072
    s_add_u32 s64, s64, s68
    buffer_load_dwordx4 v124, s[20:23], s64 offen nt lds
    s_add_u32 s64, s64, s69
    s_cmp_eq_u32 s80, 1
    s_cbranch_scc1 L_aux_go
    s_waitcnt vmcnt(0)
L_aux_go:
    s_add_u32 m0, s66, 16384
    s_nop 0
    buffer_load_dwordx4 v124, s[20:23], s64 offen nt lds
    s_add_u32 m0, s66, 17408
    s_add_u32 s64, s64, s68
    buffer_load_dwordx4 v124, s[20:23], s64 offen nt lds
    s_add_u32 m0, s66, 18432
    s_add_u32 s64, s64, s68
    buffer_load_dwordx4 v124, s[20:23], s64 offen nt lds
    s_add_u32 m0, s66, 19456
    s_add_u32 s64, s64, s68
    buffer_load_dwordx4 v124, s[20:23], s64 offen nt lds
    s_add_u32 s64, s64, s69
    s_add_u32 m0, s66, 32768
    s_nop 0
    buffer_load_dwordx4 v124, s[20:23], s64 offen nt lds
    s_add_u32 m0, s66, 33792
    s_add_u32 s64, s64, s68
    buffer_load_dwordx4 v124, s[20:23], s64 offen nt lds
    s_add_u32 m0, s66, 34816
    s_add_u32 s64, s64, s68
    buffer_load_dwordx4 v124, s[20:23], s64 offen nt lds
    s_add_u32 m0, s66, 35840
    s_add_u32 s64, s64, s68
    buffer_load_dwordx4 v124, s[20:23], s64 offen nt lds
    s_add_u32 s64, s64, s69
    s_add_u32 m0, s66, 49152
    s_nop 0
    buffer_load_dwordx4 v124, s[20:23], s64 offen nt lds
    s_add_u32 m0, s66, 50176
    s_add_u32 s64, s64, s68
    buffer_load_dwordx4 v124, s[20:23], s64 offen nt lds
    s_add_u32 m0, s66, 51200
    s_add_u32 s64, s64, s68
    buffer_load_dwordx4 v124, s[20:23], s64 offen nt lds
    s_add_u32 m0, s66, 52224
    s_add_u32 s64, s64, s68
    buffer_load_dwordx4 v124, s[20:23], s64 offen nt lds
    s_add_u32 s64, s64, s69
    s_cmp_ge_u32 s3, 2
    s_cbranch_scc1 L_aux_a
    s_add_u32 m0, s66, 65536
    s_nop 0
    buffer_load_dwordx4 v124, s[20:23], s64 offen nt lds
    s_add_u32 m0, s66, 66560
    s_add_u32 s64, s64, s68
    buffer_load_dwordx4 v124, s[20:23], s64 offen nt lds
    s_add_u32 m0, s66, 67584
    s_add_u32 s64, s64, s68
    buffer_load_dwordx4 v124, s[20:23], s64 offen nt lds
    s_add_u32 m0, s66, 68608
    s_add_u32 s64, s64, s68
    buffer_load_dwordx4 v124, s[20:23], s64 offen nt lds
    s_add_u32 s64, s64, s69
L_aux_a:
    s_lshl_b32 s30, s2, 2
    s_add_u32 s30, s30, s3
    s_add_u32 s30, s30, 272
    s_mov_b32 s20, s54
    s_and_b32 s21, s55, 0xffff
    s_mov_b32 s22, 5308416
    s_mov_b32 s23, 0x20000
    s_mul_hi_u32 s28, s30, 0xe38e38f
    s_mul_i32 s29, s28, 18
    s_sub_u32 s29, s30, s29
    s_mul_hi_u32 s64, s28, 0x1c71c71d
    s_mul_i32 s64, s64, 662400
    s_lshl_b32 s65, s28, 7
    s_add_u32 s64, s64, s65
    s_mul_i32 s65, s29, 36864
    s_add_u32 s64, s64, s65
    s_mul_i32 s65, s28, 73728
    s_lshl_b32 s67, s29, 10
    s_add_u32 s65, s65, s67
    s_add_u32 s65, s65, 14155776
    s_mov_b32 s63, 1152
    s_mov_b32 s68, 9216
    s_mov_b32 s69, 9216
    s_mov_b32 s81, s65
    v_add_u32 v250, 98304, v120
    v_add_u32 v251, 98304, v121
    v_add_u32 v252, 98304, v122
    v_add_u32 v253, 98304, v123
    s_mov_b32 s83, 4096
    v_lshrrev_b32_e64 v1, 3, v2
    v_mul_u32_u24 v1, 8064, v1
    v_sub_u32 v124, v124, v1
    s_add_u32 m0, s66, 98304
    s_nop 0
    buffer_load_dwordx4 v124, s[20:23], s64 offen nt lds
    s_add_u32 m0, s66, 99328
    s_add_u32 s64, s64, s68
    buffer_load_dwordx4 v124, s[20:23], s64 offen nt lds
    s_add_u32 m0, s66, 100352
    s_add_u32 s64, s64, s68
    buffer_load_dwordx4 v124, s[20:23], s64 offen nt lds
    s_add_u32 m0, s66, 101376
    s_add_u32 s64, s64, s68
    buffer_load_dwordx4 v124, s[20:23], s64 offen nt lds
    s_add_u32 s64, s64, s69
    s_mul_i32 s65, s62, 73728
    s_lshl_b32 s67, s3, 10
    s_add_u32 s65, s65, s67
    s_add_u32 s65, s65, 8847360
    v_mov_b32 v192, 0
    v_mov_b32 v193, 0
    v_mov_b32 v194, 0
    v_mov_b32 v195, 0
    v_mov_b32 v196, 0
    v_mov_b32 v197, 0
    v_mov_b32 v198, 0
    v_mov_b32 v199, 0
    v_mov_b32 v200, 0
    v_mov_b32 v201, 0
    v_mov_b32 v202, 0
    v_mov_b32 v203, 0
    v_mov_b32 v204, 0
    v_mov_b32 v205, 0
    v_mov_b32 v206, 0
    v_mov_b32_e64 v207, 0
    v_mov_b32 v4, 1065369472
    v_mov_b32 v5, 1065369472
    v_mov_b32 v6, 1065369472
    v_mov_b32 v7, 1065369472
    s_waitcnt vmcnt(16)
    ds_read_b64_tr_b16 v[128:129], v120 offset:0
    ds_read_b64_tr_b16 v[130:131], v120 offset:2048
    ds_read_b64_tr_b16 v[132:133], v121 offset:0
    ds_read_b64_tr_b16 v[134:135], v121 offset:2048
    ds_read_b64_tr_b16 v[136:137], v122 offset:0
    ds_read_b64_tr_b16 v[138:139], v122 offset:2048
    ds_read_b64_tr_b16 v[140:141], v123 offset:0
    ds_read_b64_tr_b16 v[142:143], v123 offset:2048
    s_waitcnt lgkmcnt(0)
    s_waitcnt vmcnt(12)
    ds_read_b64_tr_b16 v[144:145], v120 offset:16384
    ds_read_b64_tr_b16 v[146:147], v120 offset:18432
    ds_read_b64_tr_b16 v[148:149], v121 offset:16384
    ds_read_b64_tr_b16 v[150:151], v121 offset:18432
    ds_read_b64_tr_b16 v[152:153], v122 offset:16384
    ds_read_b64_tr_b16 v[154:155], v122 offset:18432
    ds_read_b64_tr_b16 v[156:157], v123 offset:16384
    ds_read_b64_tr_b16 v[158:159], v123 offset:18432
    s_waitcnt lgkmcnt(0)
    s_waitcnt vmcnt(8)
    ds_read_b64_tr_b16 v[160:161], v120 offset:32768
    ds_read_b64_tr_b16 v[162:163], v120 offset:34816
    ds_read_b64_tr_b16 v[164:165], v121 offset:32768
    ds_read_b64_tr_b16 v[166:167], v121 offset:34816
    ds_read_b64_tr_b16 v[168:169], v122 offset:32768
    ds_read_b64_tr_b16 v[170:171], v122 offset:34816
    ds_read_b64_tr_b16 v[172:173], v123 offset:32768
    ds_read_b64_tr_b16 v[174:175], v123 offset:34816
    s_waitcnt lgkmcnt(0)
    s_waitcnt vmcnt(4)
    ds_read_b64_tr_b16 v[176:177], v120 offset:49152
    ds_read_b64_tr_b16 v[178:179], v120 offset:51200
    ds_read_b64_tr_b16 v[180:181], v121 offset:49152
    ds_read_b64_tr_b16 v[182:183], v121 offset:51200
    ds_read_b64_tr_b16 v[184:185], v122 offset:49152
    ds_read_b64_tr_b16 v[186:187], v122 offset:51200
    ds_read_b64_tr_b16 v[188:189], v123 offset:49152
    ds_read_b64_tr_b16 v[190:191], v123 offset:51200
    s_waitcnt lgkmcnt(0)
    s_nop 0
    v_add_u32 v120, 65536, v120
    v_add_u32 v121, 65536, v121
    v_add_u32 v122, 65536, v122
    v_add_u32 v123, 65536, v123
    s_cmp_ge_u32 s3, 2
    s_cbranch_scc1 L_aux_b
    ds_read_b64_tr_b16 v[192:193], v120 offset:0
    ds_read_b64_tr_b16 v[194:195], v120 offset:2048
    ds_read_b64_tr_b16 v[196:197], v121 offset:0
    ds_read_b64_tr_b16 v[198:199], v121 offset:2048
    ds_read_b64_tr_b16 v[200:201], v122 offset:0
    ds_read_b64_tr_b16 v[202:203], v122 offset:2048
    ds_read_b64_tr_b16 v[204:205], v123 offset:0
    ds_read_b64_tr_b16 v[206:207], v123 offset:2048
    s_waitcnt lgkmcnt(0)
L_aux_b:
    v_mfma_f32_16x16x32_bf16 v[8:11], v[4:7], v[128:131], 0
    v_mfma_f32_16x16x32_bf16 v[12:15], v[4:7], v[132:135], 0
    v_mfma_f32_16x16x32_bf16 v[16:19], v[4:7], v[136:139], 0
    v_mfma_f32_16x16x32_bf16 v[20:23], v[4:7], v[140:143], 0
    v_mfma_f32_16x16x32_bf16 v[8:11], v[4:7], v[144:147], v[8:11]
    v_mfma_f32_16x16x32_bf16 v[12:15], v[4:7], v[148:151], v[12:15]
    v_mfma_f32_16x16x32_bf16 v[16:19], v[4:7], v[152:155], v[16:19]
    v_mfma_f32_16x16x32_bf16 v[20:23], v[4:7], v[156:159], v[20:23]
    v_mfma_f32_16x16x32_bf16 v[8:11], v[4:7], v[160:163], v[8:11]
    v_mfma_f32_16x16x32_bf16 v[12:15], v[4:7], v[164:167], v[12:15]
    v_mfma_f32_16x16x32_bf16 v[16:19], v[4:7], v[168:171], v[16:19]
    v_mfma_f32_16x16x32_bf16 v[20:23], v[4:7], v[172:175], v[20:23]
    v_mfma_f32_16x16x32_bf16 v[8:11], v[4:7], v[176:179], v[8:11]
    v_mfma_f32_16x16x32_bf16 v[12:15], v[4:7], v[180:183], v[12:15]
    v_mfma_f32_16x16x32_bf16 v[16:19], v[4:7], v[184:187], v[16:19]
    v_mfma_f32_16x16x32_bf16 v[20:23], v[4:7], v[188:191], v[20:23]
    v_mfma_f32_16x16x32_bf16 v[8:11], v[4:7], v[192:195], v[8:11]
    v_mfma_f32_16x16x32_bf16 v[12:15], v[4:7], v[196:199], v[12:15]
    v_mfma_f32_16x16x32_bf16 v[16:19], v[4:7], v[200:203], v[16:19]
    v_mfma_f32_16x16x32_bf16 v[20:23], v[4:7], v[204:207], v[20:23]
    v_and_b32 v1, 15, v2
    v_lshlrev_b32 v1, 4, v1
    v_add_u32 v1, 147456, v1
    s_lshl_b32 s67, s3, 8
    v_add_u32_e64 v3, s67, v1
    v_mov_b32_e64 v24, v8
    v_mov_b32_e64 v25, v12
    v_mov_b32_e64 v26, v16
    v_mov_b32_e64 v27, v20
    ds_write_b128 v3, v[24:27]
    s_mov_b32 s68, 0x00003f80
    s_mov_b32 s69, 0x3f800000
    s_waitcnt lgkmcnt(0)
    s_barrier
    ds_read_b128 v[8:11], v1 offset:0
    ds_read_b128 v[12:15], v1 offset:256
    ds_read_b128 v[16:19], v1 offset:512
    ds_read_b128 v[20:23], v1 offset:768
    s_waitcnt lgkmcnt(0)
    v_pk_add_f32 v[8:9], v[8:9], v[12:13]
    v_pk_add_f32 v[10:11], v[10:11], v[14:15]
    v_pk_add_f32 v[8:9], v[8:9], v[16:17]
    v_pk_add_f32 v[10:11], v[10:11], v[18:19]
    v_pk_add_f32 v[8:9], v[8:9], v[20:21]
    v_pk_add_f32 v[10:11], v[10:11], v[22:23]
    v_mul_f32 v8, 3135475257, v8
    v_mul_f32 v9, 3135475257, v9
    v_mul_f32 v10, 3135475257, v10
    v_mul_f32 v11, 3135475257, v11
    v_dot2_f32_bf16 v32, v128, s68, v8
    v_dot2_f32_bf16 v33, v128, s69, v8
    v_dot2_f32_bf16 v34, v129, s68, v8
    v_dot2_f32_bf16 v35, v129, s69, v8
    v_dot2_f32_bf16 v36, v130, s68, v8
    v_dot2_f32_bf16 v37, v130, s69, v8
    v_dot2_f32_bf16 v38, v131, s68, v8
    v_dot2_f32_bf16 v39, v131, s69, v8
    s_add_u32 s67, s65, 0
    s_nop 0
    v_cvt_pk_bf16_f32 v128, v32, v33
    v_cvt_pk_bf16_f32 v129, v34, v35
    v_cvt_pk_bf16_f32 v130, v36, v37
    v_cvt_pk_bf16_f32 v131, v38, v39
    buffer_store_dwordx4 v[128:131], v125, s[8:11], s67 offen sc1
    v_dot2_f32_bf16 v40, v132, s68, v9
    v_dot2_f32_bf16 v41, v132, s69, v9
    v_dot2_f32_bf16 v42, v133, s68, v9
    v_dot2_f32_bf16 v43, v133, s69, v9
    v_dot2_f32_bf16 v44, v134, s68, v9
    v_dot2_f32_bf16 v45, v134, s69, v9
    v_dot2_f32_bf16 v46, v135, s68, v9
    v_dot2_f32_bf16 v47, v135, s69, v9
    s_add_u32 s67, s65, 18432
    v_cvt_pk_bf16_f32 v132, v40, v41
    v_cvt_pk_bf16_f32 v133, v42, v43
    v_cvt_pk_bf16_f32 v134, v44, v45
    v_cvt_pk_bf16_f32 v135, v46, v47
    buffer_store_dwordx4 v[132:135], v125, s[8:11], s67 offen sc1
    v_dot2_f32_bf16 v32, v136, s68, v10
    v_dot2_f32_bf16 v33, v136, s69, v10
    v_dot2_f32_bf16 v34, v137, s68, v10
    v_dot2_f32_bf16 v35, v137, s69, v10
    v_dot2_f32_bf16 v36, v138, s68, v10
    v_dot2_f32_bf16 v37, v138, s69, v10
    v_dot2_f32_bf16 v38, v139, s68, v10
    v_dot2_f32_bf16 v39, v139, s69, v10
    s_add_u32 s67, s65, 36864
    v_cvt_pk_bf16_f32 v136, v32, v33
    v_cvt_pk_bf16_f32 v137, v34, v35
    v_cvt_pk_bf16_f32 v138, v36, v37
    v_cvt_pk_bf16_f32 v139, v38, v39
    buffer_store_dwordx4 v[136:139], v125, s[8:11], s67 offen sc1
    v_dot2_f32_bf16 v40, v140, s68, v11
    v_dot2_f32_bf16 v41, v140, s69, v11
    v_dot2_f32_bf16 v42, v141, s68, v11
    v_dot2_f32_bf16 v43, v141, s69, v11
    v_dot2_f32_bf16 v44, v142, s68, v11
    v_dot2_f32_bf16 v45, v142, s69, v11
    v_dot2_f32_bf16 v46, v143, s68, v11
    v_dot2_f32_bf16 v47, v143, s69, v11
    s_add_u32 s67, s65, 55296
    v_cvt_pk_bf16_f32 v140, v40, v41
    v_cvt_pk_bf16_f32 v141, v42, v43
    v_cvt_pk_bf16_f32 v142, v44, v45
    v_cvt_pk_bf16_f32 v143, v46, v47
    buffer_store_dwordx4 v[140:143], v125, s[8:11], s67 offen sc1
    v_dot2_f32_bf16 v32, v144, s68, v8
    v_dot2_f32_bf16 v33, v144, s69, v8
    v_dot2_f32_bf16 v34, v145, s68, v8
    v_dot2_f32_bf16 v35, v145, s69, v8
    v_dot2_f32_bf16 v36, v146, s68, v8
    v_dot2_f32_bf16 v37, v146, s69, v8
    v_dot2_f32_bf16 v38, v147, s68, v8
    v_dot2_f32_bf16 v39, v147, s69, v8
    s_add_u32 s67, s65, 4096
    v_cvt_pk_bf16_f32 v144, v32, v33
    v_cvt_pk_bf16_f32 v145, v34, v35
    v_cvt_pk_bf16_f32 v146, v36, v37
    v_cvt_pk_bf16_f32 v147, v38, v39
    buffer_store_dwordx4 v[144:147], v125, s[8:11], s67 offen sc1
    v_dot2_f32_bf16 v40, v148, s68, v9
    v_dot2_f32_bf16 v41, v148, s69, v9
    v_dot2_f32_bf16 v42, v149, s68, v9
    v_dot2_f32_bf16 v43, v149, s69, v9
    v_dot2_f32_bf16 v44, v150, s68, v9
    v_dot2_f32_bf16 v45, v150, s69, v9
    v_dot2_f32_bf16 v46, v151, s68, v9
    v_dot2_f32_bf16 v47, v151, s69, v9
    s_add_u32 s67, s65, 22528
    v_cvt_pk_bf16_f32 v148, v40, v41
    v_cvt_pk_bf16_f32 v149, v42, v43
    v_cvt_pk_bf16_f32 v150, v44, v45
    v_cvt_pk_bf16_f32 v151, v46, v47
    buffer_store_dwordx4 v[148:151], v125, s[8:11], s67 offen sc1
    v_dot2_f32_bf16 v32, v152, s68, v10
    v_dot2_f32_bf16 v33, v152, s69, v10
    v_dot2_f32_bf16 v34, v153, s68, v10
    v_dot2_f32_bf16 v35, v153, s69, v10
    v_dot2_f32_bf16 v36, v154, s68, v10
    v_dot2_f32_bf16 v37, v154, s69, v10
    v_dot2_f32_bf16 v38, v155, s68, v10
    v_dot2_f32_bf16 v39, v155, s69, v10
    s_add_u32 s67, s65, 40960
    v_cvt_pk_bf16_f32 v152, v32, v33
    v_cvt_pk_bf16_f32 v153, v34, v35
    v_cvt_pk_bf16_f32 v154, v36, v37
    v_cvt_pk_bf16_f32 v155, v38, v39
    buffer_store_dwordx4 v[152:155], v125, s[8:11], s67 offen sc1
    v_dot2_f32_bf16 v40, v156, s68, v11
    v_dot2_f32_bf16 v41, v156, s69, v11
    v_dot2_f32_bf16 v42, v157, s68, v11
    v_dot2_f32_bf16 v43, v157, s69, v11
    v_dot2_f32_bf16 v44, v158, s68, v11
    v_dot2_f32_bf16 v45, v158, s69, v11
    v_dot2_f32_bf16 v46, v159, s68, v11
    v_dot2_f32_bf16 v47, v159, s69, v11
    s_add_u32 s67, s65, 59392
    v_cvt_pk_bf16_f32 v156, v40, v41
    v_cvt_pk_bf16_f32 v157, v42, v43
    v_cvt_pk_bf16_f32 v158, v44, v45
    v_cvt_pk_bf16_f32 v159, v46, v47
    buffer_store_dwordx4 v[156:159], v125, s[8:11], s67 offen sc1
    v_dot2_f32_bf16 v32, v160, s68, v8
    v_dot2_f32_bf16 v33, v160, s69, v8
    v_dot2_f32_bf16 v34, v161, s68, v8
    v_dot2_f32_bf16 v35, v161, s69, v8
    v_dot2_f32_bf16 v36, v162, s68, v8
    v_dot2_f32_bf16 v37, v162, s69, v8
    v_dot2_f32_bf16 v38, v163, s68, v8
    v_dot2_f32_bf16 v39, v163, s69, v8
    s_add_u32 s67, s65, 8192
    v_cvt_pk_bf16_f32 v160, v32, v33
    v_cvt_pk_bf16_f32 v161, v34, v35
    v_cvt_pk_bf16_f32 v162, v36, v37
    v_cvt_pk_bf16_f32 v163, v38, v39
    buffer_store_dwordx4 v[160:163], v125, s[8:11], s67 offen sc1
    v_dot2_f32_bf16 v40, v164, s68, v9
    v_dot2_f32_bf16 v41, v164, s69, v9
    v_dot2_f32_bf16 v42, v165, s68, v9
    v_dot2_f32_bf16 v43, v165, s69, v9
    v_dot2_f32_bf16 v44, v166, s68, v9
    v_dot2_f32_bf16 v45, v166, s69, v9
    v_dot2_f32_bf16 v46, v167, s68, v9
    v_dot2_f32_bf16 v47, v167, s69, v9
    s_add_u32 s67, s65, 26624
    v_cvt_pk_bf16_f32 v164, v40, v41
    v_cvt_pk_bf16_f32 v165, v42, v43
    v_cvt_pk_bf16_f32 v166, v44, v45
    v_cvt_pk_bf16_f32 v167, v46, v47
    buffer_store_dwordx4 v[164:167], v125, s[8:11], s67 offen sc1
    v_dot2_f32_bf16 v32, v168, s68, v10
    v_dot2_f32_bf16 v33, v168, s69, v10
    v_dot2_f32_bf16 v34, v169, s68, v10
    v_dot2_f32_bf16 v35, v169, s69, v10
    v_dot2_f32_bf16 v36, v170, s68, v10
    v_dot2_f32_bf16 v37, v170, s69, v10
    v_dot2_f32_bf16 v38, v171, s68, v10
    v_dot2_f32_bf16 v39, v171, s69, v10
    s_add_u32 s67, s65, 45056
    v_cvt_pk_bf16_f32 v168, v32, v33
    v_cvt_pk_bf16_f32 v169, v34, v35
    v_cvt_pk_bf16_f32 v170, v36, v37
    v_cvt_pk_bf16_f32 v171, v38, v39
    buffer_store_dwordx4 v[168:171], v125, s[8:11], s67 offen sc1
    v_dot2_f32_bf16 v40, v172, s68, v11
    v_dot2_f32_bf16 v41, v172, s69, v11
    v_dot2_f32_bf16 v42, v173, s68, v11
    v_dot2_f32_bf16 v43, v173, s69, v11
    v_dot2_f32_bf16 v44, v174, s68, v11
    v_dot2_f32_bf16 v45, v174, s69, v11
    v_dot2_f32_bf16 v46, v175, s68, v11
    v_dot2_f32_bf16 v47, v175, s69, v11
    s_add_u32 s67, s65, 63488
    v_cvt_pk_bf16_f32 v172, v40, v41
    v_cvt_pk_bf16_f32 v173, v42, v43
    v_cvt_pk_bf16_f32 v174, v44, v45
    v_cvt_pk_bf16_f32 v175, v46, v47
    buffer_store_dwordx4 v[172:175], v125, s[8:11], s67 offen sc1
    v_dot2_f32_bf16 v32, v176, s68, v8
    v_dot2_f32_bf16 v33, v176, s69, v8
    v_dot2_f32_bf16 v34, v177, s68, v8
    v_dot2_f32_bf16 v35, v177, s69, v8
    v_dot2_f32_bf16 v36, v178, s68, v8
    v_dot2_f32_bf16 v37, v178, s69, v8
    v_dot2_f32_bf16 v38, v179, s68, v8
    v_dot2_f32_bf16 v39, v179, s69, v8
    s_add_u32 s67, s65, 12288
    v_cvt_pk_bf16_f32 v176, v32, v33
    v_cvt_pk_bf16_f32 v177, v34, v35
    v_cvt_pk_bf16_f32 v178, v36, v37
    v_cvt_pk_bf16_f32 v179, v38, v39
    buffer_store_dwordx4 v[176:179], v125, s[8:11], s67 offen sc1
    v_dot2_f32_bf16 v40, v180, s68, v9
    v_dot2_f32_bf16 v41, v180, s69, v9
    v_dot2_f32_bf16 v42, v181, s68, v9
    v_dot2_f32_bf16 v43, v181, s69, v9
    v_dot2_f32_bf16 v44, v182, s68, v9
    v_dot2_f32_bf16 v45, v182, s69, v9
    v_dot2_f32_bf16 v46, v183, s68, v9
    v_dot2_f32_bf16 v47, v183, s69, v9
    s_add_u32 s67, s65, 30720
    v_cvt_pk_bf16_f32 v180, v40, v41
    v_cvt_pk_bf16_f32 v181, v42, v43
    v_cvt_pk_bf16_f32 v182, v44, v45
    v_cvt_pk_bf16_f32 v183, v46, v47
    buffer_store_dwordx4 v[180:183], v125, s[8:11], s67 offen sc1
    v_dot2_f32_bf16 v32, v184, s68, v10
    v_dot2_f32_bf16 v33, v184, s69, v10
    v_dot2_f32_bf16 v34, v185, s68, v10
    v_dot2_f32_bf16 v35, v185, s69, v10
    v_dot2_f32_bf16 v36, v186, s68, v10
    v_dot2_f32_bf16 v37, v186, s69, v10
    v_dot2_f32_bf16 v38, v187, s68, v10
    v_dot2_f32_bf16 v39, v187, s69, v10
    s_add_u32 s67, s65, 49152
    v_cvt_pk_bf16_f32 v184, v32, v33
    v_cvt_pk_bf16_f32 v185, v34, v35
    v_cvt_pk_bf16_f32 v186, v36, v37
    v_cvt_pk_bf16_f32 v187, v38, v39
    buffer_store_dwordx4 v[184:187], v125, s[8:11], s67 offen sc1
    v_dot2_f32_bf16 v40, v188, s68, v11
    v_dot2_f32_bf16 v41, v188, s69, v11
    v_dot2_f32_bf16 v42, v189, s68, v11
    v_dot2_f32_bf16 v43, v189, s69, v11
    v_dot2_f32_bf16 v44, v190, s68, v11
    v_dot2_f32_bf16 v45, v190, s69, v11
    v_dot2_f32_bf16 v46, v191, s68, v11
    v_dot2_f32_bf16 v47, v191, s69, v11
    s_add_u32 s67, s65, 67584
    v_cvt_pk_bf16_f32 v188, v40, v41
    v_cvt_pk_bf16_f32 v189, v42, v43
    v_cvt_pk_bf16_f32 v190, v44, v45
    v_cvt_pk_bf16_f32 v191, v46, v47
    buffer_store_dwordx4 v[188:191], v125, s[8:11], s67 offen sc1
    s_cmp_ge_u32 s3, 2
    s_cbranch_scc1 L_front_end
    v_dot2_f32_bf16 v32, v192, s68, v8
    v_dot2_f32_bf16 v33, v192, s69, v8
    v_dot2_f32_bf16 v34, v193, s68, v8
    v_dot2_f32_bf16 v35, v193, s69, v8
    v_dot2_f32_bf16 v36, v194, s68, v8
    v_dot2_f32_bf16 v37, v194, s69, v8
    v_dot2_f32_bf16 v38, v195, s68, v8
    v_dot2_f32_bf16 v39, v195, s69, v8
    s_add_u32 s67, s65, 16384
    v_cvt_pk_bf16_f32 v192, v32, v33
    v_cvt_pk_bf16_f32 v193, v34, v35
    v_cvt_pk_bf16_f32 v194, v36, v37
    v_cvt_pk_bf16_f32 v195, v38, v39
    buffer_store_dwordx4 v[192:195], v125, s[8:11], s67 offen sc1
    v_dot2_f32_bf16 v40, v196, s68, v9
    v_dot2_f32_bf16 v41, v196, s69, v9
    v_dot2_f32_bf16 v42, v197, s68, v9
    v_dot2_f32_bf16 v43, v197, s69, v9
    v_dot2_f32_bf16 v44, v198, s68, v9
    v_dot2_f32_bf16 v45, v198, s69, v9
    v_dot2_f32_bf16 v46, v199, s68, v9
    v_dot2_f32_bf16 v47, v199, s69, v9
    s_add_u32 s67, s65, 34816
    v_cvt_pk_bf16_f32 v196, v40, v41
    v_cvt_pk_bf16_f32 v197, v42, v43
    v_cvt_pk_bf16_f32 v198, v44, v45
    v_cvt_pk_bf16_f32 v199, v46, v47
    buffer_store_dwordx4 v[196:199], v125, s[8:11], s67 offen sc1
    v_dot2_f32_bf16 v32, v200, s68, v10
    v_dot2_f32_bf16 v33, v200, s69, v10
    v_dot2_f32_bf16 v34, v201, s68, v10
    v_dot2_f32_bf16 v35, v201, s69, v10
    v_dot2_f32_bf16 v36, v202, s68, v10
    v_dot2_f32_bf16 v37, v202, s69, v10
    v_dot2_f32_bf16 v38, v203, s68, v10
    v_dot2_f32_bf16 v39, v203, s69, v10
    s_add_u32 s67, s65, 53248
    v_cvt_pk_bf16_f32 v200, v32, v33
    v_cvt_pk_bf16_f32 v201, v34, v35
    v_cvt_pk_bf16_f32 v202, v36, v37
    v_cvt_pk_bf16_f32 v203, v38, v39
    buffer_store_dwordx4 v[200:203], v125, s[8:11], s67 offen sc1
    v_dot2_f32_bf16 v40, v204, s68, v11
    v_dot2_f32_bf16 v41, v204, s69, v11
    v_dot2_f32_bf16 v42, v205, s68, v11
    v_dot2_f32_bf16 v43, v205, s69, v11
    v_dot2_f32_bf16 v44, v206, s68, v11
    v_dot2_f32_bf16 v45, v206, s69, v11
    v_dot2_f32_bf16 v46, v207, s68, v11
    v_dot2_f32_bf16 v47, v207, s69, v11
    s_add_u32 s67, s65, 71680
    v_cvt_pk_bf16_f32 v204, v40, v41
    v_cvt_pk_bf16_f32 v205, v42, v43
    v_cvt_pk_bf16_f32 v206, v44, v45
    v_cvt_pk_bf16_f32 v207, v46, v47
    buffer_store_dwordx4 v[204:207], v125, s[8:11], s67 offen sc1
    s_branch L_front_end
L_aux_st:
    s_sub_u32 s26, s2, 216
    s_mul_i32 s27, s3, 40
    s_add_u32 s27, s27, s26
    v_lshrrev_b32 v1, 3, v2
    v_mul_u32_u24 v3, 1152, v1
    v_and_b32_e64 v4, 7, v2
    v_lshl_add_u32 v3, v4, 4, v3
    s_mul_i32 s28, s27, 9216
    v_add_u32_e64 v3, s28, v3
    v_add_u32 v5, 1474560, v3
    buffer_load_dwordx4 v[12:15], v3, s[12:15], 0 offen offset:0
    buffer_load_dwordx4 v[16:19], v3, s[12:15], 0 offen offset:128
    buffer_load_dwordx4 v[20:23], v3, s[12:15], 0 offen offset:256
    buffer_load_dwordx4 v[24:27], v3, s[12:15], 0 offen offset:384
    buffer_load_dwordx4 v[28:31], v3, s[12:15], 0 offen offset:512
    buffer_load_dwordx4 v[32:35], v3, s[12:15], 0 offen offset:640
    buffer_load_dwordx4 v[36:39], v3, s[12:15], 0 offen offset:768
    buffer_load_dwordx4 v[40:43], v3, s[12:15], 0 offen offset:896
    buffer_load_dwordx4 v[44:47], v3, s[12:15], 0 offen offset:1024
    buffer_load_dwordx4 v[48:51], v5, s[12:15], 0 offen offset:0
    buffer_load_dwordx4 v[52:55], v5, s[12:15], 0 offen offset:128
    buffer_load_dwordx4 v[56:59], v5, s[12:15], 0 offen offset:256
    buffer_load_dwordx4 v[60:63], v5, s[12:15], 0 offen offset:384
    buffer_load_dwordx4 v[64:67], v5, s[12:15], 0 offen offset:512
    buffer_load_dwordx4 v[68:71], v5, s[12:15], 0 offen offset:640
    buffer_load_dwordx4 v[72:75], v5, s[12:15], 0 offen offset:768
    buffer_load_dwordx4 v[76:79], v5, s[12:15], 0 offen offset:896
    buffer_load_dwordx4 v[80:83], v5, s[12:15], 0 offen offset:1024
    v_min_u32_e64 v4, 1, v4
    v_lshlrev_b32 v4, 31, v4
    v_lshl_add_u32 v4, v1, 3, v4
    s_lshl_b32 s30, s2, 2
    s_add_u32 s30, s30, s3
    s_add_u32 s30, s30, 272
    s_mov_b32 s20, s54
    s_and_b32 s21, s55, 0xffff
    s_mov_b32 s22, 5308416
    s_mov_b32 s23, 0x20000
    s_mul_hi_u32 s28, s30, 0xe38e38f
    s_mul_i32 s29, s28, 18
    s_sub_u32 s29, s30, s29
    s_mul_hi_u32 s64, s28, 0x1c71c71d
    s_mul_i32 s64, s64, 662400
    s_lshl_b32 s65, s28, 7
    s_add_u32 s64, s64, s65
    s_mul_i32 s65, s29, 36864
    s_add_u32 s64, s64, s65
    s_mul_i32 s65, s28, 73728
    s_lshl_b32 s67, s29, 10
    s_add_u32 s65, s65, s67
    s_add_u32 s65, s65, 14155776
    s_mov_b32 s63, 1152
    s_mov_b32 s68, 9216
    s_mov_b32 s69, 9216
    s_mov_b32 s81, s65
    s_lshl_b32 s66, s3, 12
    v_lshrrev_b32 v1, 3, v2
    v_mul_u32_u24 v124, s63, v1
    v_lshrrev_b32 v1, 4, v2
    v_lshlrev_b32 v1, 1, v1
    v_xor_b32 v1, v1, v2
    v_and_b32_e64 v1, 7, v1
    v_lshl_add_u32 v124, v1, 4, v124
    v_lshrrev_b32_e64 v1, 2, v2
    v_lshl_add_u32 v120, v1, 7, s66
    v_bfe_u32 v1, v2, 3, 2
    v_lshl_add_u32 v120, v1, 5, v120
    v_and_b32 v1, 3, v2
    v_lshl_add_u32 v120, v1, 3, v120
    v_xor_b32 v121, 32, v120
    v_xor_b32_e64 v122, 64, v120
    v_xor_b32 v123, 96, v120
    v_lshlrev_b32 v125, 4, v2
    v_add_u32 v250, 98304, v120
    v_add_u32 v251, 98304, v121
    v_add_u32 v252, 98304, v122
    v_add_u32 v253, 98304, v123
    s_mov_b32 s83, 4096
    s_mov_b32 s28, 1065369472
    s_waitcnt vmcnt(15)
    v_dot2_f32_bf16 v7, v12, s28, 0
    v_dot2_f32_bf16 v6, v12, v12, 0
    v_dot2_f32_bf16 v7, v13, s28, v7
    v_dot2_f32_bf16 v6, v13, v13, v6
    v_dot2_f32_bf16 v7, v14, s28, v7
    v_dot2_f32_bf16 v6, v14, v14, v6
    v_dot2_f32_bf16 v7, v15, s28, v7
    v_dot2_f32_bf16 v6, v15, v15, v6
    v_dot2_f32_bf16 v7, v16, s28, v7
    v_dot2_f32_bf16 v6, v16, v16, v6
    v_dot2_f32_bf16 v7, v17, s28, v7
    v_dot2_f32_bf16 v6, v17, v17, v6
    v_dot2_f32_bf16 v7, v18, s28, v7
    v_dot2_f32_bf16 v6, v18, v18, v6
    v_dot2_f32_bf16 v7, v19, s28, v7
    v_dot2_f32_bf16 v6, v19, v19, v6
    v_dot2_f32_bf16 v7, v20, s28, v7
    v_dot2_f32_bf16 v6, v20, v20, v6
    v_dot2_f32_bf16 v7, v21, s28, v7
    v_dot2_f32_bf16 v6, v21, v21, v6
    v_dot2_f32_bf16 v7, v22, s28, v7
    v_dot2_f32_bf16 v6, v22, v22, v6
    v_dot2_f32_bf16 v7, v23, s28, v7
    v_dot2_f32_bf16 v6, v23, v23, v6
    s_waitcnt vmcnt(12)
    s_nop 0
    v_dot2_f32_bf16 v7, v24, s28, v7
    v_dot2_f32_bf16 v6, v24, v24, v6
    v_dot2_f32_bf16 v7, v25, s28, v7
    v_dot2_f32_bf16 v6, v25, v25, v6
    v_dot2_f32_bf16 v7, v26, s28, v7
    v_dot2_f32_bf16 v6, v26, v26, v6
    v_dot2_f32_bf16 v7, v27, s28, v7
    v_dot2_f32_bf16 v6, v27, v27, v6
    v_dot2_f32_bf16 v7, v28, s28, v7
    v_dot2_f32_bf16 v6, v28, v28, v6
    v_dot2_f32_bf16 v7, v29, s28, v7
    v_dot2_f32_bf16 v6, v29, v29, v6
    v_dot2_f32_bf16 v7, v30, s28, v7
    v_dot2_f32_bf16 v6, v30, v30, v6
    v_dot2_f32_bf16 v7, v31, s28, v7
    v_dot2_f32_bf16 v6, v31, v31, v6
    v_dot2_f32_bf16 v7, v32, s28, v7
    v_dot2_f32_bf16 v6, v32, v32, v6
    v_dot2_f32_bf16 v7, v33, s28, v7
    v_dot2_f32_bf16 v6, v33, v33, v6
    v_dot2_f32_bf16 v7, v34, s28, v7
    v_dot2_f32_bf16 v6, v34, v34, v6
    v_dot2_f32_bf16 v7, v35, s28, v7
    v_dot2_f32_bf16 v6, v35, v35, v6
    s_waitcnt vmcnt(9)
    s_nop 0
    v_dot2_f32_bf16 v7, v36, s28, v7
    v_dot2_f32_bf16 v6, v36, v36, v6
    v_dot2_f32_bf16 v7, v37, s28, v7
    v_dot2_f32_bf16 v6, v37, v37, v6
    v_dot2_f32_bf16 v7, v38, s28, v7
    v_dot2_f32_bf16 v6, v38, v38, v6
    v_dot2_f32_bf16 v7, v39, s28, v7
    v_dot2_f32_bf16 v6, v39, v39, v6
    v_dot2_f32_bf16 v7, v40, s28, v7
    v_dot2_f32_bf16 v6, v40, v40, v6
    v_dot2_f32_bf16 v7, v41, s28, v7
    v_dot2_f32_bf16 v6, v41, v41, v6
    v_dot2_f32_bf16 v7, v42, s28, v7
    v_dot2_f32_bf16 v6, v42, v42, v6
    v_dot2_f32_bf16 v7, v43, s28, v7
    v_dot2_f32_bf16 v6, v43, v43, v6
    v_dot2_f32_bf16 v7, v44, s28, v7
    v_dot2_f32_bf16 v6, v44, v44, v6
    v_dot2_f32_bf16 v7, v45, s28, v7
    v_dot2_f32_bf16 v6, v45, v45, v6
    v_dot2_f32_bf16 v7, v46, s28, v7
    v_dot2_f32_bf16 v6, v46, v46, v6
    v_dot2_f32_bf16 v7, v47, s28, v7
    v_dot2_f32_bf16 v6, v47, v47, v6
    s_waitcnt vmcnt(6)
    s_nop 0
    v_dot2_f32_bf16 v9, v48, s28, 0
    v_dot2_f32_bf16 v8, v48, v48, 0
    v_dot2_f32_bf16 v9, v49, s28, v9
    v_dot2_f32_bf16 v8, v49, v49, v8
    v_dot2_f32_bf16 v9, v50, s28, v9
    v_dot2_f32_bf16 v8, v50, v50, v8
    v_dot2_f32_bf16 v9, v51, s28, v9
    v_dot2_f32_bf16 v8, v51, v51, v8
    v_dot2_f32_bf16 v9, v52, s28, v9
    v_dot2_f32_bf16 v8, v52, v52, v8
    v_dot2_f32_bf16 v9, v53, s28, v9
    v_dot2_f32_bf16 v8, v53, v53, v8
    v_dot2_f32_bf16 v9, v54, s28, v9
    v_dot2_f32_bf16 v8, v54, v54, v8
    v_dot2_f32_bf16 v9, v55, s28, v9
    v_dot2_f32_bf16 v8, v55, v55, v8
    v_dot2_f32_bf16 v9, v56, s28, v9
    v_dot2_f32_bf16 v8, v56, v56, v8
    v_dot2_f32_bf16 v9, v57, s28, v9
    v_dot2_f32_bf16 v8, v57, v57, v8
    v_dot2_f32_bf16 v9, v58, s28, v9
    v_dot2_f32_bf16 v8, v58, v58, v8
    v_dot2_f32_bf16 v9, v59, s28, v9
    v_dot2_f32_bf16 v8, v59, v59, v8
    s_waitcnt vmcnt(3)
    s_nop 0
    v_dot2_f32_bf16 v9, v60, s28, v9
    v_dot2_f32_bf16 v8, v60, v60, v8
    v_dot2_f32_bf16 v9, v61, s28, v9
    v_dot2_f32_bf16 v8, v61, v61, v8
    v_dot2_f32_bf16 v9, v62, s28, v9
    v_dot2_f32_bf16 v8, v62, v62, v8
    v_dot2_f32_bf16 v9, v63, s28, v9
    v_dot2_f32_bf16 v8, v63, v63, v8
    v_dot2_f32_bf16 v9, v64, s28, v9
    v_dot2_f32_bf16 v8, v64, v64, v8
    v_dot2_f32_bf16 v9, v65, s28, v9
    v_dot2_f32_bf16 v8, v65, v65, v8
    v_dot2_f32_bf16 v9, v66, s28, v9
    v_dot2_f32_bf16 v8, v66, v66, v8
    v_dot2_f32_bf16 v9, v67, s28, v9
    v_dot2_f32_bf16 v8, v67, v67, v8
    v_dot2_f32_bf16 v9, v68, s28, v9
    v_dot2_f32_bf16 v8, v68, v68, v8
    v_dot2_f32_bf16 v9, v69, s28, v9
    v_dot2_f32_bf16 v8, v69, v69, v8
    v_dot2_f32_bf16 v9, v70, s28, v9
    v_dot2_f32_bf16 v8, v70, v70, v8
    v_dot2_f32_bf16 v9, v71, s28, v9
    v_dot2_f32_bf16 v8, v71, v71, v8
    s_waitcnt vmcnt(0)
    s_nop 0
    v_dot2_f32_bf16 v9, v72, s28, v9
    v_dot2_f32_bf16 v8, v72, v72, v8
    v_dot2_f32_bf16 v9, v73, s28, v9
    v_dot2_f32_bf16 v8, v73, v73, v8
    v_dot2_f32_bf16 v9, v74, s28, v9
    v_dot2_f32_bf16 v8, v74, v74, v8
    v_dot2_f32_bf16 v9, v75, s28, v9
    v_dot2_f32_bf16 v8, v75, v75, v8
    v_dot2_f32_bf16 v9, v76, s28, v9
    v_dot2_f32_bf16 v8, v76, v76, v8
    v_dot2_f32_bf16 v9, v77, s28, v9
    v_dot2_f32_bf16 v8, v77, v77, v8
    v_dot2_f32_bf16 v9, v78, s28, v9
    v_dot2_f32_bf16 v8, v78, v78, v8
    v_dot2_f32_bf16 v9, v79, s28, v9
    v_dot2_f32_bf16 v8, v79, v79, v8
    v_dot2_f32_bf16 v9, v80, s28, v9
    v_dot2_f32_bf16 v8, v80, v80, v8
    v_dot2_f32_bf16 v9, v81, s28, v9
    v_dot2_f32_bf16 v8, v81, v81, v8
    v_dot2_f32_bf16 v9, v82, s28, v9
    v_dot2_f32_bf16 v8, v82, v82, v8
    v_dot2_f32_bf16 v9, v83, s28, v9
    v_dot2_f32_bf16 v8, v83, v83, v8
    s_load_dword s80, s[58:59], 0
    s_lshl_b32 s28, s27, 6
    s_nop 0
    s_add_u32 s28, s28, 38338560
    s_add_u32 s29, s28, 10240
    v_add_f32_dpp v6, v6, v6 quad_perm:[1,0,3,2] row_mask:0xf bank_mask:0xf
    v_add_f32_dpp v7, v7, v7 quad_perm:[1,0,3,2] row_mask:0xf bank_mask:0xf
    v_add_f32_dpp v8, v8, v8 quad_perm:[1,0,3,2] row_mask:0xf bank_mask:0xf
    v_add_f32_dpp v9, v9, v9 quad_perm:[1,0,3,2] row_mask:0xf bank_mask:0xf
    v_add_f32_dpp v6, v6, v6 quad_perm:[2,3,0,1] row_mask:0xf bank_mask:0xf
    v_add_f32_dpp v7, v7, v7 quad_perm:[2,3,0,1] row_mask:0xf bank_mask:0xf
    v_add_f32_dpp v8, v8, v8 quad_perm:[2,3,0,1] row_mask:0xf bank_mask:0xf
    v_add_f32_dpp v9, v9, v9 quad_perm:[2,3,0,1] row_mask:0xf bank_mask:0xf
    v_add_f32_dpp v6, v6, v6 row_half_mirror row_mask:0xf bank_mask:0xf
    v_add_f32_dpp v7, v7, v7 row_half_mirror row_mask:0xf bank_mask:0xf
    v_add_f32_dpp v8, v8, v8 row_half_mirror row_mask:0xf bank_mask:0xf
    v_add_f32_dpp v9, v9, v9 row_half_mirror row_mask:0xf bank_mask:0xf
    v_mul_f32 v6, 987991609, v6
    v_mul_f32 v7, 987991609, v7
    v_mul_f32 v8, 987991609, v8
    v_mul_f32 v9, 987991609, v9
    v_fma_f32 v6, -v7, v7, v6
    v_fma_f32 v8, -v9, v9, v8
    v_max_f32 v6, 0, v6
    v_max_f32 v8, 0, v8
    v_add_f32 v6, 925353388, v6
    v_add_f32 v8, 925353388, v8
    v_rsq_f32 v6, v6
    v_rsq_f32 v8, v8
    v_or_b32_e64 v6, 1, v6
    v_or_b32_e64 v8, 1, v8
    v_mul_f32 v7, -v7, v6
    v_mul_f32 v9, -v9, v8
    s_waitcnt lgkmcnt(0)
    s_cmp_lt_u32 s80, 1
    s_cbranch_scc1 L_zfs
L_zfoks:
    buffer_store_dwordx2 v[6:7], v4, s[8:11], s28 offen sc1
    s_cmp_ge_u32 s27, 96
    s_cbranch_scc1 L_aux_4
    buffer_store_dwordx2 v[8:9], v4, s[8:11], s29 offen sc1
L_aux_4:
    s_add_u32 m0, s66, 98304
    s_nop 0
    buffer_load_dwordx4 v124, s[20:23], s64 offen nt lds
    s_add_u32 m0, s66, 99328
    s_add_u32 s64, s64, s68
    buffer_load_dwordx4 v124, s[20:23], s64 offen nt lds
    s_add_u32 m0, s66, 100352
    s_add_u32 s64, s64, s68
    buffer_load_dwordx4 v124, s[20:23], s64 offen nt lds
    s_add_u32 m0, s66, 101376
    s_add_u32 s64, s64, s68
    buffer_load_dwordx4 v124, s[20:23], s64 offen nt lds
    s_add_u32 s64, s64, s69
    s_cmp_ge_u32 s26, 34
    s_cbranch_scc1 L_front_end
    s_lshl_b32 s30, s26, 2
    s_add_u32 s30, s30, s3
    s_lshl_b32 s30, s30, 1
    s_mov_b32 s20, s54
    s_and_b32 s21, s55, 0xffff
    s_mov_b32 s22, 5308416
    s_mov_b32 s23, 0x20000
    s_mul_hi_u32 s28, s30, 0xe38e38f
    s_mul_i32 s29, s28, 18
    s_sub_u32 s29, s30, s29
    s_mul_hi_u32 s64, s28, 0x1c71c71d
    s_mul_i32 s64, s64, 662400
    s_lshl_b32 s65, s28, 7
    s_add_u32 s64, s64, s65
    s_mul_i32 s65, s29, 36864
    s_add_u32 s64, s64, s65
    s_mul_i32 s65, s28, 73728
    s_lshl_b32 s67, s29, 10
    s_add_u32 s65, s65, s67
    s_add_u32 s65, s65, 14155776
    s_mov_b32 s63, 1152
    s_mov_b32 s68, 9216
    s_mov_b32 s69, 9216
    s_add_u32 m0, s66, 0
    s_nop 0
    buffer_load_dwordx4 v124, s[20:23], s64 offen nt lds
    s_add_u32 m0, s66, 1024
    s_add_u32 s64, s64, s68
    buffer_load_dwordx4 v124, s[20:23], s64 offen nt lds
    s_add_u32 m0, s66, 2048
    s_add_u32 s64, s64, s68
    buffer_load_dwordx4 v124, s[20:23], s64 offen nt lds
    s_add_u32 m0, s66, 3072
    s_add_u32 s64, s64, s68
    buffer_load_dwordx4 v124, s[20:23], s64 offen nt lds
    s_add_u32 s64, s64, s69
    s_add_u32 m0, s66, 16384
    s_nop 0
    buffer_load_dwordx4 v124, s[20:23], s64 offen nt lds
    s_add_u32 m0, s66, 17408
    s_add_u32 s64, s64, s68
    buffer_load_dwordx4 v124, s[20:23], s64 offen nt lds
    s_add_u32 m0, s66, 18432
    s_add_u32 s64, s64, s68
    buffer_load_dwordx4 v124, s[20:23], s64 offen nt lds
    s_add_u32 m0, s66, 19456
    s_add_u32 s64, s64, s68
    buffer_load_dwordx4 v124, s[20:23], s64 offen nt lds
    s_add_u32 s64, s64, s69
    s_waitcnt vmcnt(0)
    ds_read_b64_tr_b16 v[128:129], v120 offset:0
    ds_read_b64_tr_b16 v[130:131], v120 offset:2048
    ds_read_b64_tr_b16 v[132:133], v121 offset:0
    ds_read_b64_tr_b16 v[134:135], v121 offset:2048
    ds_read_b64_tr_b16 v[136:137], v122 offset:0
    ds_read_b64_tr_b16 v[138:139], v122 offset:2048
    ds_read_b64_tr_b16 v[140:141], v123 offset:0
    ds_read_b64_tr_b16 v[142:143], v123 offset:2048
    s_waitcnt lgkmcnt(0)
    s_add_u32 s67, s65, 0
    buffer_store_dwordx4 v[128:131], v125, s[8:11], s67 offen sc1
    s_add_u32 s67, s65, 18432
    buffer_store_dwordx4 v[132:135], v125, s[8:11], s67 offen sc1
    s_add_u32 s67, s65, 36864
    buffer_store_dwordx4 v[136:139], v125, s[8:11], s67 offen sc1
    s_add_u32 s67, s65, 55296
    buffer_store_dwordx4 v[140:143], v125, s[8:11], s67 offen sc1
    ds_read_b64_tr_b16 v[144:145], v120 offset:16384
    ds_read_b64_tr_b16 v[146:147], v120 offset:18432
    ds_read_b64_tr_b16 v[148:149], v121 offset:16384
    ds_read_b64_tr_b16 v[150:151], v121 offset:18432
    ds_read_b64_tr_b16 v[152:153], v122 offset:16384
    ds_read_b64_tr_b16 v[154:155], v122 offset:18432
    ds_read_b64_tr_b16 v[156:157], v123 offset:16384
    ds_read_b64_tr_b16 v[158:159], v123 offset:18432
    s_waitcnt lgkmcnt(0)
    s_nop 0
    s_add_u32 s67, s65, 1024
    buffer_store_dwordx4 v[144:147], v125, s[8:11], s67 offen sc1
    s_add_u32 s67, s65, 19456
    buffer_store_dwordx4 v[148:151], v125, s[8:11], s67 offen sc1
    s_add_u32 s67, s65, 37888
    buffer_store_dwordx4 v[152:155], v125, s[8:11], s67 offen sc1
    s_add_u32 s67, s65, 56320
    buffer_store_dwordx4 v[156:159], v125, s[8:11], s67 offen sc1
    s_branch L_front_end
L_zfc:
    v_mov_b32 v3, 0
    global_load_dword v3, v3, s[58:59] sc1
    s_waitcnt vmcnt(0)
    v_readfirstlane_b32 s80, v3
    s_nop 0
    s_cmp_ge_u32 s80, 1
    s_cbranch_scc1 L_zfokc
    s_cmp_eq_u32 s72, 0
    s_cbranch_scc1 L_zfokc
    s_sub_u32 s72, s72, 1
    s_sleep 2
    s_branch L_zfc
L_st_slow:
    s_cmp_eq_u32 s72, 0
    s_cbranch_scc1 L_st_back
    s_sub_u32 s72, s72, 1
    s_sleep 1
    buffer_load_dwordx4 v[180:183], v137, s[8:11], 0 offen offset:0 sc1
    buffer_load_dwordx4 v[184:187], v137, s[8:11], 0 offen offset:16 sc1
    buffer_load_dwordx4 v[188:191], v137, s[8:11], 0 offen offset:32 sc1
    buffer_load_dwordx4 v[192:195], v137, s[8:11], 0 offen offset:48 sc1
    s_waitcnt vmcnt(0)
    v_min_u32 v1, v180, v182
    v_min3_u32 v1, v1, v184, v186
    v_min3_u32 v1, v1, v188, v190
    v_min3_u32 v1, v1, v192, v194
    v_cmp_eq_u32 vcc, 0, v1
    s_cbranch_vccnz L_st_slow
    s_branch L_st_back
L_zff:
    v_mov_b32 v25, 0
    s_mov_b64 exec, 1
    global_atomic_add v25, v25, v25, s[58:59] offset:128 sc0 sc1
    s_mov_b64 exec, -1
    s_waitcnt vmcnt(0)
    v_readfirstlane_b32 s80, v25
    s_nop 0
    s_cmp_ge_u32 s80, 25
    s_cbranch_scc1 L_zfokf
    s_cmp_eq_u32 s31, 0
    s_cbranch_scc1 L_zfokf
    s_sub_u32 s31, s31, 1
    s_sleep 2
    s_branch L_zff
L_zfs:
    v_mov_b32 v3, 0
    global_load_dword v3, v3, s[58:59] sc1
    s_waitcnt vmcnt(0)
    v_readfirstlane_b32 s80, v3
    s_nop 0
    s_cmp_ge_u32 s80, 1
    s_cbranch_scc1 L_zfoks
    s_cmp_eq_u32 s72, 0
    s_cbranch_scc1 L_zfoks
    s_sub_u32 s72, s72, 1
    s_sleep 2
    s_branch L_zfs
L_code_end:
.section .rodata,"a"
.p2align 6
.amdhsa_kernel sequential_preLN__ssm_conv_s4__dense_activation_relu__prompt_kernel
  .amdhsa_next_free_vgpr 512
  .amdhsa_next_free_sgpr 96
  .amdhsa_accum_offset 256
  .amdhsa_group_segment_fixed_size 0
  .amdhsa_kernarg_size 120
  .amdhsa_user_sgpr_count 2
  .amdhsa_user_sgpr_kernarg_segment_ptr 1
  .amdhsa_system_sgpr_workgroup_id_x 1
.end_amdhsa_kernel
```
